```python
import torch

def _softmax(x, axis=-1):
    return torch.softmax(x, dim=axis)
def _gelu(x):
    return torch.nn.functional.gelu(x, approximate="tanh")
def _silu(x):
    return torch.nn.functional.silu(x)
def _sigmoid(x):
    return torch.sigmoid(x)
def _layernorm(x, axis=-1, eps=1e-5):
    m = x.mean(dim=axis, keepdim=True)
    v = x.var(dim=axis, keepdim=True, unbiased=False)
    return (x - m) / torch.sqrt(v + eps)
def _scatter_add(tgt, idx, src, axis=0):
    return tgt.clone().index_add_(axis, idx, src)
def _segment_sum(src, seg, n):
    out = torch.zeros((n,) + src.shape[1:], dtype=src.dtype)
    return out.index_add_(0, seg, src)
def _pad(x, pw):
    flat = tuple(v for pair in reversed(pw) for v in pair)
    return torch.nn.functional.pad(x, flat)

kernel_name = 'interleave_layers__ssm_conv_h3__linear_attn_block__prompt'

def setup_inputs():

    _w = (lambda a: (lambda t: t.to(torch.bfloat16) if t.is_floating_point() else t)(torch.as_tensor(a)))
    def _A_setup():
        B, S, D = 1, 2048, 1024
        ks = 4
        return {
            "q": _w((lambda *s: torch.randn(*s, dtype=torch.bfloat16) * 0.05)(B, S, D)),
            "k": _w((lambda *s: torch.randn(*s, dtype=torch.bfloat16) * 0.4)(B, S, D)),
            "v": _w((lambda *s: torch.randn(*s, dtype=torch.bfloat16) * 0.4)(B, S, D)),
            "shift_k": _w((lambda *s: torch.randn(*s, dtype=torch.bfloat16) * 0.4)(D, ks) * 0.5),
            "ssm_k": _w((lambda *s: torch.randn(*s, dtype=torch.bfloat16) * 0.4)(D, S) * (1.0 / S ** 0.5)),
            "ssm_D": _w((lambda *s: torch.randn(*s, dtype=torch.bfloat16) * 0.4)(D)),
        }
    _A_in = _A_setup()

    def _B_setup():
        B, S, D = 1, 2048, 1024
        return {
            "x": _w((lambda *s: torch.randn(*s, dtype=torch.bfloat16) * 0.05)(B, S, D)),
            "wqkv": _w((lambda *s: torch.randn(*s, dtype=torch.bfloat16) * 0.1)(D, 3 * D)),
            "wo": _w((lambda *s: torch.randn(*s, dtype=torch.bfloat16) * 0.05)(D, D)),
        }
    _B_in = _B_setup()

    return {
        "A_q": _A_in["q"],
        "A_k": _A_in["k"],
        "A_v": _A_in["v"],
        "A_shift_k": _A_in["shift_k"],
        "A_ssm_k": _A_in["ssm_k"],
        "A_ssm_D": _A_in["ssm_D"],
        "B_x": _B_in["x"],
        "B_wqkv": _B_in["wqkv"],
        "B_wo": _B_in["wo"],
    }

def reference(A_q, A_k, A_v, A_shift_k, A_ssm_k, A_ssm_D, B_x, B_wqkv, B_wo):
    def _A_ref(q, k, v, shift_k, ssm_k, ssm_D):
        B, S, D = q.shape
        ks = shift_k.shape[-1]
        k_pad = _pad(k, ((0, 0), (ks - 1, 0), (0, 0)))
        k_shift = torch.zeros_like(k)
        for t in range(ks):
            k_shift = k_shift + k_pad[:, t:t + S, :] * shift_k[:, ks - 1 - t][None, None, :]
        kv = k_shift * v
        L = 2 * S
        kv_pad = _pad(kv, ((0, 0), (0, S), (0, 0)))
        kf_pad = _pad(ssm_k, ((0, 0), (0, S)))
        kv_f = (lambda x, axes=(-2,-1): torch.fft.rfft2(x.float(), dim=axes))(kv_pad[:, None, :, :], axes=(1, 2))
        kf_f = (lambda x, axes=(-2,-1): torch.fft.rfft2(x.float(), dim=axes))(kf_pad[:, None, :], axes=(1, 2))
        kf_f = (lambda x, *d: x.permute(*d))(kf_f, 1, 2, 0)
        y_f = kv_f * kf_f[None, :, :, :]
        y = (lambda x, s, axes=(-2,-1): torch.fft.irfft2(x, s=s, dim=axes).to(torch.bfloat16))(y_f, (1, L), axes=(1, 2))[:, 0, :S, :]
        y = y + kv * ssm_D[None, None, :]
        return q * y

    def _B_ref(x, wqkv, wo):
        B, S, D = x.shape
        H = 32; Dh = D // H
        qkv = (lambda x, *d: x.permute(*d))((x @ wqkv).reshape(B, S, 3, H, Dh), 2, 0, 3, 1, 4)
        q, k, v = qkv[0], qkv[1], qkv[2]
        phi = lambda t: torch.where(t > 0, t + 1, torch.exp(t)) + 1e-6
        pq, pk = phi(q), phi(k)
        kv = torch.einsum("bhsd,bhse->bhde", pk, v)
        z = torch.einsum("bhsd->bhd", pk)
        num = torch.einsum("bhqd,bhde->bhqe", pq, kv)
        den = torch.einsum("bhqd,bhd->bhq", pq, z)[..., None] + 1e-6
        o = num / den
        return (lambda x, *d: x.permute(*d))(o, 0, 2, 1, 3).reshape(B, S, D) @ wo

    x = A_q
    x = x + _A_ref(_layernorm(x, axis=-1), A_k, A_v, A_shift_k, A_ssm_k, A_ssm_D)
    x = x + _B_ref(_layernorm(x, axis=-1), B_wqkv, B_wo)
    x = x + _A_ref(_layernorm(x, axis=-1), A_k, A_v, A_shift_k, A_ssm_k, A_ssm_D)
    x = x + _B_ref(_layernorm(x, axis=-1), B_wqkv, B_wo)
    return x
```

```asm
; @launch grid=(256,1,1) block=(512,1,1) lds=163840
.amdgcn_target "amdgcn-amd-amdhsa--gfx950"
.text
.globl interleave_layers__ssm_conv_h3__linear_attn_block__prompt_kernel
.p2align 8
.type interleave_layers__ssm_conv_h3__linear_attn_block__prompt_kernel,@function
interleave_layers__ssm_conv_h3__linear_attn_block__prompt_kernel:
    s_cmp_ge_u32 s2, 256
    s_cbranch_scc1 L_done
    s_load_dwordx2 s[64:65], s[0:1], 88
    s_load_dwordx2 s[66:67], s[0:1], 0
    s_load_dwordx4 s[68:71], s[0:1], 8
    s_load_dwordx4 s[72:75], s[0:1], 24
    s_load_dwordx2 s[76:77], s[0:1], 40
    s_load_dwordx2 s[78:79], s[0:1], 56
    s_load_dwordx4 s[80:83], s[0:1], 64
    s_load_dwordx2 s[84:85], s[0:1], 80
    v_lshrrev_b32 v1, 6, v0
    s_nop 0
    v_readfirstlane_b32 s3, v1
    s_waitcnt lgkmcnt(0)
    s_add_u32 s88, s64, 0x2500000
    s_addc_u32 s89, s65, 0
    s_mov_b32 s90, 0x200000
    s_mov_b32 s91, 0x20000
    s_mov_b32 s4, s84
    s_mov_b32 s5, s85
    s_mov_b32 s6, 0x100
    s_mov_b32 s7, 0x20000
    s_or_b32 s8, s2, s3
    s_cmp_lg_u32 s8, 0
    s_cbranch_scc1 non_1
    s_memrealtime s[8:9]
    s_waitcnt lgkmcnt(0)
    s_or_b32 s8, s8, 1
    v_mov_b32 v1, 0
    v_mov_b32 v2, s8
    s_mov_b64 exec, 1
    buffer_store_dword v2, v1, s[4:7], 0 offen sc1
    s_mov_b64 exec, -1
non_1:
    s_cmp_lt_u32 s3, 4
    s_cbranch_scc1 zr_2
    v_subrev_u32 v1, 256, v0
    v_mov_b32 v4, 0
    v_mov_b32 v5, 0
    v_mov_b32 v6, 0
    v_mov_b32 v7, 0
    s_add_u32 s8, s64, 0x2400000
    s_addc_u32 s9, s65, 0
    s_mov_b32 s10, 0x44000
    s_mov_b32 s11, 0x20000
    s_mul_i32 s12, s2, 1088
    v_lshlrev_b32 v2, 4, v1
    v_add_u32 v2, s12, v2
    v_cmp_gt_u32 vcc, 68, v1
    s_and_saveexec_b64 s[14:15], vcc
    s_cbranch_execz zr_3
    buffer_store_dwordx4 v[4:7], v2, s[8:11], 0 offen sc1
zr_3:
    s_mov_b64 exec, s[14:15]
    s_lshl_b32 s12, s2, 8
    s_add_u32 s12, s12, 262144
    v_mov_b32 v2, s12
    s_mov_b64 exec, 1
    buffer_store_dword v4, v2, s[88:91], 0 offen sc1
    v_add_u32 v2, 0x10000, v2
    buffer_store_dword v4, v2, s[88:91], 0 offen sc1
    s_mov_b64 exec, -1
    s_cmp_ge_u32 s2, 224
    s_cbranch_scc1 zr_2
    s_lshl_b32 s12, s2, 8
    v_mov_b32 v2, s12
    s_mov_b64 exec, 1
    buffer_store_dword v4, v2, s[88:91], 0 offen sc1
    s_mov_b64 exec, -1
zr_2:
    s_and_b32 s4, s2, 7
    s_lshl_b32 s4, s4, 1
    s_bfe_u32 s5, s2, 0x10003
    s_add_u32 s4, s4, s5
    s_lshr_b32 s5, s2, 4
    s_cmp_ge_u32 s3, 4
    s_cbranch_scc1 L_fill
    s_lshl_b32 s28, s4, 7
    s_lshl_b32 s29, s5, 7
    v_and_b32 v1, 7, v0
    v_lshrrev_b32 v2, 3, v0
    v_lshlrev_b32 v3, 2, v2
    v_add_u32 v3, s29, v3
    v_lshlrev_b32 v4, 4, v1
    v_add_u32 v4, s28, v4
    v_lshlrev_b32 v5, 11, v3
    v_add_u32 v5, v5, v4
    v_add_u32 v6, 0xffffe800, v5
    v_add_u32 v7, 0xfffff000, v5
    v_add_u32 v8, 0xfffff800, v5
    v_add_u32 v9, 0x0, v5
    v_add_u32 v10, 0x800, v5
    v_add_u32 v11, 0x1000, v5
    v_add_u32 v12, 0x1800, v5
    v_lshlrev_b32 v13, 2, v4
    v_lshlrev_b32 v14, 11, v4
    v_lshlrev_b32 v15, 1, v3
    v_sub_u32 v15, 4088, v15
    v_add_u32 v14, v14, v15
    s_mov_b32 s12, s68
    s_mov_b32 s13, s69
    s_mov_b32 s14, 0x400000
    s_mov_b32 s15, 0x20000
    s_mov_b32 s16, s70
    s_mov_b32 s17, s71
    s_mov_b32 s18, 0x400000
    s_mov_b32 s19, 0x20000
    s_mov_b32 s20, s72
    s_mov_b32 s21, s73
    s_mov_b32 s22, 0x2000
    s_mov_b32 s23, 0x20000
    s_mov_b32 s24, s64
    s_mov_b32 s25, s65
    s_mov_b32 s26, 0x400000
    s_mov_b32 s27, 0x20000
    buffer_load_dwordx4 v[16:19], v6, s[12:15], 0 offen
    buffer_load_dwordx4 v[20:23], v7, s[12:15], 0 offen
    buffer_load_dwordx4 v[24:27], v8, s[12:15], 0 offen
    buffer_load_dwordx4 v[28:31], v9, s[12:15], 0 offen
    buffer_load_dwordx4 v[32:35], v10, s[12:15], 0 offen
    buffer_load_dwordx4 v[36:39], v11, s[12:15], 0 offen
    buffer_load_dwordx4 v[40:43], v12, s[12:15], 0 offen
    buffer_load_dwordx4 v[60:63], v13, s[20:23], 0 offen offset:0
    buffer_load_dwordx4 v[64:67], v13, s[20:23], 0 offen offset:16
    buffer_load_dwordx4 v[68:71], v13, s[20:23], 0 offen offset:32
    buffer_load_dwordx4 v[72:75], v13, s[20:23], 0 offen offset:48
    buffer_load_dwordx4 v[44:47], v9, s[16:19], 0 offen
    buffer_load_dwordx4 v[48:51], v10, s[16:19], 0 offen
    buffer_load_dwordx4 v[52:55], v11, s[16:19], 0 offen
    buffer_load_dwordx4 v[56:59], v12, s[16:19], 0 offen
    s_waitcnt vmcnt(8)
    v_lshlrev_b32 v76, 16, v16
    v_and_b32 v77, 0xffff0000, v16
    v_lshlrev_b32 v78, 16, v17
    v_and_b32 v79, 0xffff0000, v17
    v_lshlrev_b32 v80, 16, v18
    v_and_b32 v81, 0xffff0000, v18
    v_lshlrev_b32 v82, 16, v19
    v_and_b32 v83, 0xffff0000, v19
    v_lshlrev_b32 v84, 16, v20
    v_and_b32 v85, 0xffff0000, v20
    v_lshlrev_b32 v86, 16, v21
    v_and_b32 v87, 0xffff0000, v21
    v_lshlrev_b32 v88, 16, v22
    v_and_b32 v89, 0xffff0000, v22
    v_lshlrev_b32 v90, 16, v23
    v_and_b32 v91, 0xffff0000, v23
    v_lshlrev_b32 v92, 16, v24
    v_and_b32 v93, 0xffff0000, v24
    v_lshlrev_b32 v94, 16, v25
    v_and_b32 v95, 0xffff0000, v25
    v_lshlrev_b32 v96, 16, v26
    v_and_b32 v97, 0xffff0000, v26
    v_lshlrev_b32 v98, 16, v27
    v_and_b32 v99, 0xffff0000, v27
    v_lshlrev_b32 v100, 16, v28
    v_and_b32 v101, 0xffff0000, v28
    v_lshlrev_b32 v102, 16, v29
    v_and_b32 v103, 0xffff0000, v29
    v_lshlrev_b32 v104, 16, v30
    v_and_b32 v105, 0xffff0000, v30
    v_lshlrev_b32 v106, 16, v31
    v_and_b32 v107, 0xffff0000, v31
    v_lshlrev_b32 v108, 16, v32
    v_and_b32 v109, 0xffff0000, v32
    v_lshlrev_b32 v110, 16, v33
    v_and_b32 v111, 0xffff0000, v33
    v_lshlrev_b32 v112, 16, v34
    v_and_b32 v113, 0xffff0000, v34
    v_lshlrev_b32 v114, 16, v35
    v_and_b32 v115, 0xffff0000, v35
    v_lshlrev_b32 v116, 16, v36
    v_and_b32 v117, 0xffff0000, v36
    v_lshlrev_b32 v118, 16, v37
    v_and_b32 v119, 0xffff0000, v37
    v_lshlrev_b32 v120, 16, v38
    v_and_b32 v121, 0xffff0000, v38
    v_lshlrev_b32 v122, 16, v39
    v_and_b32 v123, 0xffff0000, v39
    v_lshlrev_b32 v124, 16, v40
    v_and_b32 v125, 0xffff0000, v40
    v_lshlrev_b32 v126, 16, v41
    v_and_b32 v127, 0xffff0000, v41
    v_lshlrev_b32 v128, 16, v42
    v_and_b32 v129, 0xffff0000, v42
    v_lshlrev_b32 v130, 16, v43
    v_and_b32 v131, 0xffff0000, v43
    s_waitcnt vmcnt(4)
    v_lshlrev_b32 v132, 16, v60
    v_and_b32 v140, 0xffff0000, v60
    v_lshlrev_b32 v148, 16, v61
    v_and_b32 v156, 0xffff0000, v61
    v_lshlrev_b32 v133, 16, v62
    v_and_b32 v141, 0xffff0000, v62
    v_lshlrev_b32 v149, 16, v63
    v_and_b32 v157, 0xffff0000, v63
    v_lshlrev_b32 v134, 16, v64
    v_and_b32 v142, 0xffff0000, v64
    v_lshlrev_b32 v150, 16, v65
    v_and_b32 v158, 0xffff0000, v65
    v_lshlrev_b32 v135, 16, v66
    v_and_b32 v143, 0xffff0000, v66
    v_lshlrev_b32 v151, 16, v67
    v_and_b32 v159, 0xffff0000, v67
    v_lshlrev_b32 v136, 16, v68
    v_and_b32 v144, 0xffff0000, v68
    v_lshlrev_b32 v152, 16, v69
    v_and_b32 v160, 0xffff0000, v69
    v_lshlrev_b32 v137, 16, v70
    v_and_b32 v145, 0xffff0000, v70
    v_lshlrev_b32 v153, 16, v71
    v_and_b32 v161, 0xffff0000, v71
    v_lshlrev_b32 v138, 16, v72
    v_and_b32 v146, 0xffff0000, v72
    v_lshlrev_b32 v154, 16, v73
    v_and_b32 v162, 0xffff0000, v73
    v_lshlrev_b32 v139, 16, v74
    v_and_b32 v147, 0xffff0000, v74
    v_lshlrev_b32 v155, 16, v75
    v_and_b32 v163, 0xffff0000, v75
    v_pk_mul_f32 v[196:197], v[76:77], v[156:157]
    v_pk_fma_f32 v[196:197], v[84:85], v[148:149], v[196:197]
    v_pk_fma_f32 v[196:197], v[92:93], v[140:141], v[196:197]
    v_pk_fma_f32 v[196:197], v[100:101], v[132:133], v[196:197]
    v_pk_mul_f32 v[198:199], v[78:79], v[158:159]
    v_pk_fma_f32 v[198:199], v[86:87], v[150:151], v[198:199]
    v_pk_fma_f32 v[198:199], v[94:95], v[142:143], v[198:199]
    v_pk_fma_f32 v[198:199], v[102:103], v[134:135], v[198:199]
    v_pk_mul_f32 v[200:201], v[80:81], v[160:161]
    v_pk_fma_f32 v[200:201], v[88:89], v[152:153], v[200:201]
    v_pk_fma_f32 v[200:201], v[96:97], v[144:145], v[200:201]
    v_pk_fma_f32 v[200:201], v[104:105], v[136:137], v[200:201]
    v_pk_mul_f32 v[202:203], v[82:83], v[162:163]
    v_pk_fma_f32 v[202:203], v[90:91], v[154:155], v[202:203]
    v_pk_fma_f32 v[202:203], v[98:99], v[146:147], v[202:203]
    v_pk_fma_f32 v[202:203], v[106:107], v[138:139], v[202:203]
    v_pk_mul_f32 v[204:205], v[84:85], v[156:157]
    v_pk_fma_f32 v[204:205], v[92:93], v[148:149], v[204:205]
    v_pk_fma_f32 v[204:205], v[100:101], v[140:141], v[204:205]
    v_pk_fma_f32 v[204:205], v[108:109], v[132:133], v[204:205]
    v_pk_mul_f32 v[206:207], v[86:87], v[158:159]
    v_pk_fma_f32 v[206:207], v[94:95], v[150:151], v[206:207]
    v_pk_fma_f32 v[206:207], v[102:103], v[142:143], v[206:207]
    v_pk_fma_f32 v[206:207], v[110:111], v[134:135], v[206:207]
    v_pk_mul_f32 v[208:209], v[88:89], v[160:161]
    v_pk_fma_f32 v[208:209], v[96:97], v[152:153], v[208:209]
    v_pk_fma_f32 v[208:209], v[104:105], v[144:145], v[208:209]
    v_pk_fma_f32 v[208:209], v[112:113], v[136:137], v[208:209]
    v_pk_mul_f32 v[210:211], v[90:91], v[162:163]
    v_pk_fma_f32 v[210:211], v[98:99], v[154:155], v[210:211]
    v_pk_fma_f32 v[210:211], v[106:107], v[146:147], v[210:211]
    v_pk_fma_f32 v[210:211], v[114:115], v[138:139], v[210:211]
    v_pk_mul_f32 v[212:213], v[92:93], v[156:157]
    v_pk_fma_f32 v[212:213], v[100:101], v[148:149], v[212:213]
    v_pk_fma_f32 v[212:213], v[108:109], v[140:141], v[212:213]
    v_pk_fma_f32 v[212:213], v[116:117], v[132:133], v[212:213]
    v_pk_mul_f32 v[214:215], v[94:95], v[158:159]
    v_pk_fma_f32 v[214:215], v[102:103], v[150:151], v[214:215]
    v_pk_fma_f32 v[214:215], v[110:111], v[142:143], v[214:215]
    v_pk_fma_f32 v[214:215], v[118:119], v[134:135], v[214:215]
    v_pk_mul_f32 v[216:217], v[96:97], v[160:161]
    v_pk_fma_f32 v[216:217], v[104:105], v[152:153], v[216:217]
    v_pk_fma_f32 v[216:217], v[112:113], v[144:145], v[216:217]
    v_pk_fma_f32 v[216:217], v[120:121], v[136:137], v[216:217]
    v_pk_mul_f32 v[218:219], v[98:99], v[162:163]
    v_pk_fma_f32 v[218:219], v[106:107], v[154:155], v[218:219]
    v_pk_fma_f32 v[218:219], v[114:115], v[146:147], v[218:219]
    v_pk_fma_f32 v[218:219], v[122:123], v[138:139], v[218:219]
    v_pk_mul_f32 v[220:221], v[100:101], v[156:157]
    v_pk_fma_f32 v[220:221], v[108:109], v[148:149], v[220:221]
    v_pk_fma_f32 v[220:221], v[116:117], v[140:141], v[220:221]
    v_pk_fma_f32 v[220:221], v[124:125], v[132:133], v[220:221]
    v_pk_mul_f32 v[222:223], v[102:103], v[158:159]
    v_pk_fma_f32 v[222:223], v[110:111], v[150:151], v[222:223]
    v_pk_fma_f32 v[222:223], v[118:119], v[142:143], v[222:223]
    v_pk_fma_f32 v[222:223], v[126:127], v[134:135], v[222:223]
    v_pk_mul_f32 v[224:225], v[104:105], v[160:161]
    v_pk_fma_f32 v[224:225], v[112:113], v[152:153], v[224:225]
    v_pk_fma_f32 v[224:225], v[120:121], v[144:145], v[224:225]
    v_pk_fma_f32 v[224:225], v[128:129], v[136:137], v[224:225]
    v_pk_mul_f32 v[226:227], v[106:107], v[162:163]
    v_pk_fma_f32 v[226:227], v[114:115], v[154:155], v[226:227]
    v_pk_fma_f32 v[226:227], v[122:123], v[146:147], v[226:227]
    v_pk_fma_f32 v[226:227], v[130:131], v[138:139], v[226:227]
    s_waitcnt vmcnt(0)
    v_lshlrev_b32 v164, 16, v44
    v_and_b32 v165, 0xffff0000, v44
    v_lshlrev_b32 v166, 16, v45
    v_and_b32 v167, 0xffff0000, v45
    v_lshlrev_b32 v168, 16, v46
    v_and_b32 v169, 0xffff0000, v46
    v_lshlrev_b32 v170, 16, v47
    v_and_b32 v171, 0xffff0000, v47
    v_lshlrev_b32 v172, 16, v48
    v_and_b32 v173, 0xffff0000, v48
    v_lshlrev_b32 v174, 16, v49
    v_and_b32 v175, 0xffff0000, v49
    v_lshlrev_b32 v176, 16, v50
    v_and_b32 v177, 0xffff0000, v50
    v_lshlrev_b32 v178, 16, v51
    v_and_b32 v179, 0xffff0000, v51
    v_lshlrev_b32 v180, 16, v52
    v_and_b32 v181, 0xffff0000, v52
    v_lshlrev_b32 v182, 16, v53
    v_and_b32 v183, 0xffff0000, v53
    v_lshlrev_b32 v184, 16, v54
    v_and_b32 v185, 0xffff0000, v54
    v_lshlrev_b32 v186, 16, v55
    v_and_b32 v187, 0xffff0000, v55
    v_lshlrev_b32 v188, 16, v56
    v_and_b32 v189, 0xffff0000, v56
    v_lshlrev_b32 v190, 16, v57
    v_and_b32 v191, 0xffff0000, v57
    v_lshlrev_b32 v192, 16, v58
    v_and_b32 v193, 0xffff0000, v58
    v_lshlrev_b32 v194, 16, v59
    v_and_b32 v195, 0xffff0000, v59
    v_pk_mul_f32 v[196:197], v[196:197], v[164:165]
    v_pk_mul_f32 v[198:199], v[198:199], v[166:167]
    v_pk_mul_f32 v[200:201], v[200:201], v[168:169]
    v_pk_mul_f32 v[202:203], v[202:203], v[170:171]
    v_pk_mul_f32 v[204:205], v[204:205], v[172:173]
    v_pk_mul_f32 v[206:207], v[206:207], v[174:175]
    v_pk_mul_f32 v[208:209], v[208:209], v[176:177]
    v_pk_mul_f32 v[210:211], v[210:211], v[178:179]
    v_pk_mul_f32 v[212:213], v[212:213], v[180:181]
    v_pk_mul_f32 v[214:215], v[214:215], v[182:183]
    v_pk_mul_f32 v[216:217], v[216:217], v[184:185]
    v_pk_mul_f32 v[218:219], v[218:219], v[186:187]
    v_pk_mul_f32 v[220:221], v[220:221], v[188:189]
    v_pk_mul_f32 v[222:223], v[222:223], v[190:191]
    v_pk_mul_f32 v[224:225], v[224:225], v[192:193]
    v_pk_mul_f32 v[226:227], v[226:227], v[194:195]
    v_cvt_pk_bf16_f32 v16, v220, v212
    v_cvt_pk_bf16_f32 v17, v204, v196
    v_cvt_pk_bf16_f32 v18, v221, v213
    v_cvt_pk_bf16_f32 v19, v205, v197
    v_cvt_pk_bf16_f32 v20, v222, v214
    v_cvt_pk_bf16_f32 v21, v206, v198
    v_cvt_pk_bf16_f32 v22, v223, v215
    v_cvt_pk_bf16_f32 v23, v207, v199
    v_cvt_pk_bf16_f32 v24, v224, v216
    v_cvt_pk_bf16_f32 v25, v208, v200
    v_cvt_pk_bf16_f32 v26, v225, v217
    v_cvt_pk_bf16_f32 v27, v209, v201
    v_cvt_pk_bf16_f32 v28, v226, v218
    v_cvt_pk_bf16_f32 v29, v210, v202
    v_cvt_pk_bf16_f32 v30, v227, v219
    v_cvt_pk_bf16_f32 v31, v211, v203
    s_mov_b32 s30, 0
    buffer_store_dwordx2 v[16:17], v14, s[24:27], s30 offen sc1
    s_mov_b32 s30, 4096
    buffer_store_dwordx2 v[18:19], v14, s[24:27], s30 offen sc1
    s_mov_b32 s30, 8192
    buffer_store_dwordx2 v[20:21], v14, s[24:27], s30 offen sc1
    s_mov_b32 s30, 12288
    buffer_store_dwordx2 v[22:23], v14, s[24:27], s30 offen sc1
    s_mov_b32 s30, 16384
    buffer_store_dwordx2 v[24:25], v14, s[24:27], s30 offen sc1
    s_mov_b32 s30, 20480
    buffer_store_dwordx2 v[26:27], v14, s[24:27], s30 offen sc1
    s_mov_b32 s30, 24576
    buffer_store_dwordx2 v[28:29], v14, s[24:27], s30 offen sc1
    s_mov_b32 s30, 28672
    buffer_store_dwordx2 v[30:31], v14, s[24:27], s30 offen sc1
    s_cmp_lg_u32 s3, 0
    s_cbranch_scc1 gn_4
    s_mov_b32 s56, s84
    s_mov_b32 s57, s85
    s_mov_b32 s58, 0x100
    s_mov_b32 s59, 0x20000
    v_mov_b32 v250, 0
    s_mov_b32 s60, 0
gp_5:
    buffer_load_dword v251, v250, s[56:59], 0 offen sc1
    s_add_u32 s60, s60, 1
    s_cmp_gt_u32 s60, 30000
    s_cbranch_scc1 gd_6
    s_waitcnt vmcnt(0)
    v_readfirstlane_b32 s86, v251
    s_nop 3
    s_cmp_eq_u32 s86, 0
    s_cbranch_scc1 gp_5
gd_6:
gn_4:
    s_branch L_p0_join
L_fill:
    s_sub_u32 s14, s3, 4
    s_lshl_b32 s15, s4, 6
    s_lshl_b32 s16, s5, 2
    s_add_u32 s15, s15, s16
    s_add_u32 s15, s15, s14
    s_lshl_b32 s16, s15, 12
    s_mul_i32 s17, s14, 37888
    v_and_b32 v2, 63, v0
    s_add_u32 s20, s74, s16
    s_addc_u32 s21, s75, 0
    s_mov_b32 s22, 4096
    s_mov_b32 s23, 0x20000
    v_lshlrev_b32 v3, 4, v2
    v_add_u32 v4, 0xffffffe0, v3
    buffer_load_dwordx4 v[160:163], v4, s[20:23], 0 offen
    v_add_u32 v4, 0xfffffff0, v3
    buffer_load_dwordx4 v[164:167], v4, s[20:23], 0 offen
    v_add_u32 v4, 0x3e0, v3
    buffer_load_dwordx4 v[168:171], v4, s[20:23], 0 offen
    v_add_u32 v4, 0x3f0, v3
    buffer_load_dwordx4 v[172:175], v4, s[20:23], 0 offen
    v_add_u32 v4, 0x7e0, v3
    buffer_load_dwordx4 v[176:179], v4, s[20:23], 0 offen
    v_add_u32 v4, 0x7f0, v3
    buffer_load_dwordx4 v[180:183], v4, s[20:23], 0 offen
    v_add_u32 v4, 0xbe0, v3
    buffer_load_dwordx4 v[184:187], v4, s[20:23], 0 offen
    v_add_u32 v4, 0xbf0, v3
    buffer_load_dwordx4 v[188:191], v4, s[20:23], 0 offen
    v_add_u32 v4, 0xfe0, v3
    buffer_load_dwordx4 v[192:195], v4, s[20:23], 0 offen
    v_add_u32 v4, 0xff0, v3
    buffer_load_dwordx4 v[196:199], v4, s[20:23], 0 offen
    s_add_u32 s32, s17, 33280
    v_mov_b32 v8, 0
    v_mov_b32 v9, 0
    v_mov_b32 v10, 0
    v_mov_b32 v11, 0
    v_add_u32 v5, s32, v3
    v_cmp_gt_u32 vcc, 32, v2
    s_and_saveexec_b64 s[34:35], vcc
    ds_write_b128 v5, v[8:11] offset:4096
    s_mov_b64 exec, s[34:35]
    v_add_u32 v6, s17, v3
    s_waitcnt vmcnt(8)
    v_mov_b32 v16, v161
    v_mov_b32 v17, v162
    v_mov_b32 v18, v163
    v_mov_b32 v19, v164
    v_mov_b32 v20, v165
    v_mov_b32 v21, v166
    v_alignbit_b32 v22, v161, v160, 16
    v_alignbit_b32 v23, v162, v161, 16
    v_alignbit_b32 v24, v163, v162, 16
    v_alignbit_b32 v25, v164, v163, 16
    v_alignbit_b32 v26, v165, v164, 16
    v_alignbit_b32 v27, v166, v165, 16
    v_alignbit_b32 v28, v162, v161, 16
    v_alignbit_b32 v29, v163, v162, 16
    v_alignbit_b32 v30, v164, v163, 16
    v_alignbit_b32 v31, v165, v164, 16
    v_alignbit_b32 v32, v166, v165, 16
    v_alignbit_b32 v33, v167, v166, 16
    ds_write_b128 v6, v[160:163] offset:0
    ds_write_b128 v6, v[22:25] offset:4160
    ds_write_b128 v6, v[16:19] offset:8304
    ds_write_b128 v6, v[28:31] offset:12448
    ds_write_b128 v6, v[162:165] offset:16592
    ds_write_b128 v6, v[24:27] offset:20736
    ds_write_b128 v6, v[18:21] offset:24896
    ds_write_b128 v6, v[30:33] offset:29040
    s_nop 0
    s_waitcnt vmcnt(6)
    v_mov_b32 v16, v169
    v_mov_b32 v17, v170
    v_mov_b32 v18, v171
    v_mov_b32 v19, v172
    v_mov_b32 v20, v173
    v_mov_b32 v21, v174
    v_alignbit_b32 v22, v169, v168, 16
    v_alignbit_b32 v23, v170, v169, 16
    v_alignbit_b32 v24, v171, v170, 16
    v_alignbit_b32 v25, v172, v171, 16
    v_alignbit_b32 v26, v173, v172, 16
    v_alignbit_b32 v27, v174, v173, 16
    v_alignbit_b32 v28, v170, v169, 16
    v_alignbit_b32 v29, v171, v170, 16
    v_alignbit_b32 v30, v172, v171, 16
    v_alignbit_b32 v31, v173, v172, 16
    v_alignbit_b32 v32, v174, v173, 16
    v_alignbit_b32 v33, v175, v174, 16
    ds_write_b128 v6, v[168:171] offset:1024
    ds_write_b128 v6, v[22:25] offset:5184
    ds_write_b128 v6, v[16:19] offset:9328
    ds_write_b128 v6, v[28:31] offset:13472
    ds_write_b128 v6, v[170:173] offset:17616
    ds_write_b128 v6, v[24:27] offset:21760
    ds_write_b128 v6, v[18:21] offset:25920
    ds_write_b128 v6, v[30:33] offset:30064
    s_nop 0
    s_waitcnt vmcnt(4)
    v_mov_b32 v16, v177
    v_mov_b32 v17, v178
    v_mov_b32 v18, v179
    v_mov_b32 v19, v180
    v_mov_b32 v20, v181
    v_mov_b32 v21, v182
    v_alignbit_b32 v22, v177, v176, 16
    v_alignbit_b32 v23, v178, v177, 16
    v_alignbit_b32 v24, v179, v178, 16
    v_alignbit_b32 v25, v180, v179, 16
    v_alignbit_b32 v26, v181, v180, 16
    v_alignbit_b32 v27, v182, v181, 16
    v_alignbit_b32 v28, v178, v177, 16
    v_alignbit_b32 v29, v179, v178, 16
    v_alignbit_b32 v30, v180, v179, 16
    v_alignbit_b32 v31, v181, v180, 16
    v_alignbit_b32 v32, v182, v181, 16
    v_alignbit_b32 v33, v183, v182, 16
    ds_write_b128 v6, v[176:179] offset:2048
    ds_write_b128 v6, v[22:25] offset:6208
    ds_write_b128 v6, v[16:19] offset:10352
    ds_write_b128 v6, v[28:31] offset:14496
    ds_write_b128 v6, v[178:181] offset:18640
    ds_write_b128 v6, v[24:27] offset:22784
    ds_write_b128 v6, v[18:21] offset:26944
    ds_write_b128 v6, v[30:33] offset:31088
    s_nop 0
    s_waitcnt vmcnt(2)
    v_mov_b32 v16, v185
    v_mov_b32 v17, v186
    v_mov_b32 v18, v187
    v_mov_b32 v19, v188
    v_mov_b32 v20, v189
    v_mov_b32 v21, v190
    v_alignbit_b32 v22, v185, v184, 16
    v_alignbit_b32 v23, v186, v185, 16
    v_alignbit_b32 v24, v187, v186, 16
    v_alignbit_b32 v25, v188, v187, 16
    v_alignbit_b32 v26, v189, v188, 16
    v_alignbit_b32 v27, v190, v189, 16
    v_alignbit_b32 v28, v186, v185, 16
    v_alignbit_b32 v29, v187, v186, 16
    v_alignbit_b32 v30, v188, v187, 16
    v_alignbit_b32 v31, v189, v188, 16
    v_alignbit_b32 v32, v190, v189, 16
    v_alignbit_b32 v33, v191, v190, 16
    ds_write_b128 v6, v[184:187] offset:3072
    ds_write_b128 v6, v[22:25] offset:7232
    ds_write_b128 v6, v[16:19] offset:11376
    ds_write_b128 v6, v[28:31] offset:15520
    ds_write_b128 v6, v[186:189] offset:19664
    ds_write_b128 v6, v[24:27] offset:23808
    ds_write_b128 v6, v[18:21] offset:27968
    ds_write_b128 v6, v[30:33] offset:32112
    s_nop 0
    s_waitcnt vmcnt(0)
    v_cmp_gt_u32 vcc, 2, v2
    s_and_saveexec_b64 s[34:35], vcc
    v_mov_b32 v16, v193
    v_mov_b32 v17, v194
    v_mov_b32 v18, v195
    v_mov_b32 v19, v196
    v_mov_b32 v20, v197
    v_mov_b32 v21, v198
    v_alignbit_b32 v22, v193, v192, 16
    v_alignbit_b32 v23, v194, v193, 16
    v_alignbit_b32 v24, v195, v194, 16
    v_alignbit_b32 v25, v196, v195, 16
    v_alignbit_b32 v26, v197, v196, 16
    v_alignbit_b32 v27, v198, v197, 16
    v_alignbit_b32 v28, v194, v193, 16
    v_alignbit_b32 v29, v195, v194, 16
    v_alignbit_b32 v30, v196, v195, 16
    v_alignbit_b32 v31, v197, v196, 16
    v_alignbit_b32 v32, v198, v197, 16
    v_alignbit_b32 v33, v199, v198, 16
    ds_write_b128 v6, v[192:195] offset:4096
    ds_write_b128 v6, v[22:25] offset:8256
    ds_write_b128 v6, v[16:19] offset:12400
    ds_write_b128 v6, v[28:31] offset:16544
    ds_write_b128 v6, v[194:197] offset:20688
    ds_write_b128 v6, v[24:27] offset:24832
    ds_write_b128 v6, v[18:21] offset:28992
    ds_write_b128 v6, v[30:33] offset:33136
    s_mov_b64 exec, s[34:35]
L_p0_join:
    s_waitcnt vmcnt(0) lgkmcnt(0)
    s_barrier
    s_lshl_b32 s6, s4, 10
    s_add_u32 s6, s6, 1048576
    s_lshl_b32 s7, s5, 6
    s_add_u32 s7, s7, s6
    s_cmp_lg_u32 s3, 0
    s_cbranch_scc1 arr_7
    v_mov_b32 v250, s7
    v_mov_b32 v251, s86
    s_mov_b64 exec, 1
    buffer_store_dword v251, v250, s[88:91], 0 offen sc1
    s_mov_b64 exec, -1
arr_7:
    s_cmp_lg_u32 s3, 0
    s_cbranch_scc1 wt_8
    v_and_b32 v250, 63, v0
    v_lshlrev_b32 v250, 6, v250
    v_add_u32 v250, s6, v250
    s_mov_b64 exec, 0xffff
    s_mov_b32 s57, 0
wp_9:
    s_mov_b32 s58, 0
    buffer_load_dword v240, v250, s[88:91], s58 offen sc1
    s_add_u32 s57, s57, 1
    s_cmp_gt_u32 s57, 30000
    s_cbranch_scc1 wd_10
    s_waitcnt vmcnt(0)
    v_xor_b32 v240, s86, v240
    v_cmp_eq_u32 vcc, 0, v240
    s_nop 1
    s_cmp_eq_u64 vcc, exec
    s_cbranch_scc0 wp_9
wd_10:
    s_mov_b64 exec, -1
wt_8:
    s_barrier
    s_cmp_ge_u32 s3, 4
    s_cbranch_scc1 L_colsum
    s_mov_b32 s14, s3
    s_lshl_b32 s15, s4, 6
    s_lshl_b32 s16, s5, 2
    s_add_u32 s15, s15, s16
    s_add_u32 s15, s15, s14
    s_lshl_b32 s16, s15, 12
    s_mul_i32 s17, s14, 37888
    v_and_b32 v2, 63, v0
    v_lshlrev_b32 v3, 4, v2
    s_mov_b32 s24, s64
    s_mov_b32 s25, s65
    s_add_u32 s24, s24, s16
    s_addc_u32 s25, s25, 0
    s_mov_b32 s26, 4096
    s_mov_b32 s27, 0x20000
    s_add_u32 s32, s17, 33280
    s_mov_b32 m0, s32
    s_nop 0
    buffer_load_dwordx4 v3, s[24:27], 0 offen offset:0 sc1 lds
    buffer_load_dwordx4 v3, s[24:27], 0 offen offset:1024 sc1 lds
    buffer_load_dwordx4 v3, s[24:27], 0 offen offset:2048 sc1 lds
    buffer_load_dwordx4 v3, s[24:27], 0 offen offset:3072 sc1 lds
    s_add_u32 s28, s64, 0x400000
    s_addc_u32 s29, s65, 0
    s_mov_b32 s30, 0x400000
    s_mov_b32 s31, 0x20000
    s_lshl_b32 s18, s15, 1
    s_and_b32 s18, s18, 0xfffffffc
    s_load_dword s19, s[76:77], s18
    v_and_b32 v12, 15, v2
    v_lshrrev_b32 v13, 4, v2
    v_add_u32 v14, 1, v12
    v_and_b32 v15, 7, v14
    v_lshrrev_b32 v14, 3, v14
    v_add_u32 v14, v14, v13
    v_mul_u32_u24 v7, 259, v15
    v_add_u32 v7, v7, v14
    v_cmp_le_u32 vcc, 1, v15
    s_nop 1
    v_addc_co_u32 v7, vcc, 0, v7, vcc
    v_cmp_le_u32 vcc, 6, v15
    s_nop 1
    v_addc_co_u32 v7, vcc, 0, v7, vcc
    v_lshlrev_b32 v7, 4, v7
    v_add_u32 v7, s17, v7
    v_lshlrev_b32 v8, 5, v12
    v_lshlrev_b32 v9, 4, v13
    v_sub_u32 v8, v9, v8
    v_add_u32 v8, 480, v8
    v_add_u32 v8, s32, v8
    v_lshlrev_b32 v9, 5, v12
    v_lshlrev_b32 v10, 3, v13
    v_add_u32 v9, v9, v10
    v_sub_u32 v9, 504, v9
    v_add_u32 v9, s32, v9
    v_lshlrev_b32 v10, 5, v12
    v_lshl_add_u32 v10, v13, 3, v10
    v_add_u32 v10, s17, v10
    v_mov_b32 v16, 0
    v_mov_b32 v17, 0
    v_mov_b32 v18, 0
    v_mov_b32 v19, 0
    v_mov_b32 v20, 0
    v_mov_b32 v21, 0
    v_mov_b32 v22, 0
    v_mov_b32 v23, 0
    v_mov_b32 v24, 0
    v_mov_b32 v25, 0
    v_mov_b32 v26, 0
    v_mov_b32 v27, 0
    v_mov_b32 v28, 0
    v_mov_b32 v29, 0
    v_mov_b32 v30, 0
    v_mov_b32 v31, 0
    v_mov_b32 v32, 0
    v_mov_b32 v33, 0
    v_mov_b32 v34, 0
    v_mov_b32 v35, 0
    v_mov_b32 v36, 0
    v_mov_b32 v37, 0
    v_mov_b32 v38, 0
    v_mov_b32 v39, 0
    v_mov_b32 v40, 0
    v_mov_b32 v41, 0
    v_mov_b32 v42, 0
    v_mov_b32 v43, 0
    v_mov_b32 v44, 0
    v_mov_b32 v45, 0
    v_mov_b32 v46, 0
    v_mov_b32 v47, 0
    s_waitcnt vmcnt(0) lgkmcnt(0)
    ds_read_b128 v[48:51], v7 offset:0
    ds_read_b128 v[80:83], v8 offset:3584
    ds_read_b128 v[52:55], v7 offset:512
    ds_read_b128 v[84:87], v8 offset:3072
    ds_read_b128 v[56:59], v7 offset:1024
    ds_read_b128 v[88:91], v8 offset:2560
    ds_read_b128 v[60:63], v7 offset:1536
    ds_read_b128 v[92:95], v8 offset:2048
    ds_read_b128 v[64:67], v7 offset:2048
    ds_read_b128 v[96:99], v8 offset:1536
    ds_read_b128 v[68:71], v7 offset:2560
    ds_read_b128 v[100:103], v8 offset:1024
    ds_read_b128 v[72:75], v7 offset:3072
    ds_read_b128 v[104:107], v8 offset:512
    ds_read_b128 v[76:79], v7 offset:3584
    ds_read_b128 v[108:111], v8 offset:0
    s_mov_b32 s40, 0
L_convloop:
    s_waitcnt lgkmcnt(0)
    v_mfma_f32_16x16x32_bf16 v[16:19], v[48:51], v[80:83], v[16:19]
    ds_read_b128 v[112:115], v7 offset:64
    v_mfma_f32_16x16x32_bf16 v[20:23], v[48:51], v[84:87], v[20:23]
    ds_read_b128 v[144:147], v8 offset:3648
    v_mfma_f32_16x16x32_bf16 v[20:23], v[52:55], v[80:83], v[20:23]
    ds_read_b128 v[116:119], v7 offset:576
    v_mfma_f32_16x16x32_bf16 v[24:27], v[52:55], v[84:87], v[24:27]
    ds_read_b128 v[148:151], v8 offset:3136
    v_mfma_f32_16x16x32_bf16 v[24:27], v[48:51], v[88:91], v[24:27]
    ds_read_b128 v[120:123], v7 offset:1088
    v_mfma_f32_16x16x32_bf16 v[28:31], v[52:55], v[88:91], v[28:31]
    ds_read_b128 v[152:155], v8 offset:2624
    v_mfma_f32_16x16x32_bf16 v[24:27], v[56:59], v[80:83], v[24:27]
    ds_read_b128 v[124:127], v7 offset:1600
    v_mfma_f32_16x16x32_bf16 v[28:31], v[56:59], v[84:87], v[28:31]
    ds_read_b128 v[156:159], v8 offset:2112
    v_mfma_f32_16x16x32_bf16 v[32:35], v[56:59], v[88:91], v[32:35]
    ds_read_b128 v[128:131], v7 offset:2112
    v_mfma_f32_16x16x32_bf16 v[28:31], v[48:51], v[92:95], v[28:31]
    ds_read_b128 v[160:163], v8 offset:1600
    v_mfma_f32_16x16x32_bf16 v[32:35], v[52:55], v[92:95], v[32:35]
    ds_read_b128 v[132:135], v7 offset:2624
    v_mfma_f32_16x16x32_bf16 v[36:39], v[56:59], v[92:95], v[36:39]
    ds_read_b128 v[164:167], v8 offset:1088
    v_mfma_f32_16x16x32_bf16 v[28:31], v[60:63], v[80:83], v[28:31]
    ds_read_b128 v[136:139], v7 offset:3136
    v_mfma_f32_16x16x32_bf16 v[32:35], v[60:63], v[84:87], v[32:35]
    ds_read_b128 v[168:171], v8 offset:576
    v_mfma_f32_16x16x32_bf16 v[36:39], v[60:63], v[88:91], v[36:39]
    ds_read_b128 v[140:143], v7 offset:3648
    v_mfma_f32_16x16x32_bf16 v[40:43], v[60:63], v[92:95], v[40:43]
    ds_read_b128 v[172:175], v8 offset:64
    v_mfma_f32_16x16x32_bf16 v[32:35], v[48:51], v[96:99], v[32:35]
    v_mfma_f32_16x16x32_bf16 v[36:39], v[52:55], v[96:99], v[36:39]
    v_mfma_f32_16x16x32_bf16 v[40:43], v[56:59], v[96:99], v[40:43]
    v_mfma_f32_16x16x32_bf16 v[44:47], v[60:63], v[96:99], v[44:47]
    v_mfma_f32_16x16x32_bf16 v[32:35], v[64:67], v[80:83], v[32:35]
    v_mfma_f32_16x16x32_bf16 v[36:39], v[64:67], v[84:87], v[36:39]
    v_mfma_f32_16x16x32_bf16 v[40:43], v[64:67], v[88:91], v[40:43]
    v_mfma_f32_16x16x32_bf16 v[44:47], v[64:67], v[92:95], v[44:47]
    v_mfma_f32_16x16x32_bf16 v[36:39], v[48:51], v[100:103], v[36:39]
    v_mfma_f32_16x16x32_bf16 v[40:43], v[52:55], v[100:103], v[40:43]
    v_mfma_f32_16x16x32_bf16 v[44:47], v[56:59], v[100:103], v[44:47]
    v_mfma_f32_16x16x32_bf16 v[36:39], v[68:71], v[80:83], v[36:39]
    v_mfma_f32_16x16x32_bf16 v[40:43], v[68:71], v[84:87], v[40:43]
    v_mfma_f32_16x16x32_bf16 v[44:47], v[68:71], v[88:91], v[44:47]
    v_mfma_f32_16x16x32_bf16 v[40:43], v[48:51], v[104:107], v[40:43]
    v_mfma_f32_16x16x32_bf16 v[44:47], v[52:55], v[104:107], v[44:47]
    v_mfma_f32_16x16x32_bf16 v[40:43], v[72:75], v[80:83], v[40:43]
    v_mfma_f32_16x16x32_bf16 v[44:47], v[72:75], v[84:87], v[44:47]
    v_mfma_f32_16x16x32_bf16 v[44:47], v[48:51], v[108:111], v[44:47]
    v_mfma_f32_16x16x32_bf16 v[44:47], v[76:79], v[80:83], v[44:47]
    s_waitcnt lgkmcnt(0)
    v_mfma_f32_16x16x32_bf16 v[16:19], v[112:115], v[144:147], v[16:19]
    ds_read_b128 v[48:51], v7 offset:128
    v_mfma_f32_16x16x32_bf16 v[20:23], v[112:115], v[148:151], v[20:23]
    ds_read_b128 v[80:83], v8 offset:3712
    v_mfma_f32_16x16x32_bf16 v[20:23], v[116:119], v[144:147], v[20:23]
    ds_read_b128 v[52:55], v7 offset:640
    v_mfma_f32_16x16x32_bf16 v[24:27], v[116:119], v[148:151], v[24:27]
    ds_read_b128 v[84:87], v8 offset:3200
    v_mfma_f32_16x16x32_bf16 v[24:27], v[112:115], v[152:155], v[24:27]
    ds_read_b128 v[56:59], v7 offset:1152
    v_mfma_f32_16x16x32_bf16 v[28:31], v[116:119], v[152:155], v[28:31]
    ds_read_b128 v[88:91], v8 offset:2688
    v_mfma_f32_16x16x32_bf16 v[24:27], v[120:123], v[144:147], v[24:27]
    ds_read_b128 v[60:63], v7 offset:1664
    v_mfma_f32_16x16x32_bf16 v[28:31], v[120:123], v[148:151], v[28:31]
    ds_read_b128 v[92:95], v8 offset:2176
    v_mfma_f32_16x16x32_bf16 v[32:35], v[120:123], v[152:155], v[32:35]
    ds_read_b128 v[64:67], v7 offset:2176
    v_mfma_f32_16x16x32_bf16 v[28:31], v[112:115], v[156:159], v[28:31]
    ds_read_b128 v[96:99], v8 offset:1664
    v_mfma_f32_16x16x32_bf16 v[32:35], v[116:119], v[156:159], v[32:35]
    ds_read_b128 v[68:71], v7 offset:2688
    v_mfma_f32_16x16x32_bf16 v[36:39], v[120:123], v[156:159], v[36:39]
    ds_read_b128 v[100:103], v8 offset:1152
    v_mfma_f32_16x16x32_bf16 v[28:31], v[124:127], v[144:147], v[28:31]
    ds_read_b128 v[72:75], v7 offset:3200
    v_mfma_f32_16x16x32_bf16 v[32:35], v[124:127], v[148:151], v[32:35]
    ds_read_b128 v[104:107], v8 offset:640
    v_mfma_f32_16x16x32_bf16 v[36:39], v[124:127], v[152:155], v[36:39]
    ds_read_b128 v[76:79], v7 offset:3712
    v_mfma_f32_16x16x32_bf16 v[40:43], v[124:127], v[156:159], v[40:43]
    ds_read_b128 v[108:111], v8 offset:128
    v_mfma_f32_16x16x32_bf16 v[32:35], v[112:115], v[160:163], v[32:35]
    v_mfma_f32_16x16x32_bf16 v[36:39], v[116:119], v[160:163], v[36:39]
    v_mfma_f32_16x16x32_bf16 v[40:43], v[120:123], v[160:163], v[40:43]
    v_mfma_f32_16x16x32_bf16 v[44:47], v[124:127], v[160:163], v[44:47]
    v_mfma_f32_16x16x32_bf16 v[32:35], v[128:131], v[144:147], v[32:35]
    s_add_u32 s40, s40, 1
    v_mfma_f32_16x16x32_bf16 v[36:39], v[128:131], v[148:151], v[36:39]
    v_mfma_f32_16x16x32_bf16 v[40:43], v[128:131], v[152:155], v[40:43]
    v_mfma_f32_16x16x32_bf16 v[44:47], v[128:131], v[156:159], v[44:47]
    v_mfma_f32_16x16x32_bf16 v[36:39], v[112:115], v[164:167], v[36:39]
    v_mfma_f32_16x16x32_bf16 v[40:43], v[116:119], v[164:167], v[40:43]
    v_mfma_f32_16x16x32_bf16 v[44:47], v[120:123], v[164:167], v[44:47]
    v_mfma_f32_16x16x32_bf16 v[36:39], v[132:135], v[144:147], v[36:39]
    v_mfma_f32_16x16x32_bf16 v[40:43], v[132:135], v[148:151], v[40:43]
    v_mfma_f32_16x16x32_bf16 v[44:47], v[132:135], v[152:155], v[44:47]
    v_mfma_f32_16x16x32_bf16 v[40:43], v[112:115], v[168:171], v[40:43]
    v_mfma_f32_16x16x32_bf16 v[44:47], v[116:119], v[168:171], v[44:47]
    v_mfma_f32_16x16x32_bf16 v[40:43], v[136:139], v[144:147], v[40:43]
    v_mfma_f32_16x16x32_bf16 v[44:47], v[136:139], v[148:151], v[44:47]
    v_mfma_f32_16x16x32_bf16 v[44:47], v[112:115], v[172:175], v[44:47]
    v_mfma_f32_16x16x32_bf16 v[44:47], v[140:143], v[144:147], v[44:47]
    v_add_u32 v7, 128, v7
    v_add_u32 v8, 128, v8
    s_cmp_lt_u32 s40, 4
    s_cbranch_scc1 L_convloop
    s_waitcnt lgkmcnt(0)
    ds_read_b64 v[48:49], v9 offset:3584
    ds_read_b64 v[50:51], v9 offset:3072
    ds_read_b64 v[52:53], v9 offset:2560
    ds_read_b64 v[54:55], v9 offset:2048
    ds_read_b64 v[56:57], v9 offset:1536
    ds_read_b64 v[58:59], v9 offset:1024
    ds_read_b64 v[60:61], v9 offset:512
    ds_read_b64 v[62:63], v9 offset:0
    s_waitcnt lgkmcnt(0)
    s_and_b32 s36, s15, 1
    s_lshl_b32 s36, s36, 4
    s_lshr_b32 s19, s19, s36
    s_lshl_b32 s19, s19, 16
    s_nop 7
    v_lshlrev_b32 v67, 16, v48
    v_and_b32 v66, 0xffff0000, v48
    v_lshlrev_b32 v65, 16, v49
    v_and_b32 v64, 0xffff0000, v49
    v_fma_f32 v16, v64, s19, v16
    v_fma_f32 v17, v65, s19, v17
    v_fma_f32 v18, v66, s19, v18
    v_fma_f32 v19, v67, s19, v19
    v_cvt_pk_bf16_f32 v72, v16, v17
    v_cvt_pk_bf16_f32 v73, v18, v19
    ds_write_b64 v10, v[72:73] offset:0
    v_lshlrev_b32 v67, 16, v50
    v_and_b32 v66, 0xffff0000, v50
    v_lshlrev_b32 v65, 16, v51
    v_and_b32 v64, 0xffff0000, v51
    v_fma_f32 v20, v64, s19, v20
    v_fma_f32 v21, v65, s19, v21
    v_fma_f32 v22, v66, s19, v22
    v_fma_f32 v23, v67, s19, v23
    v_cvt_pk_bf16_f32 v74, v20, v21
    v_cvt_pk_bf16_f32 v75, v22, v23
    ds_write_b64 v10, v[74:75] offset:512
    v_lshlrev_b32 v67, 16, v52
    v_and_b32 v66, 0xffff0000, v52
    v_lshlrev_b32 v65, 16, v53
    v_and_b32 v64, 0xffff0000, v53
    v_fma_f32 v24, v64, s19, v24
    v_fma_f32 v25, v65, s19, v25
    v_fma_f32 v26, v66, s19, v26
    v_fma_f32 v27, v67, s19, v27
    v_cvt_pk_bf16_f32 v76, v24, v25
    v_cvt_pk_bf16_f32 v77, v26, v27
    ds_write_b64 v10, v[76:77] offset:1024
    v_lshlrev_b32 v67, 16, v54
    v_and_b32 v66, 0xffff0000, v54
    v_lshlrev_b32 v65, 16, v55
    v_and_b32 v64, 0xffff0000, v55
    v_fma_f32 v28, v64, s19, v28
    v_fma_f32 v29, v65, s19, v29
    v_fma_f32 v30, v66, s19, v30
    v_fma_f32 v31, v67, s19, v31
    v_cvt_pk_bf16_f32 v78, v28, v29
    v_cvt_pk_bf16_f32 v79, v30, v31
    ds_write_b64 v10, v[78:79] offset:1536
    v_lshlrev_b32 v67, 16, v56
    v_and_b32 v66, 0xffff0000, v56
    v_lshlrev_b32 v65, 16, v57
    v_and_b32 v64, 0xffff0000, v57
    v_fma_f32 v32, v64, s19, v32
    v_fma_f32 v33, v65, s19, v33
    v_fma_f32 v34, v66, s19, v34
    v_fma_f32 v35, v67, s19, v35
    v_cvt_pk_bf16_f32 v80, v32, v33
    v_cvt_pk_bf16_f32 v81, v34, v35
    ds_write_b64 v10, v[80:81] offset:2048
    v_lshlrev_b32 v67, 16, v58
    v_and_b32 v66, 0xffff0000, v58
    v_lshlrev_b32 v65, 16, v59
    v_and_b32 v64, 0xffff0000, v59
    v_fma_f32 v36, v64, s19, v36
    v_fma_f32 v37, v65, s19, v37
    v_fma_f32 v38, v66, s19, v38
    v_fma_f32 v39, v67, s19, v39
    v_cvt_pk_bf16_f32 v82, v36, v37
    v_cvt_pk_bf16_f32 v83, v38, v39
    ds_write_b64 v10, v[82:83] offset:2560
    v_lshlrev_b32 v67, 16, v60
    v_and_b32 v66, 0xffff0000, v60
    v_lshlrev_b32 v65, 16, v61
    v_and_b32 v64, 0xffff0000, v61
    v_fma_f32 v40, v64, s19, v40
    v_fma_f32 v41, v65, s19, v41
    v_fma_f32 v42, v66, s19, v42
    v_fma_f32 v43, v67, s19, v43
    v_cvt_pk_bf16_f32 v84, v40, v41
    v_cvt_pk_bf16_f32 v85, v42, v43
    ds_write_b64 v10, v[84:85] offset:3072
    v_lshlrev_b32 v67, 16, v62
    v_and_b32 v66, 0xffff0000, v62
    v_lshlrev_b32 v65, 16, v63
    v_and_b32 v64, 0xffff0000, v63
    v_fma_f32 v44, v64, s19, v44
    v_fma_f32 v45, v65, s19, v45
    v_fma_f32 v46, v66, s19, v46
    v_fma_f32 v47, v67, s19, v47
    v_cvt_pk_bf16_f32 v86, v44, v45
    v_cvt_pk_bf16_f32 v87, v46, v47
    ds_write_b64 v10, v[86:87] offset:3584
    s_branch L_conv_skip
L_colsum:
    s_sub_u32 s40, s3, 4
    v_and_b32 v1, 63, v0
    s_cmp_ge_u32 s2, 192
    s_cbranch_scc1 L_wot
    s_mov_b32 s44, s78
    s_mov_b32 s45, s79
    s_mov_b32 s46, 0x600000
    s_mov_b32 s47, 0x20000
    s_add_u32 s48, s64, 0x1000000
    s_addc_u32 s49, s65, 0
    s_mov_b32 s50, 0x600000
    s_mov_b32 s51, 0x20000
    v_lshrrev_b32 v2, 3, v1
    v_and_b32 v3, 7, v1
    v_mul_u32_u24 v4, 6144, v2
    v_lshl_add_u32 v4, v3, 4, v4
    s_and_b32 s41, s2, 3
    s_lshl_b32 s41, s41, 2
    s_add_u32 s41, s41, s40
    s_mul_i32 s42, s41, 393216
    s_lshr_b32 s43, s2, 2
    s_lshl_b32 s52, s43, 7
    s_add_u32 s42, s42, s52
    v_add_u32 v4, s42, v4
    s_mov_b32 s52, 0
    buffer_load_dwordx4 v[48:51], v4, s[44:47], s52 offen
    s_mov_b32 s52, 49152
    buffer_load_dwordx4 v[52:55], v4, s[44:47], s52 offen
    s_mov_b32 s52, 98304
    buffer_load_dwordx4 v[56:59], v4, s[44:47], s52 offen
    s_mov_b32 s52, 147456
    buffer_load_dwordx4 v[60:63], v4, s[44:47], s52 offen
    s_mov_b32 s52, 196608
    buffer_load_dwordx4 v[64:67], v4, s[44:47], s52 offen
    s_mov_b32 s52, 245760
    buffer_load_dwordx4 v[68:71], v4, s[44:47], s52 offen
    s_mov_b32 s52, 294912
    buffer_load_dwordx4 v[72:75], v4, s[44:47], s52 offen
    s_mov_b32 s52, 344064
    buffer_load_dwordx4 v[76:79], v4, s[44:47], s52 offen
    s_and_b32 s52, s43, 15
    s_lshl_b32 s52, s52, 4
    s_add_u32 s52, s52, s41
    s_mul_i32 s52, s52, 3
    s_lshr_b32 s53, s43, 4
    s_add_u32 s52, s52, s53
    s_lshl_b32 s52, s52, 13
    v_lshrrev_b32 v5, 1, v3
    v_bfe_u32 v6, v2, 1, 1
    v_xor_b32 v5, v5, v6
    v_and_b32 v6, 1, v3
    v_lshlrev_b32 v7, 7, v2
    v_lshl_add_u32 v7, v6, 4, v7
    v_lshl_add_u32 v8, v5, 5, v7
    v_xor_b32 v5, 2, v5
    v_lshl_add_u32 v9, v5, 5, v7
    s_waitcnt vmcnt(0)
    s_add_u32 s53, s52, 0
    buffer_store_dwordx4 v[48:51], v8, s[48:51], s53 offen sc1
    s_add_u32 s53, s52, 1024
    buffer_store_dwordx4 v[52:55], v9, s[48:51], s53 offen sc1
    s_add_u32 s53, s52, 2048
    buffer_store_dwordx4 v[56:59], v8, s[48:51], s53 offen sc1
    s_add_u32 s53, s52, 3072
    buffer_store_dwordx4 v[60:63], v9, s[48:51], s53 offen sc1
    s_add_u32 s53, s52, 4096
    buffer_store_dwordx4 v[64:67], v8, s[48:51], s53 offen sc1
    s_add_u32 s53, s52, 5120
    buffer_store_dwordx4 v[68:71], v9, s[48:51], s53 offen sc1
    s_add_u32 s53, s52, 6144
    buffer_store_dwordx4 v[72:75], v8, s[48:51], s53 offen sc1
    s_add_u32 s53, s52, 7168
    buffer_store_dwordx4 v[76:79], v9, s[48:51], s53 offen sc1
    v_mov_b32 v16, 0
    v_mov_b32 v17, 0
    v_mov_b32 v18, 0
    v_mov_b32 v19, 0
    v_mov_b32 v20, 0
    v_mov_b32 v21, 0
    v_mov_b32 v22, 0
    v_mov_b32 v23, 0
    v_lshlrev_b32 v160, 16, v48
    v_and_b32 v161, 0xffff0000, v48
    v_lshlrev_b32 v162, 16, v49
    v_and_b32 v163, 0xffff0000, v49
    v_lshlrev_b32 v164, 16, v50
    v_and_b32 v165, 0xffff0000, v50
    v_lshlrev_b32 v166, 16, v51
    v_and_b32 v167, 0xffff0000, v51
    v_pk_add_f32 v[16:17], v[16:17], v[160:161]
    v_pk_add_f32 v[18:19], v[18:19], v[162:163]
    v_pk_add_f32 v[20:21], v[20:21], v[164:165]
    v_pk_add_f32 v[22:23], v[22:23], v[166:167]
    v_lshlrev_b32 v160, 16, v52
    v_and_b32 v161, 0xffff0000, v52
    v_lshlrev_b32 v162, 16, v53
    v_and_b32 v163, 0xffff0000, v53
    v_lshlrev_b32 v164, 16, v54
    v_and_b32 v165, 0xffff0000, v54
    v_lshlrev_b32 v166, 16, v55
    v_and_b32 v167, 0xffff0000, v55
    v_pk_add_f32 v[16:17], v[16:17], v[160:161]
    v_pk_add_f32 v[18:19], v[18:19], v[162:163]
    v_pk_add_f32 v[20:21], v[20:21], v[164:165]
    v_pk_add_f32 v[22:23], v[22:23], v[166:167]
    v_lshlrev_b32 v160, 16, v56
    v_and_b32 v161, 0xffff0000, v56
    v_lshlrev_b32 v162, 16, v57
    v_and_b32 v163, 0xffff0000, v57
    v_lshlrev_b32 v164, 16, v58
    v_and_b32 v165, 0xffff0000, v58
    v_lshlrev_b32 v166, 16, v59
    v_and_b32 v167, 0xffff0000, v59
    v_pk_add_f32 v[16:17], v[16:17], v[160:161]
    v_pk_add_f32 v[18:19], v[18:19], v[162:163]
    v_pk_add_f32 v[20:21], v[20:21], v[164:165]
    v_pk_add_f32 v[22:23], v[22:23], v[166:167]
    v_lshlrev_b32 v160, 16, v60
    v_and_b32 v161, 0xffff0000, v60
    v_lshlrev_b32 v162, 16, v61
    v_and_b32 v163, 0xffff0000, v61
    v_lshlrev_b32 v164, 16, v62
    v_and_b32 v165, 0xffff0000, v62
    v_lshlrev_b32 v166, 16, v63
    v_and_b32 v167, 0xffff0000, v63
    v_pk_add_f32 v[16:17], v[16:17], v[160:161]
    v_pk_add_f32 v[18:19], v[18:19], v[162:163]
    v_pk_add_f32 v[20:21], v[20:21], v[164:165]
    v_pk_add_f32 v[22:23], v[22:23], v[166:167]
    v_lshlrev_b32 v160, 16, v64
    v_and_b32 v161, 0xffff0000, v64
    v_lshlrev_b32 v162, 16, v65
    v_and_b32 v163, 0xffff0000, v65
    v_lshlrev_b32 v164, 16, v66
    v_and_b32 v165, 0xffff0000, v66
    v_lshlrev_b32 v166, 16, v67
    v_and_b32 v167, 0xffff0000, v67
    v_pk_add_f32 v[16:17], v[16:17], v[160:161]
    v_pk_add_f32 v[18:19], v[18:19], v[162:163]
    v_pk_add_f32 v[20:21], v[20:21], v[164:165]
    v_pk_add_f32 v[22:23], v[22:23], v[166:167]
    v_lshlrev_b32 v160, 16, v68
    v_and_b32 v161, 0xffff0000, v68
    v_lshlrev_b32 v162, 16, v69
    v_and_b32 v163, 0xffff0000, v69
    v_lshlrev_b32 v164, 16, v70
    v_and_b32 v165, 0xffff0000, v70
    v_lshlrev_b32 v166, 16, v71
    v_and_b32 v167, 0xffff0000, v71
    v_pk_add_f32 v[16:17], v[16:17], v[160:161]
    v_pk_add_f32 v[18:19], v[18:19], v[162:163]
    v_pk_add_f32 v[20:21], v[20:21], v[164:165]
    v_pk_add_f32 v[22:23], v[22:23], v[166:167]
    v_lshlrev_b32 v160, 16, v72
    v_and_b32 v161, 0xffff0000, v72
    v_lshlrev_b32 v162, 16, v73
    v_and_b32 v163, 0xffff0000, v73
    v_lshlrev_b32 v164, 16, v74
    v_and_b32 v165, 0xffff0000, v74
    v_lshlrev_b32 v166, 16, v75
    v_and_b32 v167, 0xffff0000, v75
    v_pk_add_f32 v[16:17], v[16:17], v[160:161]
    v_pk_add_f32 v[18:19], v[18:19], v[162:163]
    v_pk_add_f32 v[20:21], v[20:21], v[164:165]
    v_pk_add_f32 v[22:23], v[22:23], v[166:167]
    v_lshlrev_b32 v160, 16, v76
    v_and_b32 v161, 0xffff0000, v76
    v_lshlrev_b32 v162, 16, v77
    v_and_b32 v163, 0xffff0000, v77
    v_lshlrev_b32 v164, 16, v78
    v_and_b32 v165, 0xffff0000, v78
    v_lshlrev_b32 v166, 16, v79
    v_and_b32 v167, 0xffff0000, v79
    v_pk_add_f32 v[16:17], v[16:17], v[160:161]
    v_pk_add_f32 v[18:19], v[18:19], v[162:163]
    v_pk_add_f32 v[20:21], v[20:21], v[164:165]
    v_pk_add_f32 v[22:23], v[22:23], v[166:167]
    s_nop 1
    v_add_f32_dpp v16, v16, v16 row_ror:8 row_mask:0xf bank_mask:0xf
    v_add_f32_dpp v17, v17, v17 row_ror:8 row_mask:0xf bank_mask:0xf
    v_add_f32_dpp v18, v18, v18 row_ror:8 row_mask:0xf bank_mask:0xf
    v_add_f32_dpp v19, v19, v19 row_ror:8 row_mask:0xf bank_mask:0xf
    v_add_f32_dpp v20, v20, v20 row_ror:8 row_mask:0xf bank_mask:0xf
    v_add_f32_dpp v21, v21, v21 row_ror:8 row_mask:0xf bank_mask:0xf
    v_add_f32_dpp v22, v22, v22 row_ror:8 row_mask:0xf bank_mask:0xf
    v_add_f32_dpp v23, v23, v23 row_ror:8 row_mask:0xf bank_mask:0xf
    v_mov_b32 v160, v16
    v_mov_b32 v161, v17
    v_mov_b32 v162, v18
    v_mov_b32 v163, v19
    v_mov_b32 v164, v20
    v_mov_b32 v165, v21
    v_mov_b32 v166, v22
    v_mov_b32 v167, v23
    s_nop 1
    v_permlane16_swap_b32 v16, v160
    v_permlane16_swap_b32 v17, v161
    v_permlane16_swap_b32 v18, v162
    v_permlane16_swap_b32 v19, v163
    v_permlane16_swap_b32 v20, v164
    v_permlane16_swap_b32 v21, v165
    v_permlane16_swap_b32 v22, v166
    v_permlane16_swap_b32 v23, v167
    s_nop 1
    v_add_f32 v16, v16, v160
    v_mov_b32 v160, v16
    v_add_f32 v17, v17, v161
    v_mov_b32 v161, v17
    v_add_f32 v18, v18, v162
    v_mov_b32 v162, v18
    v_add_f32 v19, v19, v163
    v_mov_b32 v163, v19
    v_add_f32 v20, v20, v164
    v_mov_b32 v164, v20
    v_add_f32 v21, v21, v165
    v_mov_b32 v165, v21
    v_add_f32 v22, v22, v166
    v_mov_b32 v166, v22
    v_add_f32 v23, v23, v167
    v_mov_b32 v167, v23
    s_nop 1
    v_permlane32_swap_b32 v16, v160
    v_permlane32_swap_b32 v17, v161
    v_permlane32_swap_b32 v18, v162
    v_permlane32_swap_b32 v19, v163
    v_permlane32_swap_b32 v20, v164
    v_permlane32_swap_b32 v21, v165
    v_permlane32_swap_b32 v22, v166
    v_permlane32_swap_b32 v23, v167
    s_nop 1
    v_add_f32 v16, v16, v160
    v_add_f32 v17, v17, v161
    v_add_f32 v18, v18, v162
    v_add_f32 v19, v19, v163
    v_add_f32 v20, v20, v164
    v_add_f32 v21, v21, v165
    v_add_f32 v22, v22, v166
    v_add_f32 v23, v23, v167
    v_lshlrev_b32 v5, 5, v3
    s_lshl_b32 s42, s40, 8
    s_add_u32 s42, s42, 151552
    v_add_u32 v5, s42, v5
    s_mov_b64 exec, 0xff
    ds_write_b128 v5, v[16:19]
    ds_write_b128 v5, v[20:23] offset:16
    s_mov_b64 exec, -1
    s_branch L_conv_skip
L_wot:
    s_mov_b32 s44, s80
    s_mov_b32 s45, s81
    s_mov_b32 s46, 0x200000
    s_mov_b32 s47, 0x20000
    s_add_u32 s48, s64, 0x1800000
    s_addc_u32 s49, s65, 0
    s_mov_b32 s50, 0x200000
    s_mov_b32 s51, 0x20000
    s_sub_u32 s41, s2, 192
    s_lshl_b32 s41, s41, 2
    s_add_u32 s41, s41, s40
    v_lshrrev_b32 v2, 4, v1
    v_and_b32 v3, 15, v1
    v_lshlrev_b32 v4, 11, v2
    v_lshl_add_u32 v4, v3, 4, v4
    s_and_b32 s42, s41, 31
    s_lshl_b32 s42, s42, 16
    s_lshr_b32 s43, s41, 5
    s_lshl_b32 s52, s43, 8
    s_add_u32 s42, s42, s52
    v_add_u32 v4, s42, v4
    s_mov_b32 s52, 0
    buffer_load_dwordx4 v[48:51], v4, s[44:47], s52 offen
    s_mov_b32 s52, 8192
    buffer_load_dwordx4 v[52:55], v4, s[44:47], s52 offen
    s_mov_b32 s52, 16384
    buffer_load_dwordx4 v[56:59], v4, s[44:47], s52 offen
    s_mov_b32 s52, 24576
    buffer_load_dwordx4 v[60:63], v4, s[44:47], s52 offen
    s_mov_b32 s52, 32768
    buffer_load_dwordx4 v[64:67], v4, s[44:47], s52 offen
    s_mov_b32 s52, 40960
    buffer_load_dwordx4 v[68:71], v4, s[44:47], s52 offen
    s_mov_b32 s52, 49152
    buffer_load_dwordx4 v[72:75], v4, s[44:47], s52 offen
    s_mov_b32 s52, 57344
    buffer_load_dwordx4 v[76:79], v4, s[44:47], s52 offen
    s_lshl_b32 s52, s41, 13
    v_lshrrev_b32 v5, 1, v3
    v_xor_b32 v5, v5, v2
    v_and_b32 v6, 1, v3
    v_lshlrev_b32 v7, 8, v2
    v_lshl_add_u32 v7, v6, 4, v7
    v_lshl_add_u32 v8, v5, 5, v7
    v_xor_b32 v5, 4, v5
    v_lshl_add_u32 v9, v5, 5, v7
    s_waitcnt vmcnt(0)
    s_add_u32 s53, s52, 0
    buffer_store_dwordx4 v[48:51], v8, s[48:51], s53 offen sc1
    s_add_u32 s53, s52, 1024
    buffer_store_dwordx4 v[52:55], v9, s[48:51], s53 offen sc1
    s_add_u32 s53, s52, 2048
    buffer_store_dwordx4 v[56:59], v8, s[48:51], s53 offen sc1
    s_add_u32 s53, s52, 3072
    buffer_store_dwordx4 v[60:63], v9, s[48:51], s53 offen sc1
    s_add_u32 s53, s52, 4096
    buffer_store_dwordx4 v[64:67], v8, s[48:51], s53 offen sc1
    s_add_u32 s53, s52, 5120
    buffer_store_dwordx4 v[68:71], v9, s[48:51], s53 offen sc1
    s_add_u32 s53, s52, 6144
    buffer_store_dwordx4 v[72:75], v8, s[48:51], s53 offen sc1
    s_add_u32 s53, s52, 7168
    buffer_store_dwordx4 v[76:79], v9, s[48:51], s53 offen sc1
L_conv_skip:
    s_waitcnt lgkmcnt(0)
    s_barrier
    s_cmp_lg_u32 s3, 4
    s_cbranch_scc1 csf_11
    s_add_u32 s16, s64, 0x2700000
    s_addc_u32 s17, s65, 0
    s_mov_b32 s18, 0xc000
    s_mov_b32 s19, 0x20000
    v_and_b32 v1, 63, v0
    v_lshlrev_b32 v1, 2, v1
    v_add_u32 v3, 151552, v1
    ds_read_b32 v4, v3 offset:0
    ds_read_b32 v5, v3 offset:256
    ds_read_b32 v6, v3 offset:512
    ds_read_b32 v7, v3 offset:768
    s_waitcnt lgkmcnt(0)
    v_add_f32 v4, v4, v5
    v_add_f32 v6, v6, v7
    v_add_f32 v4, v4, v6
    s_and_b32 s40, s2, 3
    s_mul_i32 s40, s40, 12288
    s_lshr_b32 s41, s2, 2
    s_lshl_b32 s42, s41, 8
    s_add_u32 s40, s40, s42
    s_cmp_ge_u32 s41, 48
    s_cselect_b32 s40, 0x7f000000, s40
    buffer_store_dword v4, v1, s[16:19], s40 offen sc1
csf_11:
    s_add_u32 s28, s64, 0x400000
    s_addc_u32 s29, s65, 0
    s_mov_b32 s30, 0x400000
    s_mov_b32 s31, 0x20000
    v_and_b32 v2, 63, v0
    s_lshl_b32 s33, s3, 9
    v_lshlrev_b32 v14, 1, v2
    v_add_u32 v14, s33, v14
    v_add_u32 v15, 37888, v14
    v_add_u32 v16, 75776, v14
    v_add_u32 v17, 113664, v14
    ds_read_u16 v112, v14 offset:0
    ds_read_u16 v113, v15 offset:0
    ds_read_u16 v114, v16 offset:0
    ds_read_u16 v115, v17 offset:0
    ds_read_u16 v116, v14 offset:128
    ds_read_u16 v117, v15 offset:128
    ds_read_u16 v118, v16 offset:128
    ds_read_u16 v119, v17 offset:128
    ds_read_u16 v120, v14 offset:256
    ds_read_u16 v121, v15 offset:256
    ds_read_u16 v122, v16 offset:256
    ds_read_u16 v123, v17 offset:256
    ds_read_u16 v124, v14 offset:384
    ds_read_u16 v125, v15 offset:384
    ds_read_u16 v126, v16 offset:384
    ds_read_u16 v127, v17 offset:384
    v_lshrrev_b32 v11, 4, v2
    v_lshlrev_b32 v11, 11, v11
    v_and_b32 v12, 15, v2
    v_lshl_add_u32 v11, v12, 3, v11
    s_lshl_b32 s33, s3, 19
    s_lshl_b32 s34, s4, 14
    s_add_u32 s33, s33, s34
    s_bfe_u32 s34, s5, 0x10003
    s_lshl_b32 s34, s34, 10
    s_add_u32 s33, s33, s34
    s_bfe_u32 s34, s5, 0x20001
    s_lshl_b32 s34, s34, 8
    s_add_u32 s33, s33, s34
    s_and_b32 s34, s5, 1
    s_lshl_b32 s34, s34, 7
    s_add_u32 s33, s33, s34
    v_add_u32 v11, s33, v11
    s_waitcnt lgkmcnt(12)
    v_lshl_or_b32 v96, v113, 16, v112
    v_lshl_or_b32 v97, v115, 16, v114
    s_mov_b32 s37, 0
    buffer_store_dwordx2 v[96:97], v11, s[28:31], s37 offen sc1
    s_waitcnt lgkmcnt(8)
    v_lshl_or_b32 v98, v117, 16, v116
    v_lshl_or_b32 v99, v119, 16, v118
    s_mov_b32 s37, 8192
    buffer_store_dwordx2 v[98:99], v11, s[28:31], s37 offen sc1
    s_waitcnt lgkmcnt(4)
    v_lshl_or_b32 v100, v121, 16, v120
    v_lshl_or_b32 v101, v123, 16, v122
    s_mov_b32 s37, 262144
    buffer_store_dwordx2 v[100:101], v11, s[28:31], s37 offen sc1
    s_waitcnt lgkmcnt(0)
    v_lshl_or_b32 v102, v125, 16, v124
    v_lshl_or_b32 v103, v127, 16, v126
    s_mov_b32 s37, 270336
    buffer_store_dwordx2 v[102:103], v11, s[28:31], s37 offen sc1
    s_waitcnt vmcnt(0) lgkmcnt(0)
    s_barrier
    s_lshl_b32 s7, s2, 6
    s_add_u32 s7, s7, 1114112
    s_cmp_lg_u32 s3, 0
    s_cbranch_scc1 arr_12
    v_mov_b32 v250, s7
    v_mov_b32 v251, s86
    s_mov_b64 exec, 1
    buffer_store_dword v251, v250, s[88:91], 0 offen sc1
    s_mov_b64 exec, -1
arr_12:
    s_mov_b32 s12, s66
    s_mov_b32 s13, s67
    s_mov_b32 s14, 0x400000
    s_mov_b32 s15, 0x20000
    v_and_b32 v1, 63, v0
    v_and_b32 v2, 7, v1
    v_lshrrev_b32 v3, 3, v1
    s_lshl_b32 s4, s3, 3
    v_add_u32 v3, s4, v3
    v_lshlrev_b32 v4, 11, v2
    v_lshl_add_u32 v4, v3, 4, v4
    s_lshl_b32 s4, s2, 14
    v_add_u32 v4, s4, v4
    buffer_load_dwordx4 v[200:203], v4, s[12:15], 0 offen offset:0
    buffer_load_dwordx4 v[204:207], v4, s[12:15], 0 offen offset:1024
    s_mov_b32 s6, 1114112
    s_cmp_lg_u32 s3, 0
    s_cbranch_scc1 wt_13
    v_and_b32 v250, 63, v0
    v_lshlrev_b32 v250, 6, v250
    v_add_u32 v250, s6, v250
    s_mov_b32 s57, 0
wp_14:
    s_mov_b32 s58, 0
    buffer_load_dword v240, v250, s[88:91], s58 offen sc1
    s_mov_b32 s58, 4096
    buffer_load_dword v241, v250, s[88:91], s58 offen sc1
    s_mov_b32 s58, 8192
    buffer_load_dword v242, v250, s[88:91], s58 offen sc1
    s_mov_b32 s58, 12288
    buffer_load_dword v243, v250, s[88:91], s58 offen sc1
    s_add_u32 s57, s57, 1
    s_cmp_gt_u32 s57, 30000
    s_cbranch_scc1 wd_15
    s_waitcnt vmcnt(0)
    v_xor_b32 v240, s86, v240
    v_xor_b32 v241, s86, v241
    v_xor_b32 v242, s86, v242
    v_xor_b32 v243, s86, v243
    v_or_b32 v240, v240, v241
    v_or_b32 v240, v240, v242
    v_or_b32 v240, v240, v243
    v_cmp_eq_u32 vcc, 0, v240
    s_nop 1
    s_cmp_eq_u64 vcc, exec
    s_cbranch_scc0 wp_14
wd_15:
    s_mov_b64 exec, -1
wt_13:
    s_barrier
    s_add_u32 s16, s64, 0x800000
    s_addc_u32 s17, s65, 0
    s_mov_b32 s18, 0x400000
    s_mov_b32 s19, 0x20000
    s_add_u32 s20, s64, 0x400000
    s_addc_u32 s21, s65, 0
    s_mov_b32 s22, 0x400000
    s_mov_b32 s23, 0x20000
    s_add_u32 s24, s64, 0x2710000
    s_addc_u32 s25, s65, 0
    s_mov_b32 s26, 0x4000
    s_mov_b32 s27, 0x20000
    v_and_b32 v1, 63, v0
    v_and_b32 v2, 7, v1
    v_lshrrev_b32 v3, 3, v1
    s_lshl_b32 s4, s3, 3
    v_add_u32 v3, s4, v3
    v_lshrrev_b32 v5, 3, v3
    v_lshlrev_b32 v5, 14, v5
    v_bfe_u32 v6, v3, 2, 1
    v_lshl_add_u32 v5, v6, 10, v5
    v_and_b32 v6, 3, v3
    v_lshl_add_u32 v5, v6, 8, v5
    v_lshl_add_u32 v5, v2, 4, v5
    s_lshr_b32 s28, s2, 4
    s_lshl_b32 s28, s28, 18
    s_bfe_u32 s29, s2, 0x30001
    s_lshl_b32 s29, s29, 11
    s_add_u32 s28, s28, s29
    s_and_b32 s29, s2, 1
    s_lshl_b32 s29, s29, 7
    s_add_u32 s28, s28, s29
    v_add_u32 v5, s28, v5
    s_mov_b32 s30, 0x20000
    v_lshlrev_b32 v6, 3, v2
    v_sub_u32 v6, v5, v6
    s_and_b32 s31, s2, 1
    s_lshl_b32 s31, s31, 6
    v_subrev_u32 v6, s31, v6
    buffer_load_dwordx2 v[16:17], v6, s[20:23], 0 offen offset:0 sc1
    buffer_load_dwordx2 v[18:19], v6, s[20:23], 0 offen offset:128 sc1
    buffer_load_dwordx2 v[20:21], v6, s[20:23], s30 offen offset:0 sc1
    buffer_load_dwordx2 v[22:23], v6, s[20:23], s30 offen offset:128 sc1
    v_lshrrev_b32 v7, 5, v1
    v_lshlrev_b32 v7, 8, v7
    v_lshl_add_u32 v7, v2, 5, v7
    s_lshl_b32 s4, s3, 2
    v_add_u32 v7, s4, v7
    v_lshlrev_b32 v8, 5, v2
    v_and_b32 v9, 24, v1
    v_cmp_eq_u32 s[32:33], 0, v9
    s_waitcnt vmcnt(4)
    v_lshlrev_b32 v32, 16, v200
    v_and_b32 v33, 0xffff0000, v200
    v_lshlrev_b32 v34, 16, v201
    v_and_b32 v35, 0xffff0000, v201
    v_lshlrev_b32 v36, 16, v202
    v_and_b32 v37, 0xffff0000, v202
    v_lshlrev_b32 v38, 16, v203
    v_and_b32 v39, 0xffff0000, v203
    v_lshlrev_b32 v40, 16, v204
    v_and_b32 v41, 0xffff0000, v204
    v_lshlrev_b32 v42, 16, v205
    v_and_b32 v43, 0xffff0000, v205
    v_lshlrev_b32 v44, 16, v206
    v_and_b32 v45, 0xffff0000, v206
    v_lshlrev_b32 v46, 16, v207
    v_and_b32 v47, 0xffff0000, v207
    v_pk_add_f32 v[64:65], v[32:33], v[34:35]
    v_pk_mul_f32 v[66:67], v[32:33], v[32:33]
    v_pk_fma_f32 v[66:67], v[34:35], v[34:35], v[66:67]
    v_pk_add_f32 v[64:65], v[64:65], v[36:37]
    v_pk_fma_f32 v[66:67], v[36:37], v[36:37], v[66:67]
    v_pk_add_f32 v[64:65], v[64:65], v[38:39]
    v_pk_fma_f32 v[66:67], v[38:39], v[38:39], v[66:67]
    v_pk_add_f32 v[64:65], v[64:65], v[40:41]
    v_pk_fma_f32 v[66:67], v[40:41], v[40:41], v[66:67]
    v_pk_add_f32 v[64:65], v[64:65], v[42:43]
    v_pk_fma_f32 v[66:67], v[42:43], v[42:43], v[66:67]
    v_pk_add_f32 v[64:65], v[64:65], v[44:45]
    v_pk_fma_f32 v[66:67], v[44:45], v[44:45], v[66:67]
    v_pk_add_f32 v[64:65], v[64:65], v[46:47]
    v_pk_fma_f32 v[66:67], v[46:47], v[46:47], v[66:67]
    v_add_f32 v84, v64, v65
    v_add_f32 v85, v66, v67
    s_nop 1
    v_permlane32_swap_b32 v84, v85
    s_nop 1
    v_add_f32 v84, v84, v85
    v_mov_b32 v64, v84
    s_nop 1
    v_permlane16_swap_b32 v84, v64
    s_nop 1
    v_add_f32 v84, v84, v64
    s_nop 1
    v_add_f32_dpp v84, v84, v84 row_ror:8 row_mask:0xf bank_mask:0xf
    s_mov_b64 exec, s[32:33]
    ds_write_b32 v7, v84 offset:0
    s_mov_b64 exec, -1
    s_waitcnt lgkmcnt(0)
    s_barrier
    ds_read_b128 v[64:67], v8 offset:0
    ds_read_b128 v[68:71], v8 offset:16
    ds_read_b128 v[72:75], v8 offset:256
    ds_read_b128 v[76:79], v8 offset:272
    s_waitcnt lgkmcnt(0)
    v_pk_add_f32 v[64:65], v[64:65], v[66:67]
    v_pk_add_f32 v[68:69], v[68:69], v[70:71]
    v_pk_add_f32 v[64:65], v[64:65], v[68:69]
    v_add_f32 v84, v64, v65
    v_pk_add_f32 v[72:73], v[72:73], v[74:75]
    v_pk_add_f32 v[76:77], v[76:77], v[78:79]
    v_pk_add_f32 v[72:73], v[72:73], v[76:77]
    v_add_f32 v85, v72, v73
    v_mul_f32 v84, 0x3a800000, v84
    v_mul_f32 v85, 0x3a800000, v85
    v_fma_f32 v85, -v84, v84, v85
    v_max_f32 v85, 0, v85
    v_add_f32 v85, 0x3727c5ac, v85
    v_rsq_f32 v86, v85
    s_nop 0
    v_mul_f32 v87, v84, v86
    v_sub_f32 v87, 0, v87
    s_waitcnt vmcnt(0)
    s_cmp_lt_u32 s3, 4
    s_cbranch_scc1 ln0pf_16
    s_mov_b32 s60, s28
    s_mov_b32 s61, s30
    s_add_u32 s16, s64, 0x1000000
    s_addc_u32 s17, s65, 0
    s_mov_b32 s18, 0x600000
    s_mov_b32 s19, 0x20000
    s_sub_u32 s37, s3, 4
    s_lshl_b32 s38, s37, 12
    v_and_b32 v244, 63, v0
    v_lshlrev_b32 v244, 4, v244
    s_bfe_u32 s29, s2, 0x20001
    s_lshl_b32 s29, s29, 2
    s_lshr_b32 s39, s2, 6
    s_add_u32 s29, s29, s39
    s_mul_i32 s29, s29, 393216
    s_add_u32 s30, s29, s38
    s_add_u32 s30, s30, 8192
    s_add_u32 s41, s38, 16384
    s_add_u32 m0, s41, 0
    s_add_u32 s40, s30, 0
    buffer_load_dwordx4 v244, s[16:19], s40 offen offset:0 sc1 lds
    buffer_load_dwordx4 v244, s[16:19], s40 offen offset:1024 sc1 lds
    buffer_load_dwordx4 v244, s[16:19], s40 offen offset:2048 sc1 lds
    buffer_load_dwordx4 v244, s[16:19], s40 offen offset:3072 sc1 lds
    s_add_u32 m0, s41, 32768
    s_add_u32 s40, s30, 24576
    buffer_load_dwordx4 v244, s[16:19], s40 offen offset:0 sc1 lds
    buffer_load_dwordx4 v244, s[16:19], s40 offen offset:1024 sc1 lds
    buffer_load_dwordx4 v244, s[16:19], s40 offen offset:2048 sc1 lds
    buffer_load_dwordx4 v244, s[16:19], s40 offen offset:3072 sc1 lds
    s_add_u32 m0, s41, 65536
    s_add_u32 s40, s30, 49152
    buffer_load_dwordx4 v244, s[16:19], s40 offen offset:0 sc1 lds
    buffer_load_dwordx4 v244, s[16:19], s40 offen offset:1024 sc1 lds
    buffer_load_dwordx4 v244, s[16:19], s40 offen offset:2048 sc1 lds
    buffer_load_dwordx4 v244, s[16:19], s40 offen offset:3072 sc1 lds
    s_mov_b32 s30, s61
    s_add_u32 s16, s64, 0x800000
    s_addc_u32 s17, s65, 0
    s_mov_b32 s18, 0x400000
    s_mov_b32 s19, 0x20000
ln0pf_16:
    v_lshlrev_b32 v48, 16, v16
    v_and_b32 v49, 0xffff0000, v16
    v_lshlrev_b32 v50, 16, v17
    v_and_b32 v51, 0xffff0000, v17
    v_lshlrev_b32 v52, 16, v18
    v_and_b32 v53, 0xffff0000, v18
    v_lshlrev_b32 v54, 16, v19
    v_and_b32 v55, 0xffff0000, v19
    v_lshlrev_b32 v56, 16, v20
    v_and_b32 v57, 0xffff0000, v20
    v_lshlrev_b32 v58, 16, v21
    v_and_b32 v59, 0xffff0000, v21
    v_lshlrev_b32 v60, 16, v22
    v_and_b32 v61, 0xffff0000, v22
    v_lshlrev_b32 v62, 16, v23
    v_and_b32 v63, 0xffff0000, v23
    v_pk_fma_f32 v[64:65], v[32:33], v[86:87], v[86:87] op_sel:[0,0,1] op_sel_hi:[1,0,1]
    v_pk_fma_f32 v[32:33], v[64:65], v[48:49], v[32:33]
    v_pk_fma_f32 v[64:65], v[34:35], v[86:87], v[86:87] op_sel:[0,0,1] op_sel_hi:[1,0,1]
    v_pk_fma_f32 v[34:35], v[64:65], v[50:51], v[34:35]
    v_pk_fma_f32 v[64:65], v[36:37], v[86:87], v[86:87] op_sel:[0,0,1] op_sel_hi:[1,0,1]
    v_pk_fma_f32 v[36:37], v[64:65], v[52:53], v[36:37]
    v_pk_fma_f32 v[64:65], v[38:39], v[86:87], v[86:87] op_sel:[0,0,1] op_sel_hi:[1,0,1]
    v_pk_fma_f32 v[38:39], v[64:65], v[54:55], v[38:39]
    v_pk_fma_f32 v[64:65], v[40:41], v[86:87], v[86:87] op_sel:[0,0,1] op_sel_hi:[1,0,1]
    v_pk_fma_f32 v[40:41], v[64:65], v[56:57], v[40:41]
    v_pk_fma_f32 v[64:65], v[42:43], v[86:87], v[86:87] op_sel:[0,0,1] op_sel_hi:[1,0,1]
    v_pk_fma_f32 v[42:43], v[64:65], v[58:59], v[42:43]
    v_pk_fma_f32 v[64:65], v[44:45], v[86:87], v[86:87] op_sel:[0,0,1] op_sel_hi:[1,0,1]
    v_pk_fma_f32 v[44:45], v[64:65], v[60:61], v[44:45]
    v_pk_fma_f32 v[64:65], v[46:47], v[86:87], v[86:87] op_sel:[0,0,1] op_sel_hi:[1,0,1]
    v_pk_fma_f32 v[46:47], v[64:65], v[62:63], v[46:47]
    v_cvt_pk_bf16_f32 v16, v32, v33
    v_cvt_pk_bf16_f32 v17, v34, v35
    v_cvt_pk_bf16_f32 v18, v36, v37
    v_cvt_pk_bf16_f32 v19, v38, v39
    v_cvt_pk_bf16_f32 v20, v40, v41
    v_cvt_pk_bf16_f32 v21, v42, v43
    v_cvt_pk_bf16_f32 v22, v44, v45
    v_cvt_pk_bf16_f32 v23, v46, v47
    buffer_store_dwordx4 v[16:19], v5, s[16:19], 0 offen sc1
    buffer_store_dwordx4 v[20:23], v5, s[16:19], s30 offen sc1
    v_lshlrev_b32 v32, 16, v16
    v_and_b32 v33, 0xffff0000, v16
    v_lshlrev_b32 v34, 16, v17
    v_and_b32 v35, 0xffff0000, v17
    v_lshlrev_b32 v36, 16, v18
    v_and_b32 v37, 0xffff0000, v18
    v_lshlrev_b32 v38, 16, v19
    v_and_b32 v39, 0xffff0000, v19
    v_lshlrev_b32 v40, 16, v20
    v_and_b32 v41, 0xffff0000, v20
    v_lshlrev_b32 v42, 16, v21
    v_and_b32 v43, 0xffff0000, v21
    v_lshlrev_b32 v44, 16, v22
    v_and_b32 v45, 0xffff0000, v22
    v_lshlrev_b32 v46, 16, v23
    v_and_b32 v47, 0xffff0000, v23
    v_pk_add_f32 v[64:65], v[32:33], v[34:35]
    v_pk_mul_f32 v[66:67], v[32:33], v[32:33]
    v_pk_fma_f32 v[66:67], v[34:35], v[34:35], v[66:67]
    v_pk_add_f32 v[64:65], v[64:65], v[36:37]
    v_pk_fma_f32 v[66:67], v[36:37], v[36:37], v[66:67]
    v_pk_add_f32 v[64:65], v[64:65], v[38:39]
    v_pk_fma_f32 v[66:67], v[38:39], v[38:39], v[66:67]
    v_pk_add_f32 v[64:65], v[64:65], v[40:41]
    v_pk_fma_f32 v[66:67], v[40:41], v[40:41], v[66:67]
    v_pk_add_f32 v[64:65], v[64:65], v[42:43]
    v_pk_fma_f32 v[66:67], v[42:43], v[42:43], v[66:67]
    v_pk_add_f32 v[64:65], v[64:65], v[44:45]
    v_pk_fma_f32 v[66:67], v[44:45], v[44:45], v[66:67]
    v_pk_add_f32 v[64:65], v[64:65], v[46:47]
    v_pk_fma_f32 v[66:67], v[46:47], v[46:47], v[66:67]
    v_add_f32 v84, v64, v65
    v_add_f32 v85, v66, v67
    s_nop 1
    v_permlane32_swap_b32 v84, v85
    s_nop 1
    v_add_f32 v84, v84, v85
    v_mov_b32 v64, v84
    s_nop 1
    v_permlane16_swap_b32 v84, v64
    s_nop 1
    v_add_f32 v84, v84, v64
    s_nop 1
    v_add_f32_dpp v84, v84, v84 row_ror:8 row_mask:0xf bank_mask:0xf
    s_mov_b64 exec, s[32:33]
    ds_write_b32 v7, v84 offset:512
    s_mov_b64 exec, -1
    s_waitcnt lgkmcnt(0)
    s_barrier
    ds_read_b128 v[64:67], v8 offset:512
    ds_read_b128 v[68:71], v8 offset:528
    ds_read_b128 v[72:75], v8 offset:768
    ds_read_b128 v[76:79], v8 offset:784
    s_waitcnt lgkmcnt(0)
    v_pk_add_f32 v[64:65], v[64:65], v[66:67]
    v_pk_add_f32 v[68:69], v[68:69], v[70:71]
    v_pk_add_f32 v[64:65], v[64:65], v[68:69]
    v_add_f32 v84, v64, v65
    v_pk_add_f32 v[72:73], v[72:73], v[74:75]
    v_pk_add_f32 v[76:77], v[76:77], v[78:79]
    v_pk_add_f32 v[72:73], v[72:73], v[76:77]
    v_add_f32 v85, v72, v73
    s_cmp_lg_u32 s3, 0
    s_cbranch_scc1 ln0s_17
    s_lshl_b32 s4, s2, 6
    v_lshlrev_b32 v9, 3, v2
    s_mov_b64 exec, 0xff
    buffer_store_dwordx2 v[84:85], v9, s[24:27], s4 offen sc1
    s_mov_b64 exec, -1
ln0s_17:
    s_waitcnt vmcnt(0) lgkmcnt(0)
    s_barrier
    s_lshr_b32 s9, s2, 4
    s_cmp_lg_u32 s3, 0
    s_cbranch_scc1 arr_18
    s_lshl_b32 s56, s9, 8
    s_add_u32 s56, s56, 0
    v_mov_b32 v250, s56
    v_mov_b32 v251, 1
    s_mov_b64 exec, 1
    buffer_atomic_add v251, v250, s[88:91], 0 offen sc1
    s_mov_b64 exec, -1
arr_18:
    s_and_b32 s4, s2, 7
    s_lshr_b32 s5, s2, 3
    s_and_b32 s6, s4, 1
    s_lshl_b32 s6, s6, 3
    s_and_b32 s7, s5, 7
    s_add_u32 s6, s6, s7
    s_lshr_b32 s7, s4, 1
    s_lshl_b32 s7, s7, 2
    s_lshr_b32 s8, s5, 3
    s_add_u32 s7, s7, s8
    s_cmp_lt_u32 s3, 4
    s_cbranch_scc1 p3pre_19
    s_add_u32 s12, s64, 0x800000
    s_addc_u32 s13, s65, 0
    s_mov_b32 s14, 0x400000
    s_mov_b32 s15, 0x20000
    s_add_u32 s16, s64, 0x1000000
    s_addc_u32 s17, s65, 0
    s_mov_b32 s18, 0x600000
    s_mov_b32 s19, 0x20000
    s_sub_u32 s37, s3, 4
    s_lshl_b32 s38, s37, 12
    s_lshl_b32 s28, s6, 18
    s_add_u32 s28, s28, s38
    v_and_b32 v1, 63, v0
    v_lshlrev_b32 v2, 4, v1
    s_mul_i32 s29, s7, 393216
    s_add_u32 s30, s29, s38
    s_add_u32 s30, s30, 8192
    s_lshl_b32 s39, s37, 11
    s_add_u32 s31, s29, s39
    s_add_u32 s41, s38, 16384
    s_add_u32 s42, s39, 16384
p3pre_19:
    s_cmp_lg_u32 s3, 0
    s_cbranch_scc1 wt_20
    v_and_b32 v250, 63, v0
    v_lshlrev_b32 v250, 8, v250
    s_lshl_b32 s56, s6, 8
    s_add_u32 s56, s56, 0
    v_add_u32 v250, s56, v250
    s_mov_b64 exec, 0x1
    s_mov_b32 s57, 0
wp_21:
    buffer_load_dword v251, v250, s[88:91], 0 offen sc1
    s_add_u32 s57, s57, 1
    s_cmp_gt_u32 s57, 30000
    s_cbranch_scc1 wd_22
    s_waitcnt vmcnt(0)
    v_cmp_le_u32 vcc, 16, v251
    s_nop 1
    s_cmp_eq_u64 vcc, exec
    s_cbranch_scc0 wp_21
wd_22:
    s_mov_b64 exec, -1
wt_20:
    s_barrier
    s_cmp_lt_u32 s3, 4
    s_cbranch_scc1 p3comp_23
    s_add_u32 m0, s38, 0
    s_add_u32 s40, s28, 0
    buffer_load_dwordx4 v2, s[12:15], s40 offen offset:0 sc1 lds
    buffer_load_dwordx4 v2, s[12:15], s40 offen offset:1024 sc1 lds
    buffer_load_dwordx4 v2, s[12:15], s40 offen offset:2048 sc1 lds
    buffer_load_dwordx4 v2, s[12:15], s40 offen offset:3072 sc1 lds
    s_add_u32 m0, s38, 32768
    s_add_u32 s40, s28, 16384
    buffer_load_dwordx4 v2, s[12:15], s40 offen offset:0 sc1 lds
    buffer_load_dwordx4 v2, s[12:15], s40 offen offset:1024 sc1 lds
    buffer_load_dwordx4 v2, s[12:15], s40 offen offset:2048 sc1 lds
    buffer_load_dwordx4 v2, s[12:15], s40 offen offset:3072 sc1 lds
    s_add_u32 m0, s38, 65536
    s_add_u32 s40, s28, 32768
    buffer_load_dwordx4 v2, s[12:15], s40 offen offset:0 sc1 lds
    buffer_load_dwordx4 v2, s[12:15], s40 offen offset:1024 sc1 lds
    buffer_load_dwordx4 v2, s[12:15], s40 offen offset:2048 sc1 lds
    buffer_load_dwordx4 v2, s[12:15], s40 offen offset:3072 sc1 lds
    s_lshl_b32 s43, s6, 7
    s_lshl_b32 s44, s37, 5
    s_add_u32 s43, s43, s44
    s_add_u32 s20, s64, 0x2710000
    s_addc_u32 s21, s65, 0
    s_mov_b32 s22, 0x4000
    s_mov_b32 s23, 0x20000
    v_lshlrev_b32 v3, 3, v1
    s_lshl_b32 s43, s43, 3
    s_add_u32 s24, s64, 0x2700000
    s_addc_u32 s25, s65, 0
    s_mov_b32 s26, 0xc000
    s_mov_b32 s27, 0x20000
    v_lshlrev_b32 v9, 2, v1
    s_lshl_b32 s45, s37, 12
    s_lshl_b32 s44, s7, 8
    s_add_u32 s45, s45, s44
    s_cmp_eq_u32 s37, 3
    s_cselect_b32 s45, 0x7f000000, s45
    s_waitcnt vmcnt(8)
    s_barrier
    s_add_u32 m0, s38, 98304
    s_add_u32 s40, s28, 49152
    buffer_load_dwordx4 v2, s[12:15], s40 offen offset:0 sc1 lds
    buffer_load_dwordx4 v2, s[12:15], s40 offen offset:1024 sc1 lds
    buffer_load_dwordx4 v2, s[12:15], s40 offen offset:2048 sc1 lds
    buffer_load_dwordx4 v2, s[12:15], s40 offen offset:3072 sc1 lds
    s_add_u32 m0, s41, 98304
    s_add_u32 s40, s30, 73728
    buffer_load_dwordx4 v2, s[16:19], s40 offen offset:0 sc1 lds
    buffer_load_dwordx4 v2, s[16:19], s40 offen offset:1024 sc1 lds
    buffer_load_dwordx4 v2, s[16:19], s40 offen offset:2048 sc1 lds
    buffer_load_dwordx4 v2, s[16:19], s40 offen offset:3072 sc1 lds
    s_waitcnt vmcnt(12)
    s_barrier
    s_add_u32 m0, s38, 0
    s_add_u32 s40, s28, 65536
    buffer_load_dwordx4 v2, s[12:15], s40 offen offset:0 sc1 lds
    buffer_load_dwordx4 v2, s[12:15], s40 offen offset:1024 sc1 lds
    buffer_load_dwordx4 v2, s[12:15], s40 offen offset:2048 sc1 lds
    buffer_load_dwordx4 v2, s[12:15], s40 offen offset:3072 sc1 lds
    s_add_u32 m0, s41, 0
    s_add_u32 s40, s30, 98304
    buffer_load_dwordx4 v2, s[16:19], s40 offen offset:0 sc1 lds
    buffer_load_dwordx4 v2, s[16:19], s40 offen offset:1024 sc1 lds
    buffer_load_dwordx4 v2, s[16:19], s40 offen offset:2048 sc1 lds
    buffer_load_dwordx4 v2, s[16:19], s40 offen offset:3072 sc1 lds
    s_waitcnt vmcnt(16)
    s_barrier
    s_add_u32 m0, s38, 32768
    s_add_u32 s40, s28, 81920
    buffer_load_dwordx4 v2, s[12:15], s40 offen offset:0 sc1 lds
    buffer_load_dwordx4 v2, s[12:15], s40 offen offset:1024 sc1 lds
    buffer_load_dwordx4 v2, s[12:15], s40 offen offset:2048 sc1 lds
    buffer_load_dwordx4 v2, s[12:15], s40 offen offset:3072 sc1 lds
    s_add_u32 m0, s41, 32768
    s_add_u32 s40, s30, 122880
    buffer_load_dwordx4 v2, s[16:19], s40 offen offset:0 sc1 lds
    buffer_load_dwordx4 v2, s[16:19], s40 offen offset:1024 sc1 lds
    buffer_load_dwordx4 v2, s[16:19], s40 offen offset:2048 sc1 lds
    buffer_load_dwordx4 v2, s[16:19], s40 offen offset:3072 sc1 lds
    s_waitcnt vmcnt(16)
    s_barrier
    s_add_u32 m0, s38, 65536
    s_add_u32 s40, s28, 98304
    buffer_load_dwordx4 v2, s[12:15], s40 offen offset:0 sc1 lds
    buffer_load_dwordx4 v2, s[12:15], s40 offen offset:1024 sc1 lds
    buffer_load_dwordx4 v2, s[12:15], s40 offen offset:2048 sc1 lds
    buffer_load_dwordx4 v2, s[12:15], s40 offen offset:3072 sc1 lds
    s_add_u32 m0, s41, 65536
    s_add_u32 s40, s30, 147456
    buffer_load_dwordx4 v2, s[16:19], s40 offen offset:0 sc1 lds
    buffer_load_dwordx4 v2, s[16:19], s40 offen offset:1024 sc1 lds
    buffer_load_dwordx4 v2, s[16:19], s40 offen offset:2048 sc1 lds
    buffer_load_dwordx4 v2, s[16:19], s40 offen offset:3072 sc1 lds
    s_waitcnt vmcnt(16)
    s_barrier
    s_add_u32 m0, s38, 98304
    s_add_u32 s40, s28, 114688
    buffer_load_dwordx4 v2, s[12:15], s40 offen offset:0 sc1 lds
    buffer_load_dwordx4 v2, s[12:15], s40 offen offset:1024 sc1 lds
    buffer_load_dwordx4 v2, s[12:15], s40 offen offset:2048 sc1 lds
    buffer_load_dwordx4 v2, s[12:15], s40 offen offset:3072 sc1 lds
    s_add_u32 m0, s41, 98304
    s_add_u32 s40, s30, 172032
    buffer_load_dwordx4 v2, s[16:19], s40 offen offset:0 sc1 lds
    buffer_load_dwordx4 v2, s[16:19], s40 offen offset:1024 sc1 lds
    buffer_load_dwordx4 v2, s[16:19], s40 offen offset:2048 sc1 lds
    buffer_load_dwordx4 v2, s[16:19], s40 offen offset:3072 sc1 lds
    s_waitcnt vmcnt(16)
    s_barrier
    s_add_u32 m0, s38, 0
    s_add_u32 s40, s28, 131072
    buffer_load_dwordx4 v2, s[12:15], s40 offen offset:0 sc1 lds
    buffer_load_dwordx4 v2, s[12:15], s40 offen offset:1024 sc1 lds
    buffer_load_dwordx4 v2, s[12:15], s40 offen offset:2048 sc1 lds
    buffer_load_dwordx4 v2, s[12:15], s40 offen offset:3072 sc1 lds
    s_add_u32 m0, s41, 0
    s_add_u32 s40, s30, 196608
    buffer_load_dwordx4 v2, s[16:19], s40 offen offset:0 sc1 lds
    buffer_load_dwordx4 v2, s[16:19], s40 offen offset:1024 sc1 lds
    buffer_load_dwordx4 v2, s[16:19], s40 offen offset:2048 sc1 lds
    buffer_load_dwordx4 v2, s[16:19], s40 offen offset:3072 sc1 lds
    s_waitcnt vmcnt(16)
    s_barrier
    s_add_u32 m0, s38, 32768
    s_add_u32 s40, s28, 147456
    buffer_load_dwordx4 v2, s[12:15], s40 offen offset:0 sc1 lds
    buffer_load_dwordx4 v2, s[12:15], s40 offen offset:1024 sc1 lds
    buffer_load_dwordx4 v2, s[12:15], s40 offen offset:2048 sc1 lds
    buffer_load_dwordx4 v2, s[12:15], s40 offen offset:3072 sc1 lds
    s_add_u32 m0, s41, 32768
    s_add_u32 s40, s30, 221184
    buffer_load_dwordx4 v2, s[16:19], s40 offen offset:0 sc1 lds
    buffer_load_dwordx4 v2, s[16:19], s40 offen offset:1024 sc1 lds
    buffer_load_dwordx4 v2, s[16:19], s40 offen offset:2048 sc1 lds
    buffer_load_dwordx4 v2, s[16:19], s40 offen offset:3072 sc1 lds
    s_waitcnt vmcnt(16)
    s_barrier
    s_add_u32 m0, s38, 65536
    s_add_u32 s40, s28, 163840
    buffer_load_dwordx4 v2, s[12:15], s40 offen offset:0 sc1 lds
    buffer_load_dwordx4 v2, s[12:15], s40 offen offset:1024 sc1 lds
    buffer_load_dwordx4 v2, s[12:15], s40 offen offset:2048 sc1 lds
    buffer_load_dwordx4 v2, s[12:15], s40 offen offset:3072 sc1 lds
    s_add_u32 m0, s41, 65536
    s_add_u32 s40, s30, 245760
    buffer_load_dwordx4 v2, s[16:19], s40 offen offset:0 sc1 lds
    buffer_load_dwordx4 v2, s[16:19], s40 offen offset:1024 sc1 lds
    buffer_load_dwordx4 v2, s[16:19], s40 offen offset:2048 sc1 lds
    buffer_load_dwordx4 v2, s[16:19], s40 offen offset:3072 sc1 lds
    s_waitcnt vmcnt(16)
    s_barrier
    s_add_u32 m0, s38, 98304
    s_add_u32 s40, s28, 180224
    buffer_load_dwordx4 v2, s[12:15], s40 offen offset:0 sc1 lds
    buffer_load_dwordx4 v2, s[12:15], s40 offen offset:1024 sc1 lds
    buffer_load_dwordx4 v2, s[12:15], s40 offen offset:2048 sc1 lds
    buffer_load_dwordx4 v2, s[12:15], s40 offen offset:3072 sc1 lds
    s_add_u32 m0, s41, 98304
    s_add_u32 s40, s30, 270336
    buffer_load_dwordx4 v2, s[16:19], s40 offen offset:0 sc1 lds
    buffer_load_dwordx4 v2, s[16:19], s40 offen offset:1024 sc1 lds
    buffer_load_dwordx4 v2, s[16:19], s40 offen offset:2048 sc1 lds
    buffer_load_dwordx4 v2, s[16:19], s40 offen offset:3072 sc1 lds
    s_waitcnt vmcnt(16)
    s_barrier
    s_add_u32 m0, s38, 0
    s_add_u32 s40, s28, 196608
    buffer_load_dwordx4 v2, s[12:15], s40 offen offset:0 sc1 lds
    buffer_load_dwordx4 v2, s[12:15], s40 offen offset:1024 sc1 lds
    buffer_load_dwordx4 v2, s[12:15], s40 offen offset:2048 sc1 lds
    buffer_load_dwordx4 v2, s[12:15], s40 offen offset:3072 sc1 lds
    s_add_u32 m0, s41, 0
    s_add_u32 s40, s30, 294912
    buffer_load_dwordx4 v2, s[16:19], s40 offen offset:0 sc1 lds
    buffer_load_dwordx4 v2, s[16:19], s40 offen offset:1024 sc1 lds
    buffer_load_dwordx4 v2, s[16:19], s40 offen offset:2048 sc1 lds
    buffer_load_dwordx4 v2, s[16:19], s40 offen offset:3072 sc1 lds
    s_waitcnt vmcnt(16)
    s_barrier
    s_add_u32 m0, s38, 32768
    s_add_u32 s40, s28, 212992
    buffer_load_dwordx4 v2, s[12:15], s40 offen offset:0 sc1 lds
    buffer_load_dwordx4 v2, s[12:15], s40 offen offset:1024 sc1 lds
    buffer_load_dwordx4 v2, s[12:15], s40 offen offset:2048 sc1 lds
    buffer_load_dwordx4 v2, s[12:15], s40 offen offset:3072 sc1 lds
    s_add_u32 m0, s41, 32768
    s_add_u32 s40, s30, 319488
    buffer_load_dwordx4 v2, s[16:19], s40 offen offset:0 sc1 lds
    buffer_load_dwordx4 v2, s[16:19], s40 offen offset:1024 sc1 lds
    buffer_load_dwordx4 v2, s[16:19], s40 offen offset:2048 sc1 lds
    buffer_load_dwordx4 v2, s[16:19], s40 offen offset:3072 sc1 lds
    s_waitcnt vmcnt(16)
    s_barrier
    s_add_u32 m0, s38, 65536
    s_add_u32 s40, s28, 229376
    buffer_load_dwordx4 v2, s[12:15], s40 offen offset:0 sc1 lds
    buffer_load_dwordx4 v2, s[12:15], s40 offen offset:1024 sc1 lds
    buffer_load_dwordx4 v2, s[12:15], s40 offen offset:2048 sc1 lds
    buffer_load_dwordx4 v2, s[12:15], s40 offen offset:3072 sc1 lds
    s_add_u32 m0, s41, 65536
    s_add_u32 s40, s30, 344064
    buffer_load_dwordx4 v2, s[16:19], s40 offen offset:0 sc1 lds
    buffer_load_dwordx4 v2, s[16:19], s40 offen offset:1024 sc1 lds
    buffer_load_dwordx4 v2, s[16:19], s40 offen offset:2048 sc1 lds
    buffer_load_dwordx4 v2, s[16:19], s40 offen offset:3072 sc1 lds
    s_waitcnt vmcnt(16)
    s_barrier
    s_add_u32 m0, s38, 98304
    s_add_u32 s40, s28, 245760
    buffer_load_dwordx4 v2, s[12:15], s40 offen offset:0 sc1 lds
    buffer_load_dwordx4 v2, s[12:15], s40 offen offset:1024 sc1 lds
    buffer_load_dwordx4 v2, s[12:15], s40 offen offset:2048 sc1 lds
    buffer_load_dwordx4 v2, s[12:15], s40 offen offset:3072 sc1 lds
    s_add_u32 m0, s41, 98304
    s_add_u32 s40, s30, 368640
    buffer_load_dwordx4 v2, s[16:19], s40 offen offset:0 sc1 lds
    buffer_load_dwordx4 v2, s[16:19], s40 offen offset:1024 sc1 lds
    buffer_load_dwordx4 v2, s[16:19], s40 offen offset:2048 sc1 lds
    buffer_load_dwordx4 v2, s[16:19], s40 offen offset:3072 sc1 lds
    s_mov_b64 exec, 0xffffffff
    buffer_load_dwordx2 v[16:17], v3, s[20:23], s43 offen sc1
    s_mov_b64 exec, -1
    s_add_u32 s44, s45, 0
    buffer_load_dword v32, v9, s[24:27], s44 offen sc1
    s_add_u32 s44, s45, 12288
    buffer_load_dword v33, v9, s[24:27], s44 offen sc1
    s_add_u32 s44, s45, 24576
    buffer_load_dword v34, v9, s[24:27], s44 offen sc1
    s_add_u32 s44, s45, 36864
    buffer_load_dword v35, v9, s[24:27], s44 offen sc1
    s_waitcnt vmcnt(21)
    s_barrier
    s_add_u32 m0, s42, 0
    s_add_u32 s40, s31, 294912
    buffer_load_dwordx4 v2, s[16:19], s40 offen offset:0 sc1 lds
    buffer_load_dwordx4 v2, s[16:19], s40 offen offset:1024 sc1 lds
    s_waitcnt vmcnt(15)
    s_barrier
    s_add_u32 m0, s42, 32768
    s_add_u32 s40, s31, 319488
    buffer_load_dwordx4 v2, s[16:19], s40 offen offset:0 sc1 lds
    buffer_load_dwordx4 v2, s[16:19], s40 offen offset:1024 sc1 lds
    s_waitcnt vmcnt(9)
    s_barrier
    s_add_u32 m0, s42, 65536
    s_add_u32 s40, s31, 344064
    buffer_load_dwordx4 v2, s[16:19], s40 offen offset:0 sc1 lds
    buffer_load_dwordx4 v2, s[16:19], s40 offen offset:1024 sc1 lds
    s_waitcnt vmcnt(6)
    v_add_f32 v32, v32, v33
    v_add_f32 v34, v34, v35
    v_add_f32 v32, v32, v34
    s_lshl_b32 s44, s37, 8
    v_add_u32 v10, s44, v9
    v_add_u32 v10, 132096, v10
    ds_write_b32 v10, v32
    v_mul_f32 v16, 0x3a800000, v16
    v_mul_f32 v17, 0x3a800000, v17
    v_fma_f32 v17, -v16, v16, v17
    v_max_f32 v17, 0, v17
    v_add_f32 v17, 0x3727c5ac, v17
    v_rsq_f32 v18, v17
    s_nop 0
    v_mul_f32 v19, v16, v18
    v_sub_f32 v19, 0, v19
    v_lshlrev_b32 v4, 2, v1
    s_lshl_b32 s44, s37, 7
    s_add_u32 s44, s44, 131072
    v_add_u32 v4, s44, v4
    s_mov_b64 exec, 0xffffffff
    ds_write_b32 v4, v18
    ds_write_b32 v4, v19 offset:512
    s_mov_b64 exec, -1
    s_waitcnt lgkmcnt(0)
    s_barrier
    s_waitcnt vmcnt(4)
    s_barrier
    s_add_u32 m0, s42, 98304
    s_add_u32 s40, s31, 368640
    buffer_load_dwordx4 v2, s[16:19], s40 offen offset:0 sc1 lds
    buffer_load_dwordx4 v2, s[16:19], s40 offen offset:1024 sc1 lds
    s_add_u32 s24, s64, 0x2400000
    s_addc_u32 s25, s65, 0
    s_mov_b32 s26, 0x22000
    s_mov_b32 s27, 0x20000
    s_lshr_b32 s46, s37, 1
    s_and_b32 s47, s37, 1
    s_mul_i32 s48, s46, 12288
    s_lshl_b32 s49, s47, 11
    s_add_u32 s48, s48, s49
    s_add_u32 s48, s48, 133120
    v_add_u32 v5, s48, v9
    ds_read_b32 v16, v5 offset:0
    ds_read_b32 v24, v5 offset:6144
    ds_read_b32 v17, v5 offset:256
    ds_read_b32 v25, v5 offset:6400
    ds_read_b32 v18, v5 offset:512
    ds_read_b32 v26, v5 offset:6656
    ds_read_b32 v19, v5 offset:768
    ds_read_b32 v27, v5 offset:6912
    ds_read_b32 v20, v5 offset:1024
    ds_read_b32 v28, v5 offset:7168
    ds_read_b32 v21, v5 offset:1280
    ds_read_b32 v29, v5 offset:7424
    ds_read_b32 v22, v5 offset:1536
    ds_read_b32 v30, v5 offset:7680
    ds_read_b32 v23, v5 offset:1792
    ds_read_b32 v31, v5 offset:7936
    v_bfe_u32 v6, v1, 4, 1
    v_lshlrev_b32 v6, 10, v6
    v_bfe_u32 v7, v1, 2, 2
    v_lshl_add_u32 v6, v7, 8, v6
    v_and_b32 v7, 3, v1
    v_lshl_add_u32 v6, v7, 2, v6
    s_mul_i32 s50, s46, 12288
    s_add_u32 s50, s50, 137216
    v_add_u32 v6, s50, v6
    ds_read_b32 v32, v6
    ds_read_b32 v33, v6 offset:6144
    s_lshl_b32 s50, s7, 1
    s_add_u32 s50, s50, s46
    s_mul_i32 s50, s50, 4352
    s_add_u32 s51, s50, s49
    s_add_u32 s52, s50, 4096
    s_cmp_lg_u32 s47, 0
    s_cselect_b32 s52, 0x7f000000, s52
    s_waitcnt lgkmcnt(0)
    v_add_f32 v16, v16, v24
    buffer_atomic_add_f32 v16, v9, s[24:27], s51 offen offset:0 sc1
    v_add_f32 v17, v17, v25
    buffer_atomic_add_f32 v17, v9, s[24:27], s51 offen offset:256 sc1
    v_add_f32 v18, v18, v26
    buffer_atomic_add_f32 v18, v9, s[24:27], s51 offen offset:512 sc1
    v_add_f32 v19, v19, v27
    buffer_atomic_add_f32 v19, v9, s[24:27], s51 offen offset:768 sc1
    v_add_f32 v20, v20, v28
    buffer_atomic_add_f32 v20, v9, s[24:27], s51 offen offset:1024 sc1
    v_add_f32 v21, v21, v29
    buffer_atomic_add_f32 v21, v9, s[24:27], s51 offen offset:1280 sc1
    v_add_f32 v22, v22, v30
    buffer_atomic_add_f32 v22, v9, s[24:27], s51 offen offset:1536 sc1
    v_add_f32 v23, v23, v31
    buffer_atomic_add_f32 v23, v9, s[24:27], s51 offen offset:1792 sc1
    v_add_f32 v32, v32, v33
    s_mov_b64 exec, 0xffffffff
    buffer_atomic_add_f32 v32, v9, s[24:27], s52 offen sc1
    s_mov_b64 exec, -1
    s_waitcnt vmcnt(13)
    s_barrier
    s_add_u32 m0, s38, 0
    s_add_u32 s40, s28, 0
    buffer_load_dwordx4 v2, s[12:15], s40 offen offset:0 sc1 lds
    buffer_load_dwordx4 v2, s[12:15], s40 offen offset:1024 sc1 lds
    buffer_load_dwordx4 v2, s[12:15], s40 offen offset:2048 sc1 lds
    buffer_load_dwordx4 v2, s[12:15], s40 offen offset:3072 sc1 lds
    s_add_u32 m0, s42, 0
    s_add_u32 s40, s31, 0
    buffer_load_dwordx4 v2, s[16:19], s40 offen offset:0 sc1 lds
    buffer_load_dwordx4 v2, s[16:19], s40 offen offset:1024 sc1 lds
    s_waitcnt vmcnt(17)
    s_barrier
    s_add_u32 m0, s38, 32768
    s_add_u32 s40, s28, 16384
    buffer_load_dwordx4 v2, s[12:15], s40 offen offset:0 sc1 lds
    buffer_load_dwordx4 v2, s[12:15], s40 offen offset:1024 sc1 lds
    buffer_load_dwordx4 v2, s[12:15], s40 offen offset:2048 sc1 lds
    buffer_load_dwordx4 v2, s[12:15], s40 offen offset:3072 sc1 lds
    s_add_u32 m0, s42, 32768
    s_add_u32 s40, s31, 24576
    buffer_load_dwordx4 v2, s[16:19], s40 offen offset:0 sc1 lds
    buffer_load_dwordx4 v2, s[16:19], s40 offen offset:1024 sc1 lds
    s_waitcnt vmcnt(21)
    s_barrier
    s_add_u32 m0, s38, 65536
    s_add_u32 s40, s28, 32768
    buffer_load_dwordx4 v2, s[12:15], s40 offen offset:0 sc1 lds
    buffer_load_dwordx4 v2, s[12:15], s40 offen offset:1024 sc1 lds
    buffer_load_dwordx4 v2, s[12:15], s40 offen offset:2048 sc1 lds
    buffer_load_dwordx4 v2, s[12:15], s40 offen offset:3072 sc1 lds
    s_add_u32 m0, s42, 65536
    s_add_u32 s40, s31, 49152
    buffer_load_dwordx4 v2, s[16:19], s40 offen offset:0 sc1 lds
    buffer_load_dwordx4 v2, s[16:19], s40 offen offset:1024 sc1 lds
    s_waitcnt vmcnt(12)
    s_barrier
    s_add_u32 m0, s38, 98304
    s_add_u32 s40, s28, 49152
    buffer_load_dwordx4 v2, s[12:15], s40 offen offset:0 sc1 lds
    buffer_load_dwordx4 v2, s[12:15], s40 offen offset:1024 sc1 lds
    buffer_load_dwordx4 v2, s[12:15], s40 offen offset:2048 sc1 lds
    buffer_load_dwordx4 v2, s[12:15], s40 offen offset:3072 sc1 lds
    s_add_u32 m0, s42, 98304
    s_add_u32 s40, s31, 73728
    buffer_load_dwordx4 v2, s[16:19], s40 offen offset:0 sc1 lds
    buffer_load_dwordx4 v2, s[16:19], s40 offen offset:1024 sc1 lds
    s_cmp_lg_u32 s3, 4
    s_cbranch_scc1 p3ga_25
    s_lshl_b32 s56, s7, 8
    s_add_u32 s56, s56, 40960
    v_mov_b32 v40, s56
    v_mov_b32 v41, 1
    s_mov_b64 exec, 1
    buffer_atomic_add v41, v40, s[88:91], 0 offen sc1
    s_mov_b64 exec, -1
p3ga_25:
    s_waitcnt vmcnt(12)
    s_barrier
    s_add_u32 m0, s38, 0
    s_add_u32 s40, s28, 65536
    buffer_load_dwordx4 v2, s[12:15], s40 offen offset:0 sc1 lds
    buffer_load_dwordx4 v2, s[12:15], s40 offen offset:1024 sc1 lds
    buffer_load_dwordx4 v2, s[12:15], s40 offen offset:2048 sc1 lds
    buffer_load_dwordx4 v2, s[12:15], s40 offen offset:3072 sc1 lds
    s_add_u32 m0, s42, 0
    s_add_u32 s40, s31, 98304
    buffer_load_dwordx4 v2, s[16:19], s40 offen offset:0 sc1 lds
    buffer_load_dwordx4 v2, s[16:19], s40 offen offset:1024 sc1 lds
    s_waitcnt vmcnt(12)
    s_barrier
    s_add_u32 m0, s38, 32768
    s_add_u32 s40, s28, 81920
    buffer_load_dwordx4 v2, s[12:15], s40 offen offset:0 sc1 lds
    buffer_load_dwordx4 v2, s[12:15], s40 offen offset:1024 sc1 lds
    buffer_load_dwordx4 v2, s[12:15], s40 offen offset:2048 sc1 lds
    buffer_load_dwordx4 v2, s[12:15], s40 offen offset:3072 sc1 lds
    s_add_u32 m0, s42, 32768
    s_add_u32 s40, s31, 122880
    buffer_load_dwordx4 v2, s[16:19], s40 offen offset:0 sc1 lds
    buffer_load_dwordx4 v2, s[16:19], s40 offen offset:1024 sc1 lds
    s_waitcnt vmcnt(12)
    s_barrier
    s_add_u32 m0, s38, 65536
    s_add_u32 s40, s28, 98304
    buffer_load_dwordx4 v2, s[12:15], s40 offen offset:0 sc1 lds
    buffer_load_dwordx4 v2, s[12:15], s40 offen offset:1024 sc1 lds
    buffer_load_dwordx4 v2, s[12:15], s40 offen offset:2048 sc1 lds
    buffer_load_dwordx4 v2, s[12:15], s40 offen offset:3072 sc1 lds
    s_add_u32 m0, s42, 65536
    s_add_u32 s40, s31, 147456
    buffer_load_dwordx4 v2, s[16:19], s40 offen offset:0 sc1 lds
    buffer_load_dwordx4 v2, s[16:19], s40 offen offset:1024 sc1 lds
    s_waitcnt vmcnt(12)
    s_barrier
    s_add_u32 m0, s38, 98304
    s_add_u32 s40, s28, 114688
    buffer_load_dwordx4 v2, s[12:15], s40 offen offset:0 sc1 lds
    buffer_load_dwordx4 v2, s[12:15], s40 offen offset:1024 sc1 lds
    buffer_load_dwordx4 v2, s[12:15], s40 offen offset:2048 sc1 lds
    buffer_load_dwordx4 v2, s[12:15], s40 offen offset:3072 sc1 lds
    s_add_u32 m0, s42, 98304
    s_add_u32 s40, s31, 172032
    buffer_load_dwordx4 v2, s[16:19], s40 offen offset:0 sc1 lds
    buffer_load_dwordx4 v2, s[16:19], s40 offen offset:1024 sc1 lds
    s_waitcnt vmcnt(12)
    s_barrier
    s_add_u32 m0, s38, 0
    s_add_u32 s40, s28, 131072
    buffer_load_dwordx4 v2, s[12:15], s40 offen offset:0 sc1 lds
    buffer_load_dwordx4 v2, s[12:15], s40 offen offset:1024 sc1 lds
    buffer_load_dwordx4 v2, s[12:15], s40 offen offset:2048 sc1 lds
    buffer_load_dwordx4 v2, s[12:15], s40 offen offset:3072 sc1 lds
    s_add_u32 m0, s42, 0
    s_add_u32 s40, s31, 196608
    buffer_load_dwordx4 v2, s[16:19], s40 offen offset:0 sc1 lds
    buffer_load_dwordx4 v2, s[16:19], s40 offen offset:1024 sc1 lds
    s_waitcnt vmcnt(12)
    s_barrier
    s_add_u32 m0, s38, 32768
    s_add_u32 s40, s28, 147456
    buffer_load_dwordx4 v2, s[12:15], s40 offen offset:0 sc1 lds
    buffer_load_dwordx4 v2, s[12:15], s40 offen offset:1024 sc1 lds
    buffer_load_dwordx4 v2, s[12:15], s40 offen offset:2048 sc1 lds
    buffer_load_dwordx4 v2, s[12:15], s40 offen offset:3072 sc1 lds
    s_add_u32 m0, s42, 32768
    s_add_u32 s40, s31, 221184
    buffer_load_dwordx4 v2, s[16:19], s40 offen offset:0 sc1 lds
    buffer_load_dwordx4 v2, s[16:19], s40 offen offset:1024 sc1 lds
    s_waitcnt vmcnt(12)
    s_barrier
    s_add_u32 m0, s38, 65536
    s_add_u32 s40, s28, 163840
    buffer_load_dwordx4 v2, s[12:15], s40 offen offset:0 sc1 lds
    buffer_load_dwordx4 v2, s[12:15], s40 offen offset:1024 sc1 lds
    buffer_load_dwordx4 v2, s[12:15], s40 offen offset:2048 sc1 lds
    buffer_load_dwordx4 v2, s[12:15], s40 offen offset:3072 sc1 lds
    s_add_u32 m0, s42, 65536
    s_add_u32 s40, s31, 245760
    buffer_load_dwordx4 v2, s[16:19], s40 offen offset:0 sc1 lds
    buffer_load_dwordx4 v2, s[16:19], s40 offen offset:1024 sc1 lds
    s_waitcnt vmcnt(12)
    s_barrier
    s_add_u32 m0, s38, 98304
    s_add_u32 s40, s28, 180224
    buffer_load_dwordx4 v2, s[12:15], s40 offen offset:0 sc1 lds
    buffer_load_dwordx4 v2, s[12:15], s40 offen offset:1024 sc1 lds
    buffer_load_dwordx4 v2, s[12:15], s40 offen offset:2048 sc1 lds
    buffer_load_dwordx4 v2, s[12:15], s40 offen offset:3072 sc1 lds
    s_add_u32 m0, s42, 98304
    s_add_u32 s40, s31, 270336
    buffer_load_dwordx4 v2, s[16:19], s40 offen offset:0 sc1 lds
    buffer_load_dwordx4 v2, s[16:19], s40 offen offset:1024 sc1 lds
    s_waitcnt vmcnt(12)
    s_barrier
    s_cmp_lg_u32 s3, 4
    s_cbranch_scc1 p3gp_26
    s_lshl_b32 s56, s7, 8
    s_add_u32 s56, s56, 40960
    v_mov_b32 v40, s56
    s_mov_b64 exec, 1
    s_mov_b32 s57, 0
cgp_27:
    buffer_load_dword v41, v40, s[88:91], 0 offen sc1
    s_add_u32 s57, s57, 1
    s_cmp_gt_u32 s57, 30000
    s_cbranch_scc1 cgd_28
    s_waitcnt vmcnt(0)
    v_cmp_le_u32 vcc, 16, v41
    s_nop 1
    s_cmp_eq_u64 vcc, exec
    s_cbranch_scc0 cgp_27
cgd_28:
    s_mov_b64 exec, -1
p3gp_26:
    s_waitcnt vmcnt(6)
    s_barrier
    s_add_u32 s24, s64, 0x2400000
    s_addc_u32 s25, s65, 0
    s_mov_b32 s26, 0x22000
    s_mov_b32 s27, 0x20000
    s_lshl_b32 s50, s7, 1
    s_mul_i32 s50, s50, 4352
    s_lshl_b32 s51, s37, 10
    s_add_u32 s51, s51, s50
    s_add_u32 s52, s51, 0
    buffer_load_dwordx4 v[16:19], v2, s[24:27], s52 offen sc1
    s_add_u32 s52, s51, 4352
    buffer_load_dwordx4 v[20:23], v2, s[24:27], s52 offen sc1
    v_bfe_u32 v5, v1, 3, 1
    v_bfe_u32 v6, v1, 2, 1
    v_and_b32 v7, 3, v1
    v_mul_u32_u24 v8, 4352, v5
    v_lshl_add_u32 v8, v6, 6, v8
    v_lshl_add_u32 v8, v7, 4, v8
    s_add_u32 s52, s50, 4096
    s_mov_b64 exec, 0xffff
    buffer_load_dwordx4 v[24:27], v8, s[24:27], s52 offen sc1
    s_mov_b64 exec, -1
    v_lshlrev_b32 v10, 6, v5
    v_lshl_add_u32 v10, v7, 4, v10
    v_lshl_add_u32 v10, v6, 3, v10
    v_add_u32 v10, 161792, v10
    s_lshr_b32 s53, s37, 1
    s_lshl_b32 s53, s53, 10
    s_and_b32 s54, s37, 1
    s_lshl_b32 s54, s54, 3
    s_add_u32 s53, s53, s54
    s_add_u32 s53, s53, 157696
    v_add_u32 v11, s53, v2
    s_waitcnt vmcnt(3)
    s_barrier
    s_waitcnt vmcnt(0)
    v_cvt_pk_bf16_f32 v16, v16, v17
    v_cvt_pk_bf16_f32 v17, v18, v19
    ds_write_b64 v11, v[16:17] offset:0
    v_cvt_pk_bf16_f32 v20, v20, v21
    v_cvt_pk_bf16_f32 v21, v22, v23
    ds_write_b64 v11, v[20:21] offset:2048
    v_cvt_pk_bf16_f32 v24, v24, v25
    v_cvt_pk_bf16_f32 v25, v26, v27
    s_mov_b64 exec, 0xffff
    ds_write_b64 v10, v[24:25]
    s_mov_b64 exec, -1
    s_waitcnt lgkmcnt(0)
    s_barrier
    s_add_u32 s16, s64, 0x1800000
    s_addc_u32 s17, s65, 0
    s_mov_b32 s18, 0x200000
    s_mov_b32 s19, 0x20000
    s_sub_u32 s37, s3, 4
    v_and_b32 v1, 63, v0
    v_lshlrev_b32 v5, 4, v1
    s_bfe_u32 s29, s2, 0x10002
    s_lshl_b32 s29, s29, 2
    s_lshr_b32 s39, s2, 6
    s_add_u32 s29, s29, s39
    s_lshl_b32 s29, s29, 18
    s_lshl_b32 s39, s37, 12
    s_add_u32 s29, s29, s39
    s_add_u32 m0, s39, 8192
    s_add_u32 s40, s29, 0
    buffer_load_dwordx4 v5, s[16:19], s40 offen offset:0 sc1 lds
    buffer_load_dwordx4 v5, s[16:19], s40 offen offset:1024 sc1 lds
    buffer_load_dwordx4 v5, s[16:19], s40 offen offset:2048 sc1 lds
    buffer_load_dwordx4 v5, s[16:19], s40 offen offset:3072 sc1 lds
    s_add_u32 m0, s39, 32768
    s_add_u32 s40, s29, 16384
    buffer_load_dwordx4 v5, s[16:19], s40 offen offset:0 sc1 lds
    buffer_load_dwordx4 v5, s[16:19], s40 offen offset:1024 sc1 lds
    buffer_load_dwordx4 v5, s[16:19], s40 offen offset:2048 sc1 lds
    buffer_load_dwordx4 v5, s[16:19], s40 offen offset:3072 sc1 lds
    s_add_u32 m0, s39, 57344
    s_add_u32 s40, s29, 32768
    buffer_load_dwordx4 v5, s[16:19], s40 offen offset:0 sc1 lds
    buffer_load_dwordx4 v5, s[16:19], s40 offen offset:1024 sc1 lds
    buffer_load_dwordx4 v5, s[16:19], s40 offen offset:2048 sc1 lds
    buffer_load_dwordx4 v5, s[16:19], s40 offen offset:3072 sc1 lds
    s_add_u32 m0, s39, 81920
    s_add_u32 s40, s29, 49152
    buffer_load_dwordx4 v5, s[16:19], s40 offen offset:0 sc1 lds
    buffer_load_dwordx4 v5, s[16:19], s40 offen offset:1024 sc1 lds
    buffer_load_dwordx4 v5, s[16:19], s40 offen offset:2048 sc1 lds
    buffer_load_dwordx4 v5, s[16:19], s40 offen offset:3072 sc1 lds
    s_add_u32 m0, s39, 106496
    s_add_u32 s40, s29, 65536
    buffer_load_dwordx4 v5, s[16:19], s40 offen offset:0 sc1 lds
    buffer_load_dwordx4 v5, s[16:19], s40 offen offset:1024 sc1 lds
    buffer_load_dwordx4 v5, s[16:19], s40 offen offset:2048 sc1 lds
    buffer_load_dwordx4 v5, s[16:19], s40 offen offset:3072 sc1 lds
    s_branch p3end_24_nod
p3comp_23:
    v_and_b32 v1, 63, v0
    v_lshlrev_b32 v2, 4, v1
    s_lshr_b32 s37, s3, 1
    s_and_b32 s38, s3, 1
    s_lshl_b32 s39, s37, 13
    v_lshrrev_b32 v3, 4, v1
    v_bfe_u32 v4, v1, 2, 2
    v_lshl_add_u32 v5, v3, 3, v4
    v_lshlrev_b32 v5, 7, v5
    v_and_b32 v6, 3, v1
    v_lshl_add_u32 v5, v6, 3, v5
    v_bfe_u32 v6, v1, 3, 1
    v_bfe_u32 v7, v1, 4, 1
    v_lshl_or_b32 v6, v7, 1, v6
    s_lshl_b32 s40, s38, 1
    v_xor_b32 v7, s40, v6
    v_lshl_add_u32 v8, v7, 5, v5
    v_xor_b32 v7, 1, v7
    v_lshl_add_u32 v9, v7, 5, v5
    s_add_u32 s41, s39, 0
    v_add_u32 v16, s41, v2
    v_add_u32 v20, 16384, v8
    v_add_u32 v24, 16384, v9
    s_add_u32 s41, s39, 32768
    v_add_u32 v17, s41, v2
    v_add_u32 v21, 49152, v8
    v_add_u32 v25, 49152, v9
    s_add_u32 s41, s39, 65536
    v_add_u32 v18, s41, v2
    v_add_u32 v22, 81920, v8
    v_add_u32 v26, 81920, v9
    s_add_u32 s41, s39, 98304
    v_add_u32 v19, s41, v2
    v_add_u32 v23, 114688, v8
    v_add_u32 v27, 114688, v9
    v_lshlrev_b32 v10, 4, v3
    v_and_b32 v11, 15, v1
    v_lshlrev_b32 v11, 2, v11
    v_mov_b32 v92, 0
    v_mov_b32 v93, 0
    v_mov_b32 v94, 0
    v_mov_b32 v95, 0
    v_mov_b32 v96, 0
    v_mov_b32 v97, 0
    v_mov_b32 v98, 0
    v_mov_b32 v99, 0
    v_mov_b32 v100, 0
    v_mov_b32 v101, 0
    v_mov_b32 v102, 0
    v_mov_b32 v103, 0
    v_mov_b32 v104, 0
    v_mov_b32 v105, 0
    v_mov_b32 v106, 0
    v_mov_b32 v107, 0
    v_mov_b32 v108, 0
    v_mov_b32 v109, 0
    v_mov_b32 v110, 0
    v_mov_b32 v111, 0
    v_mov_b32 v112, 0
    v_mov_b32 v113, 0
    v_mov_b32 v114, 0
    v_mov_b32 v115, 0
    v_mov_b32 v116, 0
    v_mov_b32 v117, 0
    v_mov_b32 v118, 0
    v_mov_b32 v119, 0
    v_mov_b32 v120, 0
    v_mov_b32 v121, 0
    v_mov_b32 v122, 0
    v_mov_b32 v123, 0
    v_mov_b32 v124, 0
    v_mov_b32 v125, 0
    v_mov_b32 v126, 0
    v_mov_b32 v127, 0
    v_mov_b32 v128, 0
    v_mov_b32 v129, 0
    v_mov_b32 v130, 0
    v_mov_b32 v131, 0
    v_mov_b32 v132, 0
    v_mov_b32 v133, 0
    v_mov_b32 v134, 0
    v_mov_b32 v135, 0
    v_mov_b32 v136, 0
    v_mov_b32 v137, 0
    v_mov_b32 v138, 0
    v_mov_b32 v139, 0
    v_mov_b32 v140, 0
    v_mov_b32 v141, 0
    v_mov_b32 v142, 0
    v_mov_b32 v143, 0
    v_mov_b32 v144, 0
    v_mov_b32 v145, 0
    v_mov_b32 v146, 0
    v_mov_b32 v147, 0
    v_mov_b32 v148, 0
    v_mov_b32 v149, 0
    v_mov_b32 v150, 0
    v_mov_b32 v151, 0
    v_mov_b32 v152, 0
    v_mov_b32 v153, 0
    v_mov_b32 v154, 0
    v_mov_b32 v155, 0
    v_mov_b32 v156, 0
    v_mov_b32 v157, 0
    v_mov_b32 v158, 0
    v_mov_b32 v159, 0
    v_mov_b32 v160, 0
    v_mov_b32 v161, 0
    v_mov_b32 v162, 0
    v_mov_b32 v163, 0
    v_mov_b32 v164, 0
    v_mov_b32 v165, 0
    v_mov_b32 v166, 0
    v_mov_b32 v167, 0
    v_mov_b32 v168, 0
    v_mov_b32 v169, 0
    v_mov_b32 v170, 0
    v_mov_b32 v171, 0
    v_mov_b32 v172, 0
    v_mov_b32 v173, 0
    v_mov_b32 v174, 0
    v_mov_b32 v175, 0
    v_mov_b32 v176, 0
    v_mov_b32 v177, 0
    v_mov_b32 v178, 0
    v_mov_b32 v179, 0
    v_mov_b32 v180, 0
    v_mov_b32 v181, 0
    v_mov_b32 v182, 0
    v_mov_b32 v183, 0
    v_mov_b32 v184, 0
    v_mov_b32 v185, 0
    v_mov_b32 v186, 0
    v_mov_b32 v187, 0
    s_mov_b32 s44, 0x3fb8aa3b
    s_mov_b32 s45, 0x3fb8aa3b
    s_mov_b32 s46, 0x358637bd
    s_mov_b32 s47, 0x358637bd
    s_lshl_b32 s42, s37, 8
    s_add_u32 s42, s42, 131072
    v_add_u32 v12, s42, v10
    v_add_u32 v13, s42, v11
    s_lshl_b32 s42, s38, 7
    s_add_u32 s42, s42, 132096
    v_add_u32 v14, s42, v10
    v_add_u32 v15, s42, v11
    s_lshl_b32 s42, s38, 1
    s_add_u32 s42, s42, s37
    s_mul_i32 s42, s42, 6144
    s_add_u32 s42, s42, 133120
    v_add_u32 v3, s42, v2
    v_mov_b32 v60, 0
    v_mov_b32 v61, 0
    v_mov_b32 v62, 0
    v_mov_b32 v63, 0
    v_mov_b32 v64, 0
    v_mov_b32 v65, 0
    v_mov_b32 v66, 0
    v_mov_b32 v67, 0
    v_mov_b32 v68, 0
    v_mov_b32 v69, 0
    v_mov_b32 v70, 0
    v_mov_b32 v71, 0
    v_mov_b32 v72, 0
    v_mov_b32 v73, 0
    v_mov_b32 v74, 0
    v_mov_b32 v75, 0
    v_mov_b32 v76, 0
    v_mov_b32 v77, 0
    v_mov_b32 v78, 0
    v_mov_b32 v79, 0
    v_mov_b32 v80, 0
    v_mov_b32 v81, 0
    v_mov_b32 v82, 0
    v_mov_b32 v83, 0
    v_mov_b32 v84, 0
    v_mov_b32 v85, 0
    v_mov_b32 v86, 0
    v_mov_b32 v87, 0
    v_mov_b32 v88, 0
    v_mov_b32 v89, 0
    v_mov_b32 v90, 0
    v_mov_b32 v91, 0
    s_mov_b32 s43, 0
p3loop_29:
    s_barrier
    v_mfma_f32_16x16x32_bf16 v[92:95], v[60:63], v[76:79], v[92:95]
    ds_read_b128 v[28:31], v16 offset:0
    v_mfma_f32_16x16x32_bf16 v[108:111], v[64:67], v[76:79], v[108:111]
    ds_read_b128 v[32:35], v16 offset:2048
    v_mfma_f32_16x16x32_bf16 v[124:127], v[68:71], v[76:79], v[124:127]
    ds_read_b128 v[36:39], v16 offset:4096
    v_mfma_f32_16x16x32_bf16 v[140:143], v[72:75], v[76:79], v[140:143]
    ds_read_b128 v[40:43], v16 offset:6144
    v_mfma_f32_16x16x32_bf16 v[96:99], v[60:63], v[80:83], v[96:99]
    ds_read_b64_tr_b16 v[44:45], v20 offset:0
    v_mfma_f32_16x16x32_bf16 v[112:115], v[64:67], v[80:83], v[112:115]
    ds_read_b64_tr_b16 v[46:47], v20 offset:512
    v_mfma_f32_16x16x32_bf16 v[128:131], v[68:71], v[80:83], v[128:131]
    ds_read_b64_tr_b16 v[48:49], v24 offset:0
    v_mfma_f32_16x16x32_bf16 v[144:147], v[72:75], v[80:83], v[144:147]
    ds_read_b64_tr_b16 v[50:51], v24 offset:512
    v_mfma_f32_16x16x32_bf16 v[100:103], v[60:63], v[84:87], v[100:103]
    ds_read_b64_tr_b16 v[52:53], v20 offset:8192
    v_mfma_f32_16x16x32_bf16 v[116:119], v[64:67], v[84:87], v[116:119]
    ds_read_b64_tr_b16 v[54:55], v20 offset:8704
    v_mfma_f32_16x16x32_bf16 v[132:135], v[68:71], v[84:87], v[132:135]
    ds_read_b64_tr_b16 v[56:57], v24 offset:8192
    v_mfma_f32_16x16x32_bf16 v[148:151], v[72:75], v[84:87], v[148:151]
    ds_read_b64_tr_b16 v[58:59], v24 offset:8704
    v_mfma_f32_16x16x32_bf16 v[104:107], v[60:63], v[88:91], v[104:107]
    v_mfma_f32_16x16x32_bf16 v[120:123], v[64:67], v[88:91], v[120:123]
    v_mfma_f32_16x16x32_bf16 v[136:139], v[68:71], v[88:91], v[136:139]
    v_mfma_f32_16x16x32_bf16 v[152:155], v[72:75], v[88:91], v[152:155]
    s_waitcnt lgkmcnt(0)
    v_mfma_f32_16x16x32_bf16 v[92:95], v[28:31], v[44:47], v[92:95]
    ds_read_b128 v[60:63], v16 offset:1024
    v_mfma_f32_16x16x32_bf16 v[108:111], v[32:35], v[44:47], v[108:111]
    ds_read_b128 v[64:67], v16 offset:3072
    v_mfma_f32_16x16x32_bf16 v[124:127], v[36:39], v[44:47], v[124:127]
    ds_read_b128 v[68:71], v16 offset:5120
    v_mfma_f32_16x16x32_bf16 v[140:143], v[40:43], v[44:47], v[140:143]
    ds_read_b128 v[72:75], v16 offset:7168
    v_mfma_f32_16x16x32_bf16 v[96:99], v[28:31], v[48:51], v[96:99]
    ds_read_b64_tr_b16 v[76:77], v20 offset:4096
    v_mfma_f32_16x16x32_bf16 v[112:115], v[32:35], v[48:51], v[112:115]
    ds_read_b64_tr_b16 v[78:79], v20 offset:4608
    v_mfma_f32_16x16x32_bf16 v[128:131], v[36:39], v[48:51], v[128:131]
    ds_read_b64_tr_b16 v[80:81], v24 offset:4096
    v_mfma_f32_16x16x32_bf16 v[144:147], v[40:43], v[48:51], v[144:147]
    ds_read_b64_tr_b16 v[82:83], v24 offset:4608
    v_mfma_f32_16x16x32_bf16 v[100:103], v[28:31], v[52:55], v[100:103]
    ds_read_b64_tr_b16 v[84:85], v20 offset:12288
    v_mfma_f32_16x16x32_bf16 v[116:119], v[32:35], v[52:55], v[116:119]
    ds_read_b64_tr_b16 v[86:87], v20 offset:12800
    v_mfma_f32_16x16x32_bf16 v[132:135], v[36:39], v[52:55], v[132:135]
    ds_read_b64_tr_b16 v[88:89], v24 offset:12288
    v_mfma_f32_16x16x32_bf16 v[148:151], v[40:43], v[52:55], v[148:151]
    ds_read_b64_tr_b16 v[90:91], v24 offset:12800
    v_mfma_f32_16x16x32_bf16 v[104:107], v[28:31], v[56:59], v[104:107]
    v_mfma_f32_16x16x32_bf16 v[120:123], v[32:35], v[56:59], v[120:123]
    v_mfma_f32_16x16x32_bf16 v[136:139], v[36:39], v[56:59], v[136:139]
    v_mfma_f32_16x16x32_bf16 v[152:155], v[40:43], v[56:59], v[152:155]
    s_waitcnt lgkmcnt(0)
    s_barrier
    v_mfma_f32_16x16x32_bf16 v[92:95], v[60:63], v[76:79], v[92:95]
    ds_read_b128 v[28:31], v17 offset:0
    v_mfma_f32_16x16x32_bf16 v[108:111], v[64:67], v[76:79], v[108:111]
    ds_read_b128 v[32:35], v17 offset:2048
    v_mfma_f32_16x16x32_bf16 v[124:127], v[68:71], v[76:79], v[124:127]
    ds_read_b128 v[36:39], v17 offset:4096
    v_mfma_f32_16x16x32_bf16 v[140:143], v[72:75], v[76:79], v[140:143]
    ds_read_b128 v[40:43], v17 offset:6144
    v_mfma_f32_16x16x32_bf16 v[96:99], v[60:63], v[80:83], v[96:99]
    ds_read_b64_tr_b16 v[44:45], v21 offset:0
    v_mfma_f32_16x16x32_bf16 v[112:115], v[64:67], v[80:83], v[112:115]
    ds_read_b64_tr_b16 v[46:47], v21 offset:512
    v_mfma_f32_16x16x32_bf16 v[128:131], v[68:71], v[80:83], v[128:131]
    ds_read_b64_tr_b16 v[48:49], v25 offset:0
    v_mfma_f32_16x16x32_bf16 v[144:147], v[72:75], v[80:83], v[144:147]
    ds_read_b64_tr_b16 v[50:51], v25 offset:512
    v_mfma_f32_16x16x32_bf16 v[100:103], v[60:63], v[84:87], v[100:103]
    ds_read_b64_tr_b16 v[52:53], v21 offset:8192
    v_mfma_f32_16x16x32_bf16 v[116:119], v[64:67], v[84:87], v[116:119]
    ds_read_b64_tr_b16 v[54:55], v21 offset:8704
    v_mfma_f32_16x16x32_bf16 v[132:135], v[68:71], v[84:87], v[132:135]
    ds_read_b64_tr_b16 v[56:57], v25 offset:8192
    v_mfma_f32_16x16x32_bf16 v[148:151], v[72:75], v[84:87], v[148:151]
    ds_read_b64_tr_b16 v[58:59], v25 offset:8704
    v_mfma_f32_16x16x32_bf16 v[104:107], v[60:63], v[88:91], v[104:107]
    v_mfma_f32_16x16x32_bf16 v[120:123], v[64:67], v[88:91], v[120:123]
    v_mfma_f32_16x16x32_bf16 v[136:139], v[68:71], v[88:91], v[136:139]
    v_mfma_f32_16x16x32_bf16 v[152:155], v[72:75], v[88:91], v[152:155]
    s_waitcnt lgkmcnt(0)
    v_mfma_f32_16x16x32_bf16 v[92:95], v[28:31], v[44:47], v[92:95]
    ds_read_b128 v[60:63], v17 offset:1024
    v_mfma_f32_16x16x32_bf16 v[108:111], v[32:35], v[44:47], v[108:111]
    ds_read_b128 v[64:67], v17 offset:3072
    v_mfma_f32_16x16x32_bf16 v[124:127], v[36:39], v[44:47], v[124:127]
    ds_read_b128 v[68:71], v17 offset:5120
    v_mfma_f32_16x16x32_bf16 v[140:143], v[40:43], v[44:47], v[140:143]
    ds_read_b128 v[72:75], v17 offset:7168
    v_mfma_f32_16x16x32_bf16 v[96:99], v[28:31], v[48:51], v[96:99]
    ds_read_b64_tr_b16 v[76:77], v21 offset:4096
    v_mfma_f32_16x16x32_bf16 v[112:115], v[32:35], v[48:51], v[112:115]
    ds_read_b64_tr_b16 v[78:79], v21 offset:4608
    v_mfma_f32_16x16x32_bf16 v[128:131], v[36:39], v[48:51], v[128:131]
    ds_read_b64_tr_b16 v[80:81], v25 offset:4096
    v_mfma_f32_16x16x32_bf16 v[144:147], v[40:43], v[48:51], v[144:147]
    ds_read_b64_tr_b16 v[82:83], v25 offset:4608
    v_mfma_f32_16x16x32_bf16 v[100:103], v[28:31], v[52:55], v[100:103]
    ds_read_b64_tr_b16 v[84:85], v21 offset:12288
    v_mfma_f32_16x16x32_bf16 v[116:119], v[32:35], v[52:55], v[116:119]
    ds_read_b64_tr_b16 v[86:87], v21 offset:12800
    v_mfma_f32_16x16x32_bf16 v[132:135], v[36:39], v[52:55], v[132:135]
    ds_read_b64_tr_b16 v[88:89], v25 offset:12288
    v_mfma_f32_16x16x32_bf16 v[148:151], v[40:43], v[52:55], v[148:151]
    ds_read_b64_tr_b16 v[90:91], v25 offset:12800
    v_mfma_f32_16x16x32_bf16 v[104:107], v[28:31], v[56:59], v[104:107]
    v_mfma_f32_16x16x32_bf16 v[120:123], v[32:35], v[56:59], v[120:123]
    v_mfma_f32_16x16x32_bf16 v[136:139], v[36:39], v[56:59], v[136:139]
    v_mfma_f32_16x16x32_bf16 v[152:155], v[40:43], v[56:59], v[152:155]
    s_waitcnt lgkmcnt(0)
    s_barrier
    v_mfma_f32_16x16x32_bf16 v[92:95], v[60:63], v[76:79], v[92:95]
    ds_read_b128 v[28:31], v18 offset:0
    v_mfma_f32_16x16x32_bf16 v[108:111], v[64:67], v[76:79], v[108:111]
    ds_read_b128 v[32:35], v18 offset:2048
    v_mfma_f32_16x16x32_bf16 v[124:127], v[68:71], v[76:79], v[124:127]
    ds_read_b128 v[36:39], v18 offset:4096
    v_mfma_f32_16x16x32_bf16 v[140:143], v[72:75], v[76:79], v[140:143]
    ds_read_b128 v[40:43], v18 offset:6144
    v_mfma_f32_16x16x32_bf16 v[96:99], v[60:63], v[80:83], v[96:99]
    ds_read_b64_tr_b16 v[44:45], v22 offset:0
    v_mfma_f32_16x16x32_bf16 v[112:115], v[64:67], v[80:83], v[112:115]
    ds_read_b64_tr_b16 v[46:47], v22 offset:512
    v_mfma_f32_16x16x32_bf16 v[128:131], v[68:71], v[80:83], v[128:131]
    ds_read_b64_tr_b16 v[48:49], v26 offset:0
    v_mfma_f32_16x16x32_bf16 v[144:147], v[72:75], v[80:83], v[144:147]
    ds_read_b64_tr_b16 v[50:51], v26 offset:512
    v_mfma_f32_16x16x32_bf16 v[100:103], v[60:63], v[84:87], v[100:103]
    ds_read_b64_tr_b16 v[52:53], v22 offset:8192
    v_mfma_f32_16x16x32_bf16 v[116:119], v[64:67], v[84:87], v[116:119]
    ds_read_b64_tr_b16 v[54:55], v22 offset:8704
    v_mfma_f32_16x16x32_bf16 v[132:135], v[68:71], v[84:87], v[132:135]
    ds_read_b64_tr_b16 v[56:57], v26 offset:8192
    v_mfma_f32_16x16x32_bf16 v[148:151], v[72:75], v[84:87], v[148:151]
    ds_read_b64_tr_b16 v[58:59], v26 offset:8704
    v_mfma_f32_16x16x32_bf16 v[104:107], v[60:63], v[88:91], v[104:107]
    v_mfma_f32_16x16x32_bf16 v[120:123], v[64:67], v[88:91], v[120:123]
    v_mfma_f32_16x16x32_bf16 v[136:139], v[68:71], v[88:91], v[136:139]
    v_mfma_f32_16x16x32_bf16 v[152:155], v[72:75], v[88:91], v[152:155]
    s_waitcnt lgkmcnt(0)
    v_mfma_f32_16x16x32_bf16 v[92:95], v[28:31], v[44:47], v[92:95]
    ds_read_b128 v[60:63], v18 offset:1024
    v_mfma_f32_16x16x32_bf16 v[108:111], v[32:35], v[44:47], v[108:111]
    ds_read_b128 v[64:67], v18 offset:3072
    v_mfma_f32_16x16x32_bf16 v[124:127], v[36:39], v[44:47], v[124:127]
    ds_read_b128 v[68:71], v18 offset:5120
    v_mfma_f32_16x16x32_bf16 v[140:143], v[40:43], v[44:47], v[140:143]
    ds_read_b128 v[72:75], v18 offset:7168
    v_mfma_f32_16x16x32_bf16 v[96:99], v[28:31], v[48:51], v[96:99]
    ds_read_b64_tr_b16 v[76:77], v22 offset:4096
    v_mfma_f32_16x16x32_bf16 v[112:115], v[32:35], v[48:51], v[112:115]
    ds_read_b64_tr_b16 v[78:79], v22 offset:4608
    v_mfma_f32_16x16x32_bf16 v[128:131], v[36:39], v[48:51], v[128:131]
    ds_read_b64_tr_b16 v[80:81], v26 offset:4096
    v_mfma_f32_16x16x32_bf16 v[144:147], v[40:43], v[48:51], v[144:147]
    ds_read_b64_tr_b16 v[82:83], v26 offset:4608
    v_mfma_f32_16x16x32_bf16 v[100:103], v[28:31], v[52:55], v[100:103]
    ds_read_b64_tr_b16 v[84:85], v22 offset:12288
    v_mfma_f32_16x16x32_bf16 v[116:119], v[32:35], v[52:55], v[116:119]
    ds_read_b64_tr_b16 v[86:87], v22 offset:12800
    v_mfma_f32_16x16x32_bf16 v[132:135], v[36:39], v[52:55], v[132:135]
    ds_read_b64_tr_b16 v[88:89], v26 offset:12288
    v_mfma_f32_16x16x32_bf16 v[148:151], v[40:43], v[52:55], v[148:151]
    ds_read_b64_tr_b16 v[90:91], v26 offset:12800
    v_mfma_f32_16x16x32_bf16 v[104:107], v[28:31], v[56:59], v[104:107]
    v_mfma_f32_16x16x32_bf16 v[120:123], v[32:35], v[56:59], v[120:123]
    v_mfma_f32_16x16x32_bf16 v[136:139], v[36:39], v[56:59], v[136:139]
    v_mfma_f32_16x16x32_bf16 v[152:155], v[40:43], v[56:59], v[152:155]
    s_waitcnt lgkmcnt(0)
    s_barrier
    v_mfma_f32_16x16x32_bf16 v[92:95], v[60:63], v[76:79], v[92:95]
    ds_read_b128 v[28:31], v19 offset:0
    v_mfma_f32_16x16x32_bf16 v[108:111], v[64:67], v[76:79], v[108:111]
    ds_read_b128 v[32:35], v19 offset:2048
    v_mfma_f32_16x16x32_bf16 v[124:127], v[68:71], v[76:79], v[124:127]
    ds_read_b128 v[36:39], v19 offset:4096
    v_mfma_f32_16x16x32_bf16 v[140:143], v[72:75], v[76:79], v[140:143]
    ds_read_b128 v[40:43], v19 offset:6144
    v_mfma_f32_16x16x32_bf16 v[96:99], v[60:63], v[80:83], v[96:99]
    ds_read_b64_tr_b16 v[44:45], v23 offset:0
    v_mfma_f32_16x16x32_bf16 v[112:115], v[64:67], v[80:83], v[112:115]
    ds_read_b64_tr_b16 v[46:47], v23 offset:512
    v_mfma_f32_16x16x32_bf16 v[128:131], v[68:71], v[80:83], v[128:131]
    ds_read_b64_tr_b16 v[48:49], v27 offset:0
    v_mfma_f32_16x16x32_bf16 v[144:147], v[72:75], v[80:83], v[144:147]
    ds_read_b64_tr_b16 v[50:51], v27 offset:512
    v_mfma_f32_16x16x32_bf16 v[100:103], v[60:63], v[84:87], v[100:103]
    ds_read_b64_tr_b16 v[52:53], v23 offset:8192
    v_mfma_f32_16x16x32_bf16 v[116:119], v[64:67], v[84:87], v[116:119]
    ds_read_b64_tr_b16 v[54:55], v23 offset:8704
    v_mfma_f32_16x16x32_bf16 v[132:135], v[68:71], v[84:87], v[132:135]
    ds_read_b64_tr_b16 v[56:57], v27 offset:8192
    v_mfma_f32_16x16x32_bf16 v[148:151], v[72:75], v[84:87], v[148:151]
    ds_read_b64_tr_b16 v[58:59], v27 offset:8704
    v_mfma_f32_16x16x32_bf16 v[104:107], v[60:63], v[88:91], v[104:107]
    v_mfma_f32_16x16x32_bf16 v[120:123], v[64:67], v[88:91], v[120:123]
    v_mfma_f32_16x16x32_bf16 v[136:139], v[68:71], v[88:91], v[136:139]
    v_mfma_f32_16x16x32_bf16 v[152:155], v[72:75], v[88:91], v[152:155]
    s_waitcnt lgkmcnt(0)
    v_mfma_f32_16x16x32_bf16 v[92:95], v[28:31], v[44:47], v[92:95]
    ds_read_b128 v[60:63], v19 offset:1024
    v_mfma_f32_16x16x32_bf16 v[108:111], v[32:35], v[44:47], v[108:111]
    ds_read_b128 v[64:67], v19 offset:3072
    v_mfma_f32_16x16x32_bf16 v[124:127], v[36:39], v[44:47], v[124:127]
    ds_read_b128 v[68:71], v19 offset:5120
    v_mfma_f32_16x16x32_bf16 v[140:143], v[40:43], v[44:47], v[140:143]
    ds_read_b128 v[72:75], v19 offset:7168
    v_mfma_f32_16x16x32_bf16 v[96:99], v[28:31], v[48:51], v[96:99]
    ds_read_b64_tr_b16 v[76:77], v23 offset:4096
    v_mfma_f32_16x16x32_bf16 v[112:115], v[32:35], v[48:51], v[112:115]
    ds_read_b64_tr_b16 v[78:79], v23 offset:4608
    v_mfma_f32_16x16x32_bf16 v[128:131], v[36:39], v[48:51], v[128:131]
    ds_read_b64_tr_b16 v[80:81], v27 offset:4096
    v_mfma_f32_16x16x32_bf16 v[144:147], v[40:43], v[48:51], v[144:147]
    ds_read_b64_tr_b16 v[82:83], v27 offset:4608
    v_mfma_f32_16x16x32_bf16 v[100:103], v[28:31], v[52:55], v[100:103]
    ds_read_b64_tr_b16 v[84:85], v23 offset:12288
    v_mfma_f32_16x16x32_bf16 v[116:119], v[32:35], v[52:55], v[116:119]
    ds_read_b64_tr_b16 v[86:87], v23 offset:12800
    v_mfma_f32_16x16x32_bf16 v[132:135], v[36:39], v[52:55], v[132:135]
    ds_read_b64_tr_b16 v[88:89], v27 offset:12288
    v_mfma_f32_16x16x32_bf16 v[148:151], v[40:43], v[52:55], v[148:151]
    ds_read_b64_tr_b16 v[90:91], v27 offset:12800
    v_mfma_f32_16x16x32_bf16 v[104:107], v[28:31], v[56:59], v[104:107]
    v_mfma_f32_16x16x32_bf16 v[120:123], v[32:35], v[56:59], v[120:123]
    v_mfma_f32_16x16x32_bf16 v[136:139], v[36:39], v[56:59], v[136:139]
    v_mfma_f32_16x16x32_bf16 v[152:155], v[40:43], v[56:59], v[152:155]
    s_add_u32 s43, s43, 1
    s_waitcnt lgkmcnt(0)
    s_cmp_lt_u32 s43, 4
    s_cbranch_scc1 p3loop_29
    v_mfma_f32_16x16x32_bf16 v[92:95], v[60:63], v[76:79], v[92:95]
    v_mfma_f32_16x16x32_bf16 v[108:111], v[64:67], v[76:79], v[108:111]
    v_mfma_f32_16x16x32_bf16 v[124:127], v[68:71], v[76:79], v[124:127]
    v_mfma_f32_16x16x32_bf16 v[140:143], v[72:75], v[76:79], v[140:143]
    v_mfma_f32_16x16x32_bf16 v[96:99], v[60:63], v[80:83], v[96:99]
    v_mfma_f32_16x16x32_bf16 v[112:115], v[64:67], v[80:83], v[112:115]
    v_mfma_f32_16x16x32_bf16 v[128:131], v[68:71], v[80:83], v[128:131]
    v_mfma_f32_16x16x32_bf16 v[144:147], v[72:75], v[80:83], v[144:147]
    v_mfma_f32_16x16x32_bf16 v[100:103], v[60:63], v[84:87], v[100:103]
    v_mfma_f32_16x16x32_bf16 v[116:119], v[64:67], v[84:87], v[116:119]
    v_mfma_f32_16x16x32_bf16 v[132:135], v[68:71], v[84:87], v[132:135]
    v_mfma_f32_16x16x32_bf16 v[148:151], v[72:75], v[84:87], v[148:151]
    v_mfma_f32_16x16x32_bf16 v[104:107], v[60:63], v[88:91], v[104:107]
    v_mfma_f32_16x16x32_bf16 v[120:123], v[64:67], v[88:91], v[120:123]
    v_mfma_f32_16x16x32_bf16 v[136:139], v[68:71], v[88:91], v[136:139]
    v_mfma_f32_16x16x32_bf16 v[152:155], v[72:75], v[88:91], v[152:155]
    s_barrier
    ds_read_b128 v[208:211], v12 offset:0
    ds_read_b128 v[224:227], v12 offset:512
    ds_read_b32 v188, v13 offset:0
    ds_read_b32 v192, v13 offset:512
    ds_read_b128 v[212:215], v12 offset:64
    ds_read_b128 v[228:231], v12 offset:576
    ds_read_b32 v189, v13 offset:64
    ds_read_b32 v193, v13 offset:576
    ds_read_b128 v[216:219], v12 offset:128
    ds_read_b128 v[232:235], v12 offset:640
    ds_read_b32 v190, v13 offset:128
    ds_read_b32 v194, v13 offset:640
    ds_read_b128 v[220:223], v12 offset:192
    ds_read_b128 v[236:239], v12 offset:704
    ds_read_b32 v191, v13 offset:192
    ds_read_b32 v195, v13 offset:704
    ds_read_b128 v[196:199], v14 offset:0
    ds_read_b128 v[200:203], v14 offset:64
    ds_read_b32 v204, v15 offset:256
    ds_read_b32 v205, v15 offset:320
    ds_read_b32 v206, v15 offset:512
    ds_read_b32 v207, v15 offset:576
    s_waitcnt lgkmcnt(0)
    v_pk_mul_f32 v[52:53], v[224:225], v[204:205] op_sel:[0,0] op_sel_hi:[1,0]
    v_pk_fma_f32 v[92:93], v[92:93], v[208:209], v[52:53]
    v_pk_mul_f32 v[54:55], v[226:227], v[204:205] op_sel:[0,0] op_sel_hi:[1,0]
    v_pk_fma_f32 v[94:95], v[94:95], v[210:211], v[54:55]
    v_pk_mul_f32 v[56:57], v[224:225], v[204:205] op_sel:[0,1] op_sel_hi:[1,1]
    v_pk_fma_f32 v[96:97], v[96:97], v[208:209], v[56:57]
    v_pk_mul_f32 v[58:59], v[226:227], v[204:205] op_sel:[0,1] op_sel_hi:[1,1]
    v_pk_fma_f32 v[98:99], v[98:99], v[210:211], v[58:59]
    v_pk_mul_f32 v[52:53], v[224:225], v[206:207] op_sel:[0,0] op_sel_hi:[1,0]
    v_pk_fma_f32 v[100:101], v[100:101], v[208:209], v[52:53]
    v_pk_mul_f32 v[54:55], v[226:227], v[206:207] op_sel:[0,0] op_sel_hi:[1,0]
    v_pk_fma_f32 v[102:103], v[102:103], v[210:211], v[54:55]
    v_pk_mul_f32 v[56:57], v[224:225], v[206:207] op_sel:[0,1] op_sel_hi:[1,1]
    v_pk_fma_f32 v[104:105], v[104:105], v[208:209], v[56:57]
    v_pk_mul_f32 v[58:59], v[226:227], v[206:207] op_sel:[0,1] op_sel_hi:[1,1]
    v_pk_fma_f32 v[106:107], v[106:107], v[210:211], v[58:59]
    v_pk_mul_f32 v[52:53], v[228:229], v[204:205] op_sel:[0,0] op_sel_hi:[1,0]
    v_pk_fma_f32 v[108:109], v[108:109], v[212:213], v[52:53]
    v_pk_mul_f32 v[54:55], v[230:231], v[204:205] op_sel:[0,0] op_sel_hi:[1,0]
    v_pk_fma_f32 v[110:111], v[110:111], v[214:215], v[54:55]
    v_pk_mul_f32 v[56:57], v[228:229], v[204:205] op_sel:[0,1] op_sel_hi:[1,1]
    v_pk_fma_f32 v[112:113], v[112:113], v[212:213], v[56:57]
    v_pk_mul_f32 v[58:59], v[230:231], v[204:205] op_sel:[0,1] op_sel_hi:[1,1]
    v_pk_fma_f32 v[114:115], v[114:115], v[214:215], v[58:59]
    v_pk_mul_f32 v[52:53], v[228:229], v[206:207] op_sel:[0,0] op_sel_hi:[1,0]
    v_pk_fma_f32 v[116:117], v[116:117], v[212:213], v[52:53]
    v_pk_mul_f32 v[54:55], v[230:231], v[206:207] op_sel:[0,0] op_sel_hi:[1,0]
    v_pk_fma_f32 v[118:119], v[118:119], v[214:215], v[54:55]
    v_pk_mul_f32 v[56:57], v[228:229], v[206:207] op_sel:[0,1] op_sel_hi:[1,1]
    v_pk_fma_f32 v[120:121], v[120:121], v[212:213], v[56:57]
    v_pk_mul_f32 v[58:59], v[230:231], v[206:207] op_sel:[0,1] op_sel_hi:[1,1]
    v_pk_fma_f32 v[122:123], v[122:123], v[214:215], v[58:59]
    v_pk_mul_f32 v[52:53], v[232:233], v[204:205] op_sel:[0,0] op_sel_hi:[1,0]
    v_pk_fma_f32 v[124:125], v[124:125], v[216:217], v[52:53]
    v_pk_mul_f32 v[54:55], v[234:235], v[204:205] op_sel:[0,0] op_sel_hi:[1,0]
    v_pk_fma_f32 v[126:127], v[126:127], v[218:219], v[54:55]
    v_pk_mul_f32 v[56:57], v[232:233], v[204:205] op_sel:[0,1] op_sel_hi:[1,1]
    v_pk_fma_f32 v[128:129], v[128:129], v[216:217], v[56:57]
    v_pk_mul_f32 v[58:59], v[234:235], v[204:205] op_sel:[0,1] op_sel_hi:[1,1]
    v_pk_fma_f32 v[130:131], v[130:131], v[218:219], v[58:59]
    v_pk_mul_f32 v[52:53], v[232:233], v[206:207] op_sel:[0,0] op_sel_hi:[1,0]
    v_pk_fma_f32 v[132:133], v[132:133], v[216:217], v[52:53]
    v_pk_mul_f32 v[54:55], v[234:235], v[206:207] op_sel:[0,0] op_sel_hi:[1,0]
    v_pk_fma_f32 v[134:135], v[134:135], v[218:219], v[54:55]
    v_pk_mul_f32 v[56:57], v[232:233], v[206:207] op_sel:[0,1] op_sel_hi:[1,1]
    v_pk_fma_f32 v[136:137], v[136:137], v[216:217], v[56:57]
    v_pk_mul_f32 v[58:59], v[234:235], v[206:207] op_sel:[0,1] op_sel_hi:[1,1]
    v_pk_fma_f32 v[138:139], v[138:139], v[218:219], v[58:59]
    v_pk_mul_f32 v[52:53], v[236:237], v[204:205] op_sel:[0,0] op_sel_hi:[1,0]
    v_pk_fma_f32 v[140:141], v[140:141], v[220:221], v[52:53]
    v_pk_mul_f32 v[54:55], v[238:239], v[204:205] op_sel:[0,0] op_sel_hi:[1,0]
    v_pk_fma_f32 v[142:143], v[142:143], v[222:223], v[54:55]
    v_pk_mul_f32 v[56:57], v[236:237], v[204:205] op_sel:[0,1] op_sel_hi:[1,1]
    v_pk_fma_f32 v[144:145], v[144:145], v[220:221], v[56:57]
    v_pk_mul_f32 v[58:59], v[238:239], v[204:205] op_sel:[0,1] op_sel_hi:[1,1]
    v_pk_fma_f32 v[146:147], v[146:147], v[222:223], v[58:59]
    v_pk_mul_f32 v[52:53], v[236:237], v[206:207] op_sel:[0,0] op_sel_hi:[1,0]
    v_pk_fma_f32 v[148:149], v[148:149], v[220:221], v[52:53]
    v_pk_mul_f32 v[54:55], v[238:239], v[206:207] op_sel:[0,0] op_sel_hi:[1,0]
    v_pk_fma_f32 v[150:151], v[150:151], v[222:223], v[54:55]
    v_pk_mul_f32 v[56:57], v[236:237], v[206:207] op_sel:[0,1] op_sel_hi:[1,1]
    v_pk_fma_f32 v[152:153], v[152:153], v[220:221], v[56:57]
    v_pk_mul_f32 v[58:59], v[238:239], v[206:207] op_sel:[0,1] op_sel_hi:[1,1]
    v_pk_fma_f32 v[154:155], v[154:155], v[222:223], v[58:59]
    v_pk_mul_f32 v[52:53], v[92:93], s[44:45]
    v_min_f32 v52, 0, v52
    v_min_f32 v53, 0, v53
    v_exp_f32 v52, v52
    v_exp_f32 v53, v53
    v_max_f32 v92, 0, v92
    v_max_f32 v93, 0, v93
    v_pk_add_f32 v[92:93], v[92:93], s[46:47]
    v_pk_add_f32 v[92:93], v[92:93], v[52:53]
    v_pk_mul_f32 v[56:57], v[94:95], s[44:45]
    v_min_f32 v56, 0, v56
    v_min_f32 v57, 0, v57
    v_exp_f32 v56, v56
    v_exp_f32 v57, v57
    v_max_f32 v94, 0, v94
    v_max_f32 v95, 0, v95
    v_pk_add_f32 v[94:95], v[94:95], s[46:47]
    v_pk_add_f32 v[94:95], v[94:95], v[56:57]
    v_pk_mul_f32 v[52:53], v[96:97], s[44:45]
    v_min_f32 v52, 0, v52
    v_min_f32 v53, 0, v53
    v_exp_f32 v52, v52
    v_exp_f32 v53, v53
    v_max_f32 v96, 0, v96
    v_max_f32 v97, 0, v97
    v_pk_add_f32 v[96:97], v[96:97], s[46:47]
    v_pk_add_f32 v[96:97], v[96:97], v[52:53]
    v_pk_mul_f32 v[56:57], v[98:99], s[44:45]
    v_min_f32 v56, 0, v56
    v_min_f32 v57, 0, v57
    v_exp_f32 v56, v56
    v_exp_f32 v57, v57
    v_max_f32 v98, 0, v98
    v_max_f32 v99, 0, v99
    v_pk_add_f32 v[98:99], v[98:99], s[46:47]
    v_pk_add_f32 v[98:99], v[98:99], v[56:57]
    v_pk_mul_f32 v[52:53], v[108:109], s[44:45]
    v_min_f32 v52, 0, v52
    v_min_f32 v53, 0, v53
    v_exp_f32 v52, v52
    v_exp_f32 v53, v53
    v_max_f32 v108, 0, v108
    v_max_f32 v109, 0, v109
    v_pk_add_f32 v[108:109], v[108:109], s[46:47]
    v_pk_add_f32 v[108:109], v[108:109], v[52:53]
    v_pk_mul_f32 v[56:57], v[110:111], s[44:45]
    v_min_f32 v56, 0, v56
    v_min_f32 v57, 0, v57
    v_exp_f32 v56, v56
    v_exp_f32 v57, v57
    v_max_f32 v110, 0, v110
    v_max_f32 v111, 0, v111
    v_pk_add_f32 v[110:111], v[110:111], s[46:47]
    v_pk_add_f32 v[110:111], v[110:111], v[56:57]
    v_pk_mul_f32 v[52:53], v[112:113], s[44:45]
    v_min_f32 v52, 0, v52
    v_min_f32 v53, 0, v53
    v_exp_f32 v52, v52
    v_exp_f32 v53, v53
    v_max_f32 v112, 0, v112
    v_max_f32 v113, 0, v113
    v_pk_add_f32 v[112:113], v[112:113], s[46:47]
    v_pk_add_f32 v[112:113], v[112:113], v[52:53]
    v_pk_mul_f32 v[56:57], v[114:115], s[44:45]
    v_min_f32 v56, 0, v56
    v_min_f32 v57, 0, v57
    v_exp_f32 v56, v56
    v_exp_f32 v57, v57
    v_max_f32 v114, 0, v114
    v_max_f32 v115, 0, v115
    v_pk_add_f32 v[114:115], v[114:115], s[46:47]
    v_pk_add_f32 v[114:115], v[114:115], v[56:57]
    v_pk_mul_f32 v[52:53], v[124:125], s[44:45]
    v_min_f32 v52, 0, v52
    v_min_f32 v53, 0, v53
    v_exp_f32 v52, v52
    v_exp_f32 v53, v53
    v_max_f32 v124, 0, v124
    v_max_f32 v125, 0, v125
    v_pk_add_f32 v[124:125], v[124:125], s[46:47]
    v_pk_add_f32 v[124:125], v[124:125], v[52:53]
    v_pk_mul_f32 v[56:57], v[126:127], s[44:45]
    v_min_f32 v56, 0, v56
    v_min_f32 v57, 0, v57
    v_exp_f32 v56, v56
    v_exp_f32 v57, v57
    v_max_f32 v126, 0, v126
    v_max_f32 v127, 0, v127
    v_pk_add_f32 v[126:127], v[126:127], s[46:47]
    v_pk_add_f32 v[126:127], v[126:127], v[56:57]
    v_pk_mul_f32 v[52:53], v[128:129], s[44:45]
    v_min_f32 v52, 0, v52
    v_min_f32 v53, 0, v53
    v_exp_f32 v52, v52
    v_exp_f32 v53, v53
    v_max_f32 v128, 0, v128
    v_max_f32 v129, 0, v129
    v_pk_add_f32 v[128:129], v[128:129], s[46:47]
    v_pk_add_f32 v[128:129], v[128:129], v[52:53]
    v_pk_mul_f32 v[56:57], v[130:131], s[44:45]
    v_min_f32 v56, 0, v56
    v_min_f32 v57, 0, v57
    v_exp_f32 v56, v56
    v_exp_f32 v57, v57
    v_max_f32 v130, 0, v130
    v_max_f32 v131, 0, v131
    v_pk_add_f32 v[130:131], v[130:131], s[46:47]
    v_pk_add_f32 v[130:131], v[130:131], v[56:57]
    v_pk_mul_f32 v[52:53], v[140:141], s[44:45]
    v_min_f32 v52, 0, v52
    v_min_f32 v53, 0, v53
    v_exp_f32 v52, v52
    v_exp_f32 v53, v53
    v_max_f32 v140, 0, v140
    v_max_f32 v141, 0, v141
    v_pk_add_f32 v[140:141], v[140:141], s[46:47]
    v_pk_add_f32 v[140:141], v[140:141], v[52:53]
    v_pk_mul_f32 v[56:57], v[142:143], s[44:45]
    v_min_f32 v56, 0, v56
    v_min_f32 v57, 0, v57
    v_exp_f32 v56, v56
    v_exp_f32 v57, v57
    v_max_f32 v142, 0, v142
    v_max_f32 v143, 0, v143
    v_pk_add_f32 v[142:143], v[142:143], s[46:47]
    v_pk_add_f32 v[142:143], v[142:143], v[56:57]
    v_pk_mul_f32 v[52:53], v[144:145], s[44:45]
    v_min_f32 v52, 0, v52
    v_min_f32 v53, 0, v53
    v_exp_f32 v52, v52
    v_exp_f32 v53, v53
    v_max_f32 v144, 0, v144
    v_max_f32 v145, 0, v145
    v_pk_add_f32 v[144:145], v[144:145], s[46:47]
    v_pk_add_f32 v[144:145], v[144:145], v[52:53]
    v_pk_mul_f32 v[56:57], v[146:147], s[44:45]
    v_min_f32 v56, 0, v56
    v_min_f32 v57, 0, v57
    v_exp_f32 v56, v56
    v_exp_f32 v57, v57
    v_max_f32 v146, 0, v146
    v_max_f32 v147, 0, v147
    v_pk_add_f32 v[146:147], v[146:147], s[46:47]
    v_pk_add_f32 v[146:147], v[146:147], v[56:57]
    v_cvt_pk_bf16_f32 v208, v92, v93
    v_cvt_pk_bf16_f32 v209, v94, v95
    v_cvt_pk_bf16_f32 v224, v100, v101
    v_cvt_pk_bf16_f32 v225, v102, v103
    v_cvt_pk_bf16_f32 v210, v108, v109
    v_cvt_pk_bf16_f32 v211, v110, v111
    v_cvt_pk_bf16_f32 v226, v116, v117
    v_cvt_pk_bf16_f32 v227, v118, v119
    v_cvt_pk_bf16_f32 v212, v96, v97
    v_cvt_pk_bf16_f32 v213, v98, v99
    v_cvt_pk_bf16_f32 v228, v104, v105
    v_cvt_pk_bf16_f32 v229, v106, v107
    v_cvt_pk_bf16_f32 v214, v112, v113
    v_cvt_pk_bf16_f32 v215, v114, v115
    v_cvt_pk_bf16_f32 v230, v120, v121
    v_cvt_pk_bf16_f32 v231, v122, v123
    v_cvt_pk_bf16_f32 v216, v124, v125
    v_cvt_pk_bf16_f32 v217, v126, v127
    v_cvt_pk_bf16_f32 v232, v132, v133
    v_cvt_pk_bf16_f32 v233, v134, v135
    v_cvt_pk_bf16_f32 v218, v140, v141
    v_cvt_pk_bf16_f32 v219, v142, v143
    v_cvt_pk_bf16_f32 v234, v148, v149
    v_cvt_pk_bf16_f32 v235, v150, v151
    v_cvt_pk_bf16_f32 v220, v128, v129
    v_cvt_pk_bf16_f32 v221, v130, v131
    v_cvt_pk_bf16_f32 v236, v136, v137
    v_cvt_pk_bf16_f32 v237, v138, v139
    v_cvt_pk_bf16_f32 v222, v144, v145
    v_cvt_pk_bf16_f32 v223, v146, v147
    v_cvt_pk_bf16_f32 v238, v152, v153
    v_cvt_pk_bf16_f32 v239, v154, v155
    v_mov_b32 v84, 0x3f803f80
    v_mov_b32 v85, 0x3f803f80
    v_mov_b32 v86, 0x3f803f80
    v_mov_b32 v87, 0x3f803f80
    s_nop 1
    v_mfma_f32_16x16x32_bf16 v[92:95], v[208:211], v[224:227], 0
    v_mfma_f32_16x16x32_bf16 v[100:103], v[208:211], v[228:231], 0
    v_mfma_f32_16x16x32_bf16 v[108:111], v[208:211], v[84:87], 0
    v_mfma_f32_16x16x32_bf16 v[96:99], v[212:215], v[224:227], 0
    v_mfma_f32_16x16x32_bf16 v[104:107], v[212:215], v[228:231], 0
    v_mfma_f32_16x16x32_bf16 v[112:115], v[212:215], v[84:87], 0
    v_mfma_f32_16x16x32_bf16 v[92:95], v[216:219], v[232:235], v[92:95]
    v_mfma_f32_16x16x32_bf16 v[100:103], v[216:219], v[236:239], v[100:103]
    v_mfma_f32_16x16x32_bf16 v[108:111], v[216:219], v[84:87], v[108:111]
    v_mfma_f32_16x16x32_bf16 v[96:99], v[220:223], v[232:235], v[96:99]
    v_mfma_f32_16x16x32_bf16 v[104:107], v[220:223], v[236:239], v[104:107]
    v_mfma_f32_16x16x32_bf16 v[112:115], v[220:223], v[84:87], v[112:115]
    s_nop 3
    s_nop 3
    s_nop 3
    ds_write_b128 v3, v[92:95] offset:0
    ds_write_b128 v3, v[96:99] offset:1024
    ds_write_b128 v3, v[100:103] offset:2048
    ds_write_b128 v3, v[104:107] offset:3072
    ds_write_b128 v3, v[108:111] offset:4096
    ds_write_b128 v3, v[112:115] offset:5120
    s_waitcnt lgkmcnt(0)
    v_mov_b32 v60, 0
    v_mov_b32 v61, 0
    v_mov_b32 v62, 0
    v_mov_b32 v63, 0
    v_mov_b32 v64, 0
    v_mov_b32 v65, 0
    v_mov_b32 v66, 0
    v_mov_b32 v67, 0
    v_mov_b32 v68, 0
    v_mov_b32 v69, 0
    v_mov_b32 v70, 0
    v_mov_b32 v71, 0
    v_mov_b32 v72, 0
    v_mov_b32 v73, 0
    v_mov_b32 v74, 0
    v_mov_b32 v75, 0
    v_mov_b32 v76, 0
    v_mov_b32 v77, 0
    v_mov_b32 v78, 0
    v_mov_b32 v79, 0
    v_mov_b32 v80, 0
    v_mov_b32 v81, 0
    v_mov_b32 v82, 0
    v_mov_b32 v83, 0
    s_mov_b32 s43, 0
p3loop_30:
    s_barrier
    v_mfma_f32_16x16x32_bf16 v[156:159], v[76:79], v[60:63], v[156:159]
    ds_read_b128 v[28:31], v16 offset:0
    v_mfma_f32_16x16x32_bf16 v[164:167], v[76:79], v[64:67], v[164:167]
    ds_read_b128 v[32:35], v16 offset:2048
    v_mfma_f32_16x16x32_bf16 v[172:175], v[76:79], v[68:71], v[172:175]
    ds_read_b128 v[36:39], v16 offset:4096
    v_mfma_f32_16x16x32_bf16 v[180:183], v[76:79], v[72:75], v[180:183]
    ds_read_b128 v[40:43], v16 offset:6144
    v_mfma_f32_16x16x32_bf16 v[160:163], v[80:83], v[60:63], v[160:163]
    ds_read_b64_tr_b16 v[44:45], v20 offset:0
    v_mfma_f32_16x16x32_bf16 v[168:171], v[80:83], v[64:67], v[168:171]
    ds_read_b64_tr_b16 v[46:47], v20 offset:512
    v_mfma_f32_16x16x32_bf16 v[176:179], v[80:83], v[68:71], v[176:179]
    ds_read_b64_tr_b16 v[48:49], v24 offset:0
    v_mfma_f32_16x16x32_bf16 v[184:187], v[80:83], v[72:75], v[184:187]
    ds_read_b64_tr_b16 v[50:51], v24 offset:512
    s_waitcnt lgkmcnt(0)
    v_mfma_f32_16x16x32_bf16 v[156:159], v[44:47], v[28:31], v[156:159]
    ds_read_b128 v[60:63], v16 offset:1024
    v_mfma_f32_16x16x32_bf16 v[164:167], v[44:47], v[32:35], v[164:167]
    ds_read_b128 v[64:67], v16 offset:3072
    v_mfma_f32_16x16x32_bf16 v[172:175], v[44:47], v[36:39], v[172:175]
    ds_read_b128 v[68:71], v16 offset:5120
    v_mfma_f32_16x16x32_bf16 v[180:183], v[44:47], v[40:43], v[180:183]
    ds_read_b128 v[72:75], v16 offset:7168
    v_mfma_f32_16x16x32_bf16 v[160:163], v[48:51], v[28:31], v[160:163]
    ds_read_b64_tr_b16 v[76:77], v20 offset:4096
    v_mfma_f32_16x16x32_bf16 v[168:171], v[48:51], v[32:35], v[168:171]
    ds_read_b64_tr_b16 v[78:79], v20 offset:4608
    v_mfma_f32_16x16x32_bf16 v[176:179], v[48:51], v[36:39], v[176:179]
    ds_read_b64_tr_b16 v[80:81], v24 offset:4096
    v_mfma_f32_16x16x32_bf16 v[184:187], v[48:51], v[40:43], v[184:187]
    ds_read_b64_tr_b16 v[82:83], v24 offset:4608
    s_waitcnt lgkmcnt(0)
    s_barrier
    v_mfma_f32_16x16x32_bf16 v[156:159], v[76:79], v[60:63], v[156:159]
    ds_read_b128 v[28:31], v17 offset:0
    v_mfma_f32_16x16x32_bf16 v[164:167], v[76:79], v[64:67], v[164:167]
    ds_read_b128 v[32:35], v17 offset:2048
    v_mfma_f32_16x16x32_bf16 v[172:175], v[76:79], v[68:71], v[172:175]
    ds_read_b128 v[36:39], v17 offset:4096
    v_mfma_f32_16x16x32_bf16 v[180:183], v[76:79], v[72:75], v[180:183]
    ds_read_b128 v[40:43], v17 offset:6144
    v_mfma_f32_16x16x32_bf16 v[160:163], v[80:83], v[60:63], v[160:163]
    ds_read_b64_tr_b16 v[44:45], v21 offset:0
    v_mfma_f32_16x16x32_bf16 v[168:171], v[80:83], v[64:67], v[168:171]
    ds_read_b64_tr_b16 v[46:47], v21 offset:512
    v_mfma_f32_16x16x32_bf16 v[176:179], v[80:83], v[68:71], v[176:179]
    ds_read_b64_tr_b16 v[48:49], v25 offset:0
    v_mfma_f32_16x16x32_bf16 v[184:187], v[80:83], v[72:75], v[184:187]
    ds_read_b64_tr_b16 v[50:51], v25 offset:512
    s_waitcnt lgkmcnt(0)
    v_mfma_f32_16x16x32_bf16 v[156:159], v[44:47], v[28:31], v[156:159]
    ds_read_b128 v[60:63], v17 offset:1024
    v_mfma_f32_16x16x32_bf16 v[164:167], v[44:47], v[32:35], v[164:167]
    ds_read_b128 v[64:67], v17 offset:3072
    v_mfma_f32_16x16x32_bf16 v[172:175], v[44:47], v[36:39], v[172:175]
    ds_read_b128 v[68:71], v17 offset:5120
    v_mfma_f32_16x16x32_bf16 v[180:183], v[44:47], v[40:43], v[180:183]
    ds_read_b128 v[72:75], v17 offset:7168
    v_mfma_f32_16x16x32_bf16 v[160:163], v[48:51], v[28:31], v[160:163]
    ds_read_b64_tr_b16 v[76:77], v21 offset:4096
    v_mfma_f32_16x16x32_bf16 v[168:171], v[48:51], v[32:35], v[168:171]
    ds_read_b64_tr_b16 v[78:79], v21 offset:4608
    v_mfma_f32_16x16x32_bf16 v[176:179], v[48:51], v[36:39], v[176:179]
    ds_read_b64_tr_b16 v[80:81], v25 offset:4096
    v_mfma_f32_16x16x32_bf16 v[184:187], v[48:51], v[40:43], v[184:187]
    ds_read_b64_tr_b16 v[82:83], v25 offset:4608
    s_waitcnt lgkmcnt(0)
    s_barrier
    v_mfma_f32_16x16x32_bf16 v[156:159], v[76:79], v[60:63], v[156:159]
    ds_read_b128 v[28:31], v18 offset:0
    v_mfma_f32_16x16x32_bf16 v[164:167], v[76:79], v[64:67], v[164:167]
    ds_read_b128 v[32:35], v18 offset:2048
    v_mfma_f32_16x16x32_bf16 v[172:175], v[76:79], v[68:71], v[172:175]
    ds_read_b128 v[36:39], v18 offset:4096
    v_mfma_f32_16x16x32_bf16 v[180:183], v[76:79], v[72:75], v[180:183]
    ds_read_b128 v[40:43], v18 offset:6144
    v_mfma_f32_16x16x32_bf16 v[160:163], v[80:83], v[60:63], v[160:163]
    ds_read_b64_tr_b16 v[44:45], v22 offset:0
    v_mfma_f32_16x16x32_bf16 v[168:171], v[80:83], v[64:67], v[168:171]
    ds_read_b64_tr_b16 v[46:47], v22 offset:512
    v_mfma_f32_16x16x32_bf16 v[176:179], v[80:83], v[68:71], v[176:179]
    ds_read_b64_tr_b16 v[48:49], v26 offset:0
    v_mfma_f32_16x16x32_bf16 v[184:187], v[80:83], v[72:75], v[184:187]
    ds_read_b64_tr_b16 v[50:51], v26 offset:512
    s_waitcnt lgkmcnt(0)
    v_mfma_f32_16x16x32_bf16 v[156:159], v[44:47], v[28:31], v[156:159]
    ds_read_b128 v[60:63], v18 offset:1024
    v_mfma_f32_16x16x32_bf16 v[164:167], v[44:47], v[32:35], v[164:167]
    ds_read_b128 v[64:67], v18 offset:3072
    v_mfma_f32_16x16x32_bf16 v[172:175], v[44:47], v[36:39], v[172:175]
    ds_read_b128 v[68:71], v18 offset:5120
    v_mfma_f32_16x16x32_bf16 v[180:183], v[44:47], v[40:43], v[180:183]
    ds_read_b128 v[72:75], v18 offset:7168
    v_mfma_f32_16x16x32_bf16 v[160:163], v[48:51], v[28:31], v[160:163]
    ds_read_b64_tr_b16 v[76:77], v22 offset:4096
    v_mfma_f32_16x16x32_bf16 v[168:171], v[48:51], v[32:35], v[168:171]
    ds_read_b64_tr_b16 v[78:79], v22 offset:4608
    v_mfma_f32_16x16x32_bf16 v[176:179], v[48:51], v[36:39], v[176:179]
    ds_read_b64_tr_b16 v[80:81], v26 offset:4096
    v_mfma_f32_16x16x32_bf16 v[184:187], v[48:51], v[40:43], v[184:187]
    ds_read_b64_tr_b16 v[82:83], v26 offset:4608
    s_waitcnt lgkmcnt(0)
    s_barrier
    v_mfma_f32_16x16x32_bf16 v[156:159], v[76:79], v[60:63], v[156:159]
    ds_read_b128 v[28:31], v19 offset:0
    v_mfma_f32_16x16x32_bf16 v[164:167], v[76:79], v[64:67], v[164:167]
    ds_read_b128 v[32:35], v19 offset:2048
    v_mfma_f32_16x16x32_bf16 v[172:175], v[76:79], v[68:71], v[172:175]
    ds_read_b128 v[36:39], v19 offset:4096
    v_mfma_f32_16x16x32_bf16 v[180:183], v[76:79], v[72:75], v[180:183]
    ds_read_b128 v[40:43], v19 offset:6144
    v_mfma_f32_16x16x32_bf16 v[160:163], v[80:83], v[60:63], v[160:163]
    ds_read_b64_tr_b16 v[44:45], v23 offset:0
    v_mfma_f32_16x16x32_bf16 v[168:171], v[80:83], v[64:67], v[168:171]
    ds_read_b64_tr_b16 v[46:47], v23 offset:512
    v_mfma_f32_16x16x32_bf16 v[176:179], v[80:83], v[68:71], v[176:179]
    ds_read_b64_tr_b16 v[48:49], v27 offset:0
    v_mfma_f32_16x16x32_bf16 v[184:187], v[80:83], v[72:75], v[184:187]
    ds_read_b64_tr_b16 v[50:51], v27 offset:512
    s_waitcnt lgkmcnt(0)
    v_mfma_f32_16x16x32_bf16 v[156:159], v[44:47], v[28:31], v[156:159]
    ds_read_b128 v[60:63], v19 offset:1024
    v_mfma_f32_16x16x32_bf16 v[164:167], v[44:47], v[32:35], v[164:167]
    ds_read_b128 v[64:67], v19 offset:3072
    v_mfma_f32_16x16x32_bf16 v[172:175], v[44:47], v[36:39], v[172:175]
    ds_read_b128 v[68:71], v19 offset:5120
    v_mfma_f32_16x16x32_bf16 v[180:183], v[44:47], v[40:43], v[180:183]
    ds_read_b128 v[72:75], v19 offset:7168
    v_mfma_f32_16x16x32_bf16 v[160:163], v[48:51], v[28:31], v[160:163]
    ds_read_b64_tr_b16 v[76:77], v23 offset:4096
    v_mfma_f32_16x16x32_bf16 v[168:171], v[48:51], v[32:35], v[168:171]
    ds_read_b64_tr_b16 v[78:79], v23 offset:4608
    v_mfma_f32_16x16x32_bf16 v[176:179], v[48:51], v[36:39], v[176:179]
    ds_read_b64_tr_b16 v[80:81], v27 offset:4096
    v_mfma_f32_16x16x32_bf16 v[184:187], v[48:51], v[40:43], v[184:187]
    ds_read_b64_tr_b16 v[82:83], v27 offset:4608
    s_add_u32 s43, s43, 1
    s_waitcnt lgkmcnt(0)
    s_cmp_lt_u32 s43, 4
    s_cbranch_scc1 p3loop_30
    v_mfma_f32_16x16x32_bf16 v[156:159], v[76:79], v[60:63], v[156:159]
    v_mfma_f32_16x16x32_bf16 v[164:167], v[76:79], v[64:67], v[164:167]
    v_mfma_f32_16x16x32_bf16 v[172:175], v[76:79], v[68:71], v[172:175]
    v_mfma_f32_16x16x32_bf16 v[180:183], v[76:79], v[72:75], v[180:183]
    v_mfma_f32_16x16x32_bf16 v[160:163], v[80:83], v[60:63], v[160:163]
    v_mfma_f32_16x16x32_bf16 v[168:171], v[80:83], v[64:67], v[168:171]
    v_mfma_f32_16x16x32_bf16 v[176:179], v[80:83], v[68:71], v[176:179]
    v_mfma_f32_16x16x32_bf16 v[184:187], v[80:83], v[72:75], v[184:187]
    s_add_u32 s20, s64, 0x1c00000
    s_addc_u32 s21, s65, 0
    s_mov_b32 s22, 0x400000
    s_mov_b32 s23, 0x20000
    s_nop 4
    v_pk_mul_f32 v[28:29], v[196:197], v[192:193] op_sel:[0,0] op_sel_hi:[1,0]
    v_pk_fma_f32 v[156:157], v[156:157], v[188:189], v[28:29] op_sel:[0,0,0] op_sel_hi:[1,0,1]
    v_pk_mul_f32 v[28:29], v[198:199], v[192:193] op_sel:[0,0] op_sel_hi:[1,0]
    v_pk_fma_f32 v[158:159], v[158:159], v[188:189], v[28:29] op_sel:[0,0,0] op_sel_hi:[1,0,1]
    v_pk_mul_f32 v[28:29], v[200:201], v[192:193] op_sel:[0,0] op_sel_hi:[1,0]
    v_pk_fma_f32 v[160:161], v[160:161], v[188:189], v[28:29] op_sel:[0,0,0] op_sel_hi:[1,0,1]
    v_pk_mul_f32 v[28:29], v[202:203], v[192:193] op_sel:[0,0] op_sel_hi:[1,0]
    v_pk_fma_f32 v[162:163], v[162:163], v[188:189], v[28:29] op_sel:[0,0,0] op_sel_hi:[1,0,1]
    v_pk_mul_f32 v[28:29], v[196:197], v[192:193] op_sel:[0,1] op_sel_hi:[1,1]
    v_pk_fma_f32 v[164:165], v[164:165], v[188:189], v[28:29] op_sel:[0,1,0] op_sel_hi:[1,1,1]
    v_pk_mul_f32 v[28:29], v[198:199], v[192:193] op_sel:[0,1] op_sel_hi:[1,1]
    v_pk_fma_f32 v[166:167], v[166:167], v[188:189], v[28:29] op_sel:[0,1,0] op_sel_hi:[1,1,1]
    v_pk_mul_f32 v[28:29], v[200:201], v[192:193] op_sel:[0,1] op_sel_hi:[1,1]
    v_pk_fma_f32 v[168:169], v[168:169], v[188:189], v[28:29] op_sel:[0,1,0] op_sel_hi:[1,1,1]
    v_pk_mul_f32 v[28:29], v[202:203], v[192:193] op_sel:[0,1] op_sel_hi:[1,1]
    v_pk_fma_f32 v[170:171], v[170:171], v[188:189], v[28:29] op_sel:[0,1,0] op_sel_hi:[1,1,1]
    v_pk_mul_f32 v[28:29], v[196:197], v[194:195] op_sel:[0,0] op_sel_hi:[1,0]
    v_pk_fma_f32 v[172:173], v[172:173], v[190:191], v[28:29] op_sel:[0,0,0] op_sel_hi:[1,0,1]
    v_pk_mul_f32 v[28:29], v[198:199], v[194:195] op_sel:[0,0] op_sel_hi:[1,0]
    v_pk_fma_f32 v[174:175], v[174:175], v[190:191], v[28:29] op_sel:[0,0,0] op_sel_hi:[1,0,1]
    v_pk_mul_f32 v[28:29], v[200:201], v[194:195] op_sel:[0,0] op_sel_hi:[1,0]
    v_pk_fma_f32 v[176:177], v[176:177], v[190:191], v[28:29] op_sel:[0,0,0] op_sel_hi:[1,0,1]
    v_pk_mul_f32 v[28:29], v[202:203], v[194:195] op_sel:[0,0] op_sel_hi:[1,0]
    v_pk_fma_f32 v[178:179], v[178:179], v[190:191], v[28:29] op_sel:[0,0,0] op_sel_hi:[1,0,1]
    v_pk_mul_f32 v[28:29], v[196:197], v[194:195] op_sel:[0,1] op_sel_hi:[1,1]
    v_pk_fma_f32 v[180:181], v[180:181], v[190:191], v[28:29] op_sel:[0,1,0] op_sel_hi:[1,1,1]
    v_pk_mul_f32 v[28:29], v[198:199], v[194:195] op_sel:[0,1] op_sel_hi:[1,1]
    v_pk_fma_f32 v[182:183], v[182:183], v[190:191], v[28:29] op_sel:[0,1,0] op_sel_hi:[1,1,1]
    v_pk_mul_f32 v[28:29], v[200:201], v[194:195] op_sel:[0,1] op_sel_hi:[1,1]
    v_pk_fma_f32 v[184:185], v[184:185], v[190:191], v[28:29] op_sel:[0,1,0] op_sel_hi:[1,1,1]
    v_pk_mul_f32 v[28:29], v[202:203], v[194:195] op_sel:[0,1] op_sel_hi:[1,1]
    v_pk_fma_f32 v[186:187], v[186:187], v[190:191], v[28:29] op_sel:[0,1,0] op_sel_hi:[1,1,1]
    v_pk_mul_f32 v[28:29], v[156:157], s[44:45]
    v_min_f32 v28, 0, v28
    v_min_f32 v29, 0, v29
    v_exp_f32 v28, v28
    v_exp_f32 v29, v29
    v_max_f32 v156, 0, v156
    v_max_f32 v157, 0, v157
    v_pk_add_f32 v[156:157], v[156:157], s[46:47]
    v_pk_add_f32 v[156:157], v[156:157], v[28:29]
    v_pk_mul_f32 v[32:33], v[158:159], s[44:45]
    v_min_f32 v32, 0, v32
    v_min_f32 v33, 0, v33
    v_exp_f32 v32, v32
    v_exp_f32 v33, v33
    v_max_f32 v158, 0, v158
    v_max_f32 v159, 0, v159
    v_pk_add_f32 v[158:159], v[158:159], s[46:47]
    v_pk_add_f32 v[158:159], v[158:159], v[32:33]
    v_pk_mul_f32 v[28:29], v[160:161], s[44:45]
    v_min_f32 v28, 0, v28
    v_min_f32 v29, 0, v29
    v_exp_f32 v28, v28
    v_exp_f32 v29, v29
    v_max_f32 v160, 0, v160
    v_max_f32 v161, 0, v161
    v_pk_add_f32 v[160:161], v[160:161], s[46:47]
    v_pk_add_f32 v[160:161], v[160:161], v[28:29]
    v_pk_mul_f32 v[32:33], v[162:163], s[44:45]
    v_min_f32 v32, 0, v32
    v_min_f32 v33, 0, v33
    v_exp_f32 v32, v32
    v_exp_f32 v33, v33
    v_max_f32 v162, 0, v162
    v_max_f32 v163, 0, v163
    v_pk_add_f32 v[162:163], v[162:163], s[46:47]
    v_pk_add_f32 v[162:163], v[162:163], v[32:33]
    v_cvt_pk_bf16_f32 v36, v156, v157
    v_cvt_pk_bf16_f32 v37, v158, v159
    v_cvt_pk_bf16_f32 v38, v160, v161
    v_cvt_pk_bf16_f32 v39, v162, v163
    v_pk_mul_f32 v[28:29], v[164:165], s[44:45]
    v_min_f32 v28, 0, v28
    v_min_f32 v29, 0, v29
    v_exp_f32 v28, v28
    v_exp_f32 v29, v29
    v_max_f32 v164, 0, v164
    v_max_f32 v165, 0, v165
    v_pk_add_f32 v[164:165], v[164:165], s[46:47]
    v_pk_add_f32 v[164:165], v[164:165], v[28:29]
    v_pk_mul_f32 v[32:33], v[166:167], s[44:45]
    v_min_f32 v32, 0, v32
    v_min_f32 v33, 0, v33
    v_exp_f32 v32, v32
    v_exp_f32 v33, v33
    v_max_f32 v166, 0, v166
    v_max_f32 v167, 0, v167
    v_pk_add_f32 v[166:167], v[166:167], s[46:47]
    v_pk_add_f32 v[166:167], v[166:167], v[32:33]
    v_pk_mul_f32 v[28:29], v[168:169], s[44:45]
    v_min_f32 v28, 0, v28
    v_min_f32 v29, 0, v29
    v_exp_f32 v28, v28
    v_exp_f32 v29, v29
    v_max_f32 v168, 0, v168
    v_max_f32 v169, 0, v169
    v_pk_add_f32 v[168:169], v[168:169], s[46:47]
    v_pk_add_f32 v[168:169], v[168:169], v[28:29]
    v_pk_mul_f32 v[32:33], v[170:171], s[44:45]
    v_min_f32 v32, 0, v32
    v_min_f32 v33, 0, v33
    v_exp_f32 v32, v32
    v_exp_f32 v33, v33
    v_max_f32 v170, 0, v170
    v_max_f32 v171, 0, v171
    v_pk_add_f32 v[170:171], v[170:171], s[46:47]
    v_pk_add_f32 v[170:171], v[170:171], v[32:33]
    v_cvt_pk_bf16_f32 v40, v164, v165
    v_cvt_pk_bf16_f32 v41, v166, v167
    v_cvt_pk_bf16_f32 v42, v168, v169
    v_cvt_pk_bf16_f32 v43, v170, v171
    v_pk_mul_f32 v[28:29], v[172:173], s[44:45]
    v_min_f32 v28, 0, v28
    v_min_f32 v29, 0, v29
    v_exp_f32 v28, v28
    v_exp_f32 v29, v29
    v_max_f32 v172, 0, v172
    v_max_f32 v173, 0, v173
    v_pk_add_f32 v[172:173], v[172:173], s[46:47]
    v_pk_add_f32 v[172:173], v[172:173], v[28:29]
    v_pk_mul_f32 v[32:33], v[174:175], s[44:45]
    v_min_f32 v32, 0, v32
    v_min_f32 v33, 0, v33
    v_exp_f32 v32, v32
    v_exp_f32 v33, v33
    v_max_f32 v174, 0, v174
    v_max_f32 v175, 0, v175
    v_pk_add_f32 v[174:175], v[174:175], s[46:47]
    v_pk_add_f32 v[174:175], v[174:175], v[32:33]
    v_pk_mul_f32 v[28:29], v[176:177], s[44:45]
    v_min_f32 v28, 0, v28
    v_min_f32 v29, 0, v29
    v_exp_f32 v28, v28
    v_exp_f32 v29, v29
    v_max_f32 v176, 0, v176
    v_max_f32 v177, 0, v177
    v_pk_add_f32 v[176:177], v[176:177], s[46:47]
    v_pk_add_f32 v[176:177], v[176:177], v[28:29]
    v_pk_mul_f32 v[32:33], v[178:179], s[44:45]
    v_min_f32 v32, 0, v32
    v_min_f32 v33, 0, v33
    v_exp_f32 v32, v32
    v_exp_f32 v33, v33
    v_max_f32 v178, 0, v178
    v_max_f32 v179, 0, v179
    v_pk_add_f32 v[178:179], v[178:179], s[46:47]
    v_pk_add_f32 v[178:179], v[178:179], v[32:33]
    v_cvt_pk_bf16_f32 v44, v172, v173
    v_cvt_pk_bf16_f32 v45, v174, v175
    v_cvt_pk_bf16_f32 v46, v176, v177
    v_cvt_pk_bf16_f32 v47, v178, v179
    v_pk_mul_f32 v[28:29], v[180:181], s[44:45]
    v_min_f32 v28, 0, v28
    v_min_f32 v29, 0, v29
    v_exp_f32 v28, v28
    v_exp_f32 v29, v29
    v_max_f32 v180, 0, v180
    v_max_f32 v181, 0, v181
    v_pk_add_f32 v[180:181], v[180:181], s[46:47]
    v_pk_add_f32 v[180:181], v[180:181], v[28:29]
    v_pk_mul_f32 v[32:33], v[182:183], s[44:45]
    v_min_f32 v32, 0, v32
    v_min_f32 v33, 0, v33
    v_exp_f32 v32, v32
    v_exp_f32 v33, v33
    v_max_f32 v182, 0, v182
    v_max_f32 v183, 0, v183
    v_pk_add_f32 v[182:183], v[182:183], s[46:47]
    v_pk_add_f32 v[182:183], v[182:183], v[32:33]
    v_pk_mul_f32 v[28:29], v[184:185], s[44:45]
    v_min_f32 v28, 0, v28
    v_min_f32 v29, 0, v29
    v_exp_f32 v28, v28
    v_exp_f32 v29, v29
    v_max_f32 v184, 0, v184
    v_max_f32 v185, 0, v185
    v_pk_add_f32 v[184:185], v[184:185], s[46:47]
    v_pk_add_f32 v[184:185], v[184:185], v[28:29]
    v_pk_mul_f32 v[32:33], v[186:187], s[44:45]
    v_min_f32 v32, 0, v32
    v_min_f32 v33, 0, v33
    v_exp_f32 v32, v32
    v_exp_f32 v33, v33
    v_max_f32 v186, 0, v186
    v_max_f32 v187, 0, v187
    v_pk_add_f32 v[186:187], v[186:187], s[46:47]
    v_pk_add_f32 v[186:187], v[186:187], v[32:33]
    v_cvt_pk_bf16_f32 v48, v180, v181
    v_cvt_pk_bf16_f32 v49, v182, v183
    v_cvt_pk_bf16_f32 v50, v184, v185
    v_cvt_pk_bf16_f32 v51, v186, v187
    s_lshl_b32 s41, s6, 4
    s_add_u32 s41, s41, s7
    s_lshl_b32 s41, s41, 14
    s_lshl_b32 s42, s37, 13
    s_add_u32 s41, s41, s42
    s_lshl_b32 s42, s38, 10
    s_add_u32 s41, s41, s42
    s_lshl_b32 s42, s38, 11
    s_add_u32 s42, s42, 157696
    v_add_u32 v12, s42, v2
    s_lshl_b32 s42, s38, 6
    s_add_u32 s42, s42, 161792
    v_add_u32 v13, s42, v10
    v_mov_b32 v52, 0x358637bd
    v_mov_b32 v53, 0x358637bd
    v_mov_b32 v54, 0x358637bd
    v_mov_b32 v55, 0x358637bd
    s_barrier
    ds_read_b128 v[56:59], v12
    ds_read_b128 v[60:63], v12 offset:1024
    ds_read_b128 v[64:67], v13
    s_waitcnt lgkmcnt(0)
    v_mfma_f32_16x16x32_bf16 v[100:103], v[64:67], v[36:39], v[52:55]
    v_mfma_f32_16x16x32_bf16 v[92:95], v[56:59], v[36:39], 0
    v_mfma_f32_16x16x32_bf16 v[96:99], v[60:63], v[36:39], 0
    v_mfma_f32_16x16x32_bf16 v[112:115], v[64:67], v[40:43], v[52:55]
    v_mfma_f32_16x16x32_bf16 v[104:107], v[56:59], v[40:43], 0
    v_mfma_f32_16x16x32_bf16 v[108:111], v[60:63], v[40:43], 0
    v_mfma_f32_16x16x32_bf16 v[124:127], v[64:67], v[44:47], v[52:55]
    v_mfma_f32_16x16x32_bf16 v[116:119], v[56:59], v[44:47], 0
    v_mfma_f32_16x16x32_bf16 v[120:123], v[60:63], v[44:47], 0
    v_mfma_f32_16x16x32_bf16 v[136:139], v[64:67], v[48:51], v[52:55]
    v_mfma_f32_16x16x32_bf16 v[128:131], v[56:59], v[48:51], 0
    v_mfma_f32_16x16x32_bf16 v[132:135], v[60:63], v[48:51], 0
    s_nop 7
    v_rcp_f32 v100, v100
    v_rcp_f32 v112, v112
    v_rcp_f32 v124, v124
    v_rcp_f32 v136, v136
    v_pk_mul_f32 v[92:93], v[92:93], v[100:101] op_sel_hi:[1,0]
    v_pk_mul_f32 v[94:95], v[94:95], v[100:101] op_sel_hi:[1,0]
    v_pk_mul_f32 v[96:97], v[96:97], v[100:101] op_sel_hi:[1,0]
    v_pk_mul_f32 v[98:99], v[98:99], v[100:101] op_sel_hi:[1,0]
    v_cvt_pk_bf16_f32 v36, v92, v93
    v_cvt_pk_bf16_f32 v37, v94, v95
    v_cvt_pk_bf16_f32 v38, v96, v97
    v_cvt_pk_bf16_f32 v39, v98, v99
    s_add_u32 s42, s41, 0
    buffer_store_dwordx4 v[36:39], v2, s[20:23], s42 offen sc1
    v_pk_mul_f32 v[104:105], v[104:105], v[112:113] op_sel_hi:[1,0]
    v_pk_mul_f32 v[106:107], v[106:107], v[112:113] op_sel_hi:[1,0]
    v_pk_mul_f32 v[108:109], v[108:109], v[112:113] op_sel_hi:[1,0]
    v_pk_mul_f32 v[110:111], v[110:111], v[112:113] op_sel_hi:[1,0]
    v_cvt_pk_bf16_f32 v40, v104, v105
    v_cvt_pk_bf16_f32 v41, v106, v107
    v_cvt_pk_bf16_f32 v42, v108, v109
    v_cvt_pk_bf16_f32 v43, v110, v111
    s_add_u32 s42, s41, 2048
    buffer_store_dwordx4 v[40:43], v2, s[20:23], s42 offen sc1
    v_pk_mul_f32 v[116:117], v[116:117], v[124:125] op_sel_hi:[1,0]
    v_pk_mul_f32 v[118:119], v[118:119], v[124:125] op_sel_hi:[1,0]
    v_pk_mul_f32 v[120:121], v[120:121], v[124:125] op_sel_hi:[1,0]
    v_pk_mul_f32 v[122:123], v[122:123], v[124:125] op_sel_hi:[1,0]
    v_cvt_pk_bf16_f32 v44, v116, v117
    v_cvt_pk_bf16_f32 v45, v118, v119
    v_cvt_pk_bf16_f32 v46, v120, v121
    v_cvt_pk_bf16_f32 v47, v122, v123
    s_add_u32 s42, s41, 4096
    buffer_store_dwordx4 v[44:47], v2, s[20:23], s42 offen sc1
    v_pk_mul_f32 v[128:129], v[128:129], v[136:137] op_sel_hi:[1,0]
    v_pk_mul_f32 v[130:131], v[130:131], v[136:137] op_sel_hi:[1,0]
    v_pk_mul_f32 v[132:133], v[132:133], v[136:137] op_sel_hi:[1,0]
    v_pk_mul_f32 v[134:135], v[134:135], v[136:137] op_sel_hi:[1,0]
    v_cvt_pk_bf16_f32 v48, v128, v129
    v_cvt_pk_bf16_f32 v49, v130, v131
    v_cvt_pk_bf16_f32 v50, v132, v133
    v_cvt_pk_bf16_f32 v51, v134, v135
    s_add_u32 s42, s41, 6144
    buffer_store_dwordx4 v[48:51], v2, s[20:23], s42 offen sc1
    s_waitcnt vmcnt(0)
p3end_24_nod:
    s_waitcnt lgkmcnt(0)
    s_barrier
    s_cmp_lg_u32 s3, 0
    s_cbranch_scc1 arr_31
    s_lshl_b32 s56, s6, 8
    s_add_u32 s56, s56, 8192
    v_mov_b32 v250, s56
    v_mov_b32 v251, 1
    s_mov_b64 exec, 1
    buffer_atomic_add v251, v250, s[88:91], 0 offen sc1
    s_mov_b64 exec, -1
arr_31:
    s_and_b32 s4, s2, 7
    s_lshr_b32 s5, s2, 3
    s_and_b32 s6, s4, 3
    s_lshl_b32 s6, s6, 3
    s_and_b32 s7, s5, 7
    s_add_u32 s6, s6, s7
    s_lshr_b32 s7, s4, 2
    s_lshl_b32 s7, s7, 2
    s_lshr_b32 s8, s5, 3
    s_add_u32 s7, s7, s8
    s_cmp_ge_u32 s3, 4
    s_cbranch_scc1 p4pre_33
    s_add_u32 s20, s64, 0x800000
    s_addc_u32 s21, s65, 0
    s_mov_b32 s22, 0x400000
    s_mov_b32 s23, 0x20000
    v_and_b32 v1, 63, v0
    v_lshlrev_b32 v2, 4, v1
    v_and_b32 v3, 15, v1
    v_lshrrev_b32 v4, 4, v1
    s_lshr_b32 s37, s3, 1
    s_and_b32 s38, s3, 1
    v_and_b32 v5, 1, v4
    v_lshlrev_b32 v5, 1, v5
    v_lshrrev_b32 v6, 1, v4
    v_add_u32 v5, v5, v6
    v_lshlrev_b32 v5, 8, v5
    v_lshl_add_u32 v5, v3, 4, v5
    s_lshr_b32 s44, s6, 1
    s_lshl_b32 s44, s44, 18
    s_lshl_b32 s45, s7, 1
    s_add_u32 s45, s45, s38
    s_lshl_b32 s45, s45, 14
    s_add_u32 s44, s44, s45
    s_and_b32 s45, s6, 1
    s_lshl_b32 s45, s45, 13
    s_add_u32 s44, s44, s45
    s_lshl_b32 s45, s37, 12
    s_add_u32 s44, s44, s45
    buffer_load_dwordx4 v[96:99], v5, s[20:23], s44 offen offset:0 sc1
    buffer_load_dwordx4 v[100:103], v5, s[20:23], s44 offen offset:1024 sc1
    buffer_load_dwordx4 v[104:107], v5, s[20:23], s44 offen offset:2048 sc1
    buffer_load_dwordx4 v[108:111], v5, s[20:23], s44 offen offset:3072 sc1
    s_add_u32 s16, s64, 0x400000
    s_addc_u32 s17, s65, 0
    s_mov_b32 s18, 0x400000
    s_mov_b32 s19, 0x20000
    v_lshlrev_b32 v15, 3, v3
    v_sub_u32 v15, v5, v15
    buffer_load_dwordx2 v[112:113], v15, s[16:19], s44 offen offset:0 sc1
    buffer_load_dwordx2 v[114:115], v15, s[16:19], s44 offen offset:128 sc1
    buffer_load_dwordx2 v[116:117], v15, s[16:19], s44 offen offset:1024 sc1
    buffer_load_dwordx2 v[118:119], v15, s[16:19], s44 offen offset:1152 sc1
    buffer_load_dwordx2 v[120:121], v15, s[16:19], s44 offen offset:2048 sc1
    buffer_load_dwordx2 v[122:123], v15, s[16:19], s44 offen offset:2176 sc1
    buffer_load_dwordx2 v[124:125], v15, s[16:19], s44 offen offset:3072 sc1
    buffer_load_dwordx2 v[126:127], v15, s[16:19], s44 offen offset:3200 sc1
    s_branch p4pre_32
p4pre_33:
    s_add_u32 s12, s64, 0x1c00000
    s_addc_u32 s13, s65, 0
    s_mov_b32 s14, 0x400000
    s_mov_b32 s15, 0x20000
    s_lshr_b32 s28, s6, 1
    s_lshl_b32 s28, s28, 18
    s_and_b32 s40, s6, 1
    s_lshl_b32 s40, s40, 13
    s_add_u32 s28, s28, s40
    s_lshl_b32 s41, s37, 11
    s_add_u32 s28, s28, s41
p4pre_32:
    s_lshr_b32 s9, s6, 1
    s_cmp_lg_u32 s3, 0
    s_cbranch_scc1 wt_34
    v_and_b32 v250, 63, v0
    v_lshlrev_b32 v250, 8, v250
    s_lshl_b32 s56, s9, 8
    s_add_u32 s56, s56, 8192
    v_add_u32 v250, s56, v250
    s_mov_b64 exec, 0x1
    s_mov_b32 s57, 0
wp_35:
    buffer_load_dword v251, v250, s[88:91], 0 offen sc1
    s_add_u32 s57, s57, 1
    s_cmp_gt_u32 s57, 30000
    s_cbranch_scc1 wd_36
    s_waitcnt vmcnt(0)
    v_cmp_le_u32 vcc, 16, v251
    s_nop 1
    s_cmp_eq_u64 vcc, exec
    s_cbranch_scc0 wp_35
wd_36:
    s_mov_b64 exec, -1
wt_34:
    s_barrier
    s_cmp_lt_u32 s3, 4
    s_cbranch_scc1 p4comp_37
    s_add_u32 m0, s41, 0
    s_add_u32 s40, s28, 0
    buffer_load_dwordx4 v5, s[12:15], s40 offen offset:0 sc1 lds
    buffer_load_dwordx4 v5, s[12:15], s40 offen offset:1024 sc1 lds
    s_add_u32 m0, s41, 24576
    s_add_u32 s40, s28, 16384
    buffer_load_dwordx4 v5, s[12:15], s40 offen offset:0 sc1 lds
    buffer_load_dwordx4 v5, s[12:15], s40 offen offset:1024 sc1 lds
    s_add_u32 m0, s41, 49152
    s_add_u32 s40, s28, 32768
    buffer_load_dwordx4 v5, s[12:15], s40 offen offset:0 sc1 lds
    buffer_load_dwordx4 v5, s[12:15], s40 offen offset:1024 sc1 lds
    s_add_u32 m0, s41, 73728
    s_add_u32 s40, s28, 49152
    buffer_load_dwordx4 v5, s[12:15], s40 offen offset:0 sc1 lds
    buffer_load_dwordx4 v5, s[12:15], s40 offen offset:1024 sc1 lds
    s_add_u32 m0, s41, 98304
    s_add_u32 s40, s28, 65536
    buffer_load_dwordx4 v5, s[12:15], s40 offen offset:0 sc1 lds
    buffer_load_dwordx4 v5, s[12:15], s40 offen offset:1024 sc1 lds
    s_waitcnt vmcnt(8)
    s_barrier
    s_add_u32 m0, s39, 131072
    s_add_u32 s40, s29, 81920
    buffer_load_dwordx4 v5, s[16:19], s40 offen offset:0 sc1 lds
    buffer_load_dwordx4 v5, s[16:19], s40 offen offset:1024 sc1 lds
    buffer_load_dwordx4 v5, s[16:19], s40 offen offset:2048 sc1 lds
    buffer_load_dwordx4 v5, s[16:19], s40 offen offset:3072 sc1 lds
    s_add_u32 m0, s41, 122880
    s_add_u32 s40, s28, 81920
    buffer_load_dwordx4 v5, s[12:15], s40 offen offset:0 sc1 lds
    buffer_load_dwordx4 v5, s[12:15], s40 offen offset:1024 sc1 lds
    s_waitcnt vmcnt(12)
    s_barrier
    s_add_u32 m0, s39, 8192
    s_add_u32 s40, s29, 98304
    buffer_load_dwordx4 v5, s[16:19], s40 offen offset:0 sc1 lds
    buffer_load_dwordx4 v5, s[16:19], s40 offen offset:1024 sc1 lds
    buffer_load_dwordx4 v5, s[16:19], s40 offen offset:2048 sc1 lds
    buffer_load_dwordx4 v5, s[16:19], s40 offen offset:3072 sc1 lds
    s_add_u32 m0, s41, 0
    s_add_u32 s40, s28, 98304
    buffer_load_dwordx4 v5, s[12:15], s40 offen offset:0 sc1 lds
    buffer_load_dwordx4 v5, s[12:15], s40 offen offset:1024 sc1 lds
    s_waitcnt vmcnt(16)
    s_barrier
    s_add_u32 m0, s39, 32768
    s_add_u32 s40, s29, 114688
    buffer_load_dwordx4 v5, s[16:19], s40 offen offset:0 sc1 lds
    buffer_load_dwordx4 v5, s[16:19], s40 offen offset:1024 sc1 lds
    buffer_load_dwordx4 v5, s[16:19], s40 offen offset:2048 sc1 lds
    buffer_load_dwordx4 v5, s[16:19], s40 offen offset:3072 sc1 lds
    s_add_u32 m0, s41, 24576
    s_add_u32 s40, s28, 114688
    buffer_load_dwordx4 v5, s[12:15], s40 offen offset:0 sc1 lds
    buffer_load_dwordx4 v5, s[12:15], s40 offen offset:1024 sc1 lds
    s_waitcnt vmcnt(20)
    s_barrier
    s_add_u32 m0, s39, 57344
    s_add_u32 s40, s29, 131072
    buffer_load_dwordx4 v5, s[16:19], s40 offen offset:0 sc1 lds
    buffer_load_dwordx4 v5, s[16:19], s40 offen offset:1024 sc1 lds
    buffer_load_dwordx4 v5, s[16:19], s40 offen offset:2048 sc1 lds
    buffer_load_dwordx4 v5, s[16:19], s40 offen offset:3072 sc1 lds
    s_add_u32 m0, s41, 49152
    s_add_u32 s40, s28, 131072
    buffer_load_dwordx4 v5, s[12:15], s40 offen offset:0 sc1 lds
    buffer_load_dwordx4 v5, s[12:15], s40 offen offset:1024 sc1 lds
    s_waitcnt vmcnt(24)
    s_barrier
    s_add_u32 m0, s39, 81920
    s_add_u32 s40, s29, 147456
    buffer_load_dwordx4 v5, s[16:19], s40 offen offset:0 sc1 lds
    buffer_load_dwordx4 v5, s[16:19], s40 offen offset:1024 sc1 lds
    buffer_load_dwordx4 v5, s[16:19], s40 offen offset:2048 sc1 lds
    buffer_load_dwordx4 v5, s[16:19], s40 offen offset:3072 sc1 lds
    s_add_u32 m0, s41, 73728
    s_add_u32 s40, s28, 147456
    buffer_load_dwordx4 v5, s[12:15], s40 offen offset:0 sc1 lds
    buffer_load_dwordx4 v5, s[12:15], s40 offen offset:1024 sc1 lds
    s_waitcnt vmcnt(24)
    s_barrier
    s_add_u32 m0, s39, 106496
    s_add_u32 s40, s29, 163840
    buffer_load_dwordx4 v5, s[16:19], s40 offen offset:0 sc1 lds
    buffer_load_dwordx4 v5, s[16:19], s40 offen offset:1024 sc1 lds
    buffer_load_dwordx4 v5, s[16:19], s40 offen offset:2048 sc1 lds
    buffer_load_dwordx4 v5, s[16:19], s40 offen offset:3072 sc1 lds
    s_add_u32 m0, s41, 98304
    s_add_u32 s40, s28, 163840
    buffer_load_dwordx4 v5, s[12:15], s40 offen offset:0 sc1 lds
    buffer_load_dwordx4 v5, s[12:15], s40 offen offset:1024 sc1 lds
    s_waitcnt vmcnt(24)
    s_barrier
    s_add_u32 m0, s39, 131072
    s_add_u32 s40, s29, 180224
    buffer_load_dwordx4 v5, s[16:19], s40 offen offset:0 sc1 lds
    buffer_load_dwordx4 v5, s[16:19], s40 offen offset:1024 sc1 lds
    buffer_load_dwordx4 v5, s[16:19], s40 offen offset:2048 sc1 lds
    buffer_load_dwordx4 v5, s[16:19], s40 offen offset:3072 sc1 lds
    s_add_u32 m0, s41, 122880
    s_add_u32 s40, s28, 180224
    buffer_load_dwordx4 v5, s[12:15], s40 offen offset:0 sc1 lds
    buffer_load_dwordx4 v5, s[12:15], s40 offen offset:1024 sc1 lds
    s_waitcnt vmcnt(24)
    s_barrier
    s_add_u32 m0, s39, 8192
    s_add_u32 s40, s29, 196608
    buffer_load_dwordx4 v5, s[16:19], s40 offen offset:0 sc1 lds
    buffer_load_dwordx4 v5, s[16:19], s40 offen offset:1024 sc1 lds
    buffer_load_dwordx4 v5, s[16:19], s40 offen offset:2048 sc1 lds
    buffer_load_dwordx4 v5, s[16:19], s40 offen offset:3072 sc1 lds
    s_add_u32 m0, s41, 0
    s_add_u32 s40, s28, 196608
    buffer_load_dwordx4 v5, s[12:15], s40 offen offset:0 sc1 lds
    buffer_load_dwordx4 v5, s[12:15], s40 offen offset:1024 sc1 lds
    s_waitcnt vmcnt(24)
    s_barrier
    s_add_u32 m0, s39, 32768
    s_add_u32 s40, s29, 212992
    buffer_load_dwordx4 v5, s[16:19], s40 offen offset:0 sc1 lds
    buffer_load_dwordx4 v5, s[16:19], s40 offen offset:1024 sc1 lds
    buffer_load_dwordx4 v5, s[16:19], s40 offen offset:2048 sc1 lds
    buffer_load_dwordx4 v5, s[16:19], s40 offen offset:3072 sc1 lds
    s_add_u32 m0, s41, 24576
    s_add_u32 s40, s28, 212992
    buffer_load_dwordx4 v5, s[12:15], s40 offen offset:0 sc1 lds
    buffer_load_dwordx4 v5, s[12:15], s40 offen offset:1024 sc1 lds
    s_waitcnt vmcnt(24)
    s_barrier
    s_add_u32 m0, s39, 57344
    s_add_u32 s40, s29, 229376
    buffer_load_dwordx4 v5, s[16:19], s40 offen offset:0 sc1 lds
    buffer_load_dwordx4 v5, s[16:19], s40 offen offset:1024 sc1 lds
    buffer_load_dwordx4 v5, s[16:19], s40 offen offset:2048 sc1 lds
    buffer_load_dwordx4 v5, s[16:19], s40 offen offset:3072 sc1 lds
    s_add_u32 m0, s41, 49152
    s_add_u32 s40, s28, 229376
    buffer_load_dwordx4 v5, s[12:15], s40 offen offset:0 sc1 lds
    buffer_load_dwordx4 v5, s[12:15], s40 offen offset:1024 sc1 lds
    s_waitcnt vmcnt(24)
    s_barrier
    s_add_u32 m0, s39, 81920
    s_add_u32 s40, s29, 245760
    buffer_load_dwordx4 v5, s[16:19], s40 offen offset:0 sc1 lds
    buffer_load_dwordx4 v5, s[16:19], s40 offen offset:1024 sc1 lds
    buffer_load_dwordx4 v5, s[16:19], s40 offen offset:2048 sc1 lds
    buffer_load_dwordx4 v5, s[16:19], s40 offen offset:3072 sc1 lds
    s_add_u32 m0, s41, 73728
    s_add_u32 s40, s28, 245760
    buffer_load_dwordx4 v5, s[12:15], s40 offen offset:0 sc1 lds
    buffer_load_dwordx4 v5, s[12:15], s40 offen offset:1024 sc1 lds
    s_waitcnt vmcnt(24)
    s_barrier
    s_waitcnt vmcnt(18)
    s_barrier
    s_waitcnt vmcnt(12)
    s_barrier
    s_waitcnt vmcnt(6)
    s_barrier
    s_waitcnt vmcnt(0)
    s_barrier
    s_barrier
    s_branch p4end_38_b
p4comp_37:
    s_lshl_b32 s45, s37, 12
    s_add_u32 s46, s45, 0
    v_add_u32 v140, s46, v2
    s_add_u32 s46, s45, 24576
    v_add_u32 v141, s46, v2
    s_add_u32 s46, s45, 49152
    v_add_u32 v142, s46, v2
    s_add_u32 s46, s45, 73728
    v_add_u32 v143, s46, v2
    s_add_u32 s46, s45, 98304
    v_add_u32 v144, s46, v2
    s_add_u32 s46, s45, 122880
    v_add_u32 v145, s46, v2
    v_bfe_u32 v6, v1, 2, 2
    v_lshl_add_u32 v7, v4, 2, v6
    v_lshlrev_b32 v8, 8, v7
    v_and_b32 v7, 7, v7
    v_lshl_add_u32 v8, v7, 5, v8
    v_and_b32 v7, 3, v1
    v_lshl_add_u32 v8, v7, 3, v8
    s_lshl_b32 s45, s38, 7
    v_xor_b32 v8, s45, v8
    v_xor_b32 v128, 0, v8
    v_add_u32 v128, 8192, v128
    v_xor_b32 v129, 32, v8
    v_add_u32 v129, 8192, v129
    v_xor_b32 v130, 64, v8
    v_add_u32 v130, 8192, v130
    v_xor_b32 v131, 96, v8
    v_add_u32 v131, 8192, v131
    v_xor_b32 v132, 0, v8
    v_add_u32 v132, 57344, v132
    v_xor_b32 v133, 32, v8
    v_add_u32 v133, 57344, v133
    v_xor_b32 v134, 64, v8
    v_add_u32 v134, 57344, v134
    v_xor_b32 v135, 96, v8
    v_add_u32 v135, 57344, v135
    v_xor_b32 v136, 0, v8
    v_add_u32 v136, 106496, v136
    v_xor_b32 v137, 32, v8
    v_add_u32 v137, 106496, v137
    v_xor_b32 v138, 64, v8
    v_add_u32 v138, 106496, v138
    v_xor_b32 v139, 96, v8
    v_add_u32 v139, 106496, v139
    v_mov_b32 v64, 0
    v_mov_b32 v65, 0
    v_mov_b32 v66, 0
    v_mov_b32 v67, 0
    v_mov_b32 v68, 0
    v_mov_b32 v69, 0
    v_mov_b32 v70, 0
    v_mov_b32 v71, 0
    v_mov_b32 v72, 0
    v_mov_b32 v73, 0
    v_mov_b32 v74, 0
    v_mov_b32 v75, 0
    v_mov_b32 v76, 0
    v_mov_b32 v77, 0
    v_mov_b32 v78, 0
    v_mov_b32 v79, 0
    v_mov_b32 v80, 0
    v_mov_b32 v81, 0
    v_mov_b32 v82, 0
    v_mov_b32 v83, 0
    v_mov_b32 v84, 0
    v_mov_b32 v85, 0
    v_mov_b32 v86, 0
    v_mov_b32 v87, 0
    v_mov_b32 v88, 0
    v_mov_b32 v89, 0
    v_mov_b32 v90, 0
    v_mov_b32 v91, 0
    v_mov_b32 v92, 0
    v_mov_b32 v93, 0
    v_mov_b32 v94, 0
    v_mov_b32 v95, 0
    v_mov_b32 v40, 0
    v_mov_b32 v41, 0
    v_mov_b32 v42, 0
    v_mov_b32 v43, 0
    v_mov_b32 v44, 0
    v_mov_b32 v45, 0
    v_mov_b32 v46, 0
    v_mov_b32 v47, 0
    v_mov_b32 v48, 0
    v_mov_b32 v49, 0
    v_mov_b32 v50, 0
    v_mov_b32 v51, 0
    v_mov_b32 v52, 0
    v_mov_b32 v53, 0
    v_mov_b32 v54, 0
    v_mov_b32 v55, 0
    v_mov_b32 v56, 0
    v_mov_b32 v57, 0
    v_mov_b32 v58, 0
    v_mov_b32 v59, 0
    v_mov_b32 v60, 0
    v_mov_b32 v61, 0
    v_mov_b32 v62, 0
    v_mov_b32 v63, 0
    s_mov_b32 s43, 0
p4loop_39:
    s_barrier
    v_mfma_f32_16x16x32_bf16 v[64:67], v[48:51], v[40:43], v[64:67]
    ds_read_b128 v[16:19], v140 offset:0
    ds_read_b128 v[20:23], v140 offset:2048
    v_mfma_f32_16x16x32_bf16 v[80:83], v[48:51], v[44:47], v[80:83]
    ds_read_b64_tr_b16 v[24:25], v128 offset:0
    ds_read_b64_tr_b16 v[26:27], v128 offset:4096
    v_mfma_f32_16x16x32_bf16 v[68:71], v[52:55], v[40:43], v[68:71]
    ds_read_b64_tr_b16 v[28:29], v129 offset:0
    ds_read_b64_tr_b16 v[30:31], v129 offset:4096
    v_mfma_f32_16x16x32_bf16 v[84:87], v[52:55], v[44:47], v[84:87]
    ds_read_b64_tr_b16 v[32:33], v130 offset:0
    ds_read_b64_tr_b16 v[34:35], v130 offset:4096
    v_mfma_f32_16x16x32_bf16 v[72:75], v[56:59], v[40:43], v[72:75]
    ds_read_b64_tr_b16 v[36:37], v131 offset:0
    ds_read_b64_tr_b16 v[38:39], v131 offset:4096
    v_mfma_f32_16x16x32_bf16 v[88:91], v[56:59], v[44:47], v[88:91]
    v_mfma_f32_16x16x32_bf16 v[76:79], v[60:63], v[40:43], v[76:79]
    v_mfma_f32_16x16x32_bf16 v[92:95], v[60:63], v[44:47], v[92:95]
    s_waitcnt lgkmcnt(0)
    v_mfma_f32_16x16x32_bf16 v[64:67], v[24:27], v[16:19], v[64:67]
    ds_read_b128 v[40:43], v140 offset:1024
    ds_read_b128 v[44:47], v140 offset:3072
    v_mfma_f32_16x16x32_bf16 v[80:83], v[24:27], v[20:23], v[80:83]
    ds_read_b64_tr_b16 v[48:49], v128 offset:8192
    ds_read_b64_tr_b16 v[50:51], v128 offset:12288
    v_mfma_f32_16x16x32_bf16 v[68:71], v[28:31], v[16:19], v[68:71]
    ds_read_b64_tr_b16 v[52:53], v129 offset:8192
    ds_read_b64_tr_b16 v[54:55], v129 offset:12288
    v_mfma_f32_16x16x32_bf16 v[84:87], v[28:31], v[20:23], v[84:87]
    ds_read_b64_tr_b16 v[56:57], v130 offset:8192
    ds_read_b64_tr_b16 v[58:59], v130 offset:12288
    v_mfma_f32_16x16x32_bf16 v[72:75], v[32:35], v[16:19], v[72:75]
    ds_read_b64_tr_b16 v[60:61], v131 offset:8192
    ds_read_b64_tr_b16 v[62:63], v131 offset:12288
    v_mfma_f32_16x16x32_bf16 v[88:91], v[32:35], v[20:23], v[88:91]
    v_mfma_f32_16x16x32_bf16 v[76:79], v[36:39], v[16:19], v[76:79]
    v_mfma_f32_16x16x32_bf16 v[92:95], v[36:39], v[20:23], v[92:95]
    s_waitcnt lgkmcnt(0)
    s_barrier
    v_mfma_f32_16x16x32_bf16 v[64:67], v[48:51], v[40:43], v[64:67]
    ds_read_b128 v[16:19], v141 offset:0
    ds_read_b128 v[20:23], v141 offset:2048
    v_mfma_f32_16x16x32_bf16 v[80:83], v[48:51], v[44:47], v[80:83]
    ds_read_b64_tr_b16 v[24:25], v128 offset:24576
    ds_read_b64_tr_b16 v[26:27], v128 offset:28672
    v_mfma_f32_16x16x32_bf16 v[68:71], v[52:55], v[40:43], v[68:71]
    ds_read_b64_tr_b16 v[28:29], v129 offset:24576
    ds_read_b64_tr_b16 v[30:31], v129 offset:28672
    v_mfma_f32_16x16x32_bf16 v[84:87], v[52:55], v[44:47], v[84:87]
    ds_read_b64_tr_b16 v[32:33], v130 offset:24576
    ds_read_b64_tr_b16 v[34:35], v130 offset:28672
    v_mfma_f32_16x16x32_bf16 v[72:75], v[56:59], v[40:43], v[72:75]
    ds_read_b64_tr_b16 v[36:37], v131 offset:24576
    ds_read_b64_tr_b16 v[38:39], v131 offset:28672
    v_mfma_f32_16x16x32_bf16 v[88:91], v[56:59], v[44:47], v[88:91]
    v_mfma_f32_16x16x32_bf16 v[76:79], v[60:63], v[40:43], v[76:79]
    v_mfma_f32_16x16x32_bf16 v[92:95], v[60:63], v[44:47], v[92:95]
    s_waitcnt lgkmcnt(0)
    v_mfma_f32_16x16x32_bf16 v[64:67], v[24:27], v[16:19], v[64:67]
    ds_read_b128 v[40:43], v141 offset:1024
    ds_read_b128 v[44:47], v141 offset:3072
    v_mfma_f32_16x16x32_bf16 v[80:83], v[24:27], v[20:23], v[80:83]
    ds_read_b64_tr_b16 v[48:49], v128 offset:32768
    ds_read_b64_tr_b16 v[50:51], v128 offset:36864
    v_mfma_f32_16x16x32_bf16 v[68:71], v[28:31], v[16:19], v[68:71]
    ds_read_b64_tr_b16 v[52:53], v129 offset:32768
    ds_read_b64_tr_b16 v[54:55], v129 offset:36864
    v_mfma_f32_16x16x32_bf16 v[84:87], v[28:31], v[20:23], v[84:87]
    ds_read_b64_tr_b16 v[56:57], v130 offset:32768
    ds_read_b64_tr_b16 v[58:59], v130 offset:36864
    v_mfma_f32_16x16x32_bf16 v[72:75], v[32:35], v[16:19], v[72:75]
    ds_read_b64_tr_b16 v[60:61], v131 offset:32768
    ds_read_b64_tr_b16 v[62:63], v131 offset:36864
    v_mfma_f32_16x16x32_bf16 v[88:91], v[32:35], v[20:23], v[88:91]
    v_mfma_f32_16x16x32_bf16 v[76:79], v[36:39], v[16:19], v[76:79]
    v_mfma_f32_16x16x32_bf16 v[92:95], v[36:39], v[20:23], v[92:95]
    s_waitcnt lgkmcnt(0)
    s_barrier
    v_mfma_f32_16x16x32_bf16 v[64:67], v[48:51], v[40:43], v[64:67]
    ds_read_b128 v[16:19], v142 offset:0
    ds_read_b128 v[20:23], v142 offset:2048
    v_mfma_f32_16x16x32_bf16 v[80:83], v[48:51], v[44:47], v[80:83]
    ds_read_b64_tr_b16 v[24:25], v132 offset:0
    ds_read_b64_tr_b16 v[26:27], v132 offset:4096
    v_mfma_f32_16x16x32_bf16 v[68:71], v[52:55], v[40:43], v[68:71]
    ds_read_b64_tr_b16 v[28:29], v133 offset:0
    ds_read_b64_tr_b16 v[30:31], v133 offset:4096
    v_mfma_f32_16x16x32_bf16 v[84:87], v[52:55], v[44:47], v[84:87]
    ds_read_b64_tr_b16 v[32:33], v134 offset:0
    ds_read_b64_tr_b16 v[34:35], v134 offset:4096
    v_mfma_f32_16x16x32_bf16 v[72:75], v[56:59], v[40:43], v[72:75]
    ds_read_b64_tr_b16 v[36:37], v135 offset:0
    ds_read_b64_tr_b16 v[38:39], v135 offset:4096
    v_mfma_f32_16x16x32_bf16 v[88:91], v[56:59], v[44:47], v[88:91]
    v_mfma_f32_16x16x32_bf16 v[76:79], v[60:63], v[40:43], v[76:79]
    v_mfma_f32_16x16x32_bf16 v[92:95], v[60:63], v[44:47], v[92:95]
    s_waitcnt lgkmcnt(0)
    v_mfma_f32_16x16x32_bf16 v[64:67], v[24:27], v[16:19], v[64:67]
    ds_read_b128 v[40:43], v142 offset:1024
    ds_read_b128 v[44:47], v142 offset:3072
    v_mfma_f32_16x16x32_bf16 v[80:83], v[24:27], v[20:23], v[80:83]
    ds_read_b64_tr_b16 v[48:49], v132 offset:8192
    ds_read_b64_tr_b16 v[50:51], v132 offset:12288
    v_mfma_f32_16x16x32_bf16 v[68:71], v[28:31], v[16:19], v[68:71]
    ds_read_b64_tr_b16 v[52:53], v133 offset:8192
    ds_read_b64_tr_b16 v[54:55], v133 offset:12288
    v_mfma_f32_16x16x32_bf16 v[84:87], v[28:31], v[20:23], v[84:87]
    ds_read_b64_tr_b16 v[56:57], v134 offset:8192
    ds_read_b64_tr_b16 v[58:59], v134 offset:12288
    v_mfma_f32_16x16x32_bf16 v[72:75], v[32:35], v[16:19], v[72:75]
    ds_read_b64_tr_b16 v[60:61], v135 offset:8192
    ds_read_b64_tr_b16 v[62:63], v135 offset:12288
    v_mfma_f32_16x16x32_bf16 v[88:91], v[32:35], v[20:23], v[88:91]
    v_mfma_f32_16x16x32_bf16 v[76:79], v[36:39], v[16:19], v[76:79]
    v_mfma_f32_16x16x32_bf16 v[92:95], v[36:39], v[20:23], v[92:95]
    s_waitcnt lgkmcnt(0)
    s_barrier
    v_mfma_f32_16x16x32_bf16 v[64:67], v[48:51], v[40:43], v[64:67]
    ds_read_b128 v[16:19], v143 offset:0
    ds_read_b128 v[20:23], v143 offset:2048
    v_mfma_f32_16x16x32_bf16 v[80:83], v[48:51], v[44:47], v[80:83]
    ds_read_b64_tr_b16 v[24:25], v132 offset:24576
    ds_read_b64_tr_b16 v[26:27], v132 offset:28672
    v_mfma_f32_16x16x32_bf16 v[68:71], v[52:55], v[40:43], v[68:71]
    ds_read_b64_tr_b16 v[28:29], v133 offset:24576
    ds_read_b64_tr_b16 v[30:31], v133 offset:28672
    v_mfma_f32_16x16x32_bf16 v[84:87], v[52:55], v[44:47], v[84:87]
    ds_read_b64_tr_b16 v[32:33], v134 offset:24576
    ds_read_b64_tr_b16 v[34:35], v134 offset:28672
    v_mfma_f32_16x16x32_bf16 v[72:75], v[56:59], v[40:43], v[72:75]
    ds_read_b64_tr_b16 v[36:37], v135 offset:24576
    ds_read_b64_tr_b16 v[38:39], v135 offset:28672
    v_mfma_f32_16x16x32_bf16 v[88:91], v[56:59], v[44:47], v[88:91]
    v_mfma_f32_16x16x32_bf16 v[76:79], v[60:63], v[40:43], v[76:79]
    v_mfma_f32_16x16x32_bf16 v[92:95], v[60:63], v[44:47], v[92:95]
    s_waitcnt lgkmcnt(0)
    v_mfma_f32_16x16x32_bf16 v[64:67], v[24:27], v[16:19], v[64:67]
    ds_read_b128 v[40:43], v143 offset:1024
    ds_read_b128 v[44:47], v143 offset:3072
    v_mfma_f32_16x16x32_bf16 v[80:83], v[24:27], v[20:23], v[80:83]
    ds_read_b64_tr_b16 v[48:49], v132 offset:32768
    ds_read_b64_tr_b16 v[50:51], v132 offset:36864
    v_mfma_f32_16x16x32_bf16 v[68:71], v[28:31], v[16:19], v[68:71]
    ds_read_b64_tr_b16 v[52:53], v133 offset:32768
    ds_read_b64_tr_b16 v[54:55], v133 offset:36864
    v_mfma_f32_16x16x32_bf16 v[84:87], v[28:31], v[20:23], v[84:87]
    ds_read_b64_tr_b16 v[56:57], v134 offset:32768
    ds_read_b64_tr_b16 v[58:59], v134 offset:36864
    v_mfma_f32_16x16x32_bf16 v[72:75], v[32:35], v[16:19], v[72:75]
    ds_read_b64_tr_b16 v[60:61], v135 offset:32768
    ds_read_b64_tr_b16 v[62:63], v135 offset:36864
    v_mfma_f32_16x16x32_bf16 v[88:91], v[32:35], v[20:23], v[88:91]
    v_mfma_f32_16x16x32_bf16 v[76:79], v[36:39], v[16:19], v[76:79]
    v_mfma_f32_16x16x32_bf16 v[92:95], v[36:39], v[20:23], v[92:95]
    s_waitcnt lgkmcnt(0)
    s_barrier
    v_mfma_f32_16x16x32_bf16 v[64:67], v[48:51], v[40:43], v[64:67]
    ds_read_b128 v[16:19], v144 offset:0
    ds_read_b128 v[20:23], v144 offset:2048
    v_mfma_f32_16x16x32_bf16 v[80:83], v[48:51], v[44:47], v[80:83]
    ds_read_b64_tr_b16 v[24:25], v136 offset:0
    ds_read_b64_tr_b16 v[26:27], v136 offset:4096
    v_mfma_f32_16x16x32_bf16 v[68:71], v[52:55], v[40:43], v[68:71]
    ds_read_b64_tr_b16 v[28:29], v137 offset:0
    ds_read_b64_tr_b16 v[30:31], v137 offset:4096
    v_mfma_f32_16x16x32_bf16 v[84:87], v[52:55], v[44:47], v[84:87]
    ds_read_b64_tr_b16 v[32:33], v138 offset:0
    ds_read_b64_tr_b16 v[34:35], v138 offset:4096
    v_mfma_f32_16x16x32_bf16 v[72:75], v[56:59], v[40:43], v[72:75]
    ds_read_b64_tr_b16 v[36:37], v139 offset:0
    ds_read_b64_tr_b16 v[38:39], v139 offset:4096
    v_mfma_f32_16x16x32_bf16 v[88:91], v[56:59], v[44:47], v[88:91]
    v_mfma_f32_16x16x32_bf16 v[76:79], v[60:63], v[40:43], v[76:79]
    v_mfma_f32_16x16x32_bf16 v[92:95], v[60:63], v[44:47], v[92:95]
    s_waitcnt lgkmcnt(0)
    v_mfma_f32_16x16x32_bf16 v[64:67], v[24:27], v[16:19], v[64:67]
    ds_read_b128 v[40:43], v144 offset:1024
    ds_read_b128 v[44:47], v144 offset:3072
    v_mfma_f32_16x16x32_bf16 v[80:83], v[24:27], v[20:23], v[80:83]
    ds_read_b64_tr_b16 v[48:49], v136 offset:8192
    ds_read_b64_tr_b16 v[50:51], v136 offset:12288
    v_mfma_f32_16x16x32_bf16 v[68:71], v[28:31], v[16:19], v[68:71]
    ds_read_b64_tr_b16 v[52:53], v137 offset:8192
    ds_read_b64_tr_b16 v[54:55], v137 offset:12288
    v_mfma_f32_16x16x32_bf16 v[84:87], v[28:31], v[20:23], v[84:87]
    ds_read_b64_tr_b16 v[56:57], v138 offset:8192
    ds_read_b64_tr_b16 v[58:59], v138 offset:12288
    v_mfma_f32_16x16x32_bf16 v[72:75], v[32:35], v[16:19], v[72:75]
    ds_read_b64_tr_b16 v[60:61], v139 offset:8192
    ds_read_b64_tr_b16 v[62:63], v139 offset:12288
    v_mfma_f32_16x16x32_bf16 v[88:91], v[32:35], v[20:23], v[88:91]
    v_mfma_f32_16x16x32_bf16 v[76:79], v[36:39], v[16:19], v[76:79]
    v_mfma_f32_16x16x32_bf16 v[92:95], v[36:39], v[20:23], v[92:95]
    s_waitcnt lgkmcnt(0)
    s_barrier
    v_mfma_f32_16x16x32_bf16 v[64:67], v[48:51], v[40:43], v[64:67]
    ds_read_b128 v[16:19], v145 offset:0
    ds_read_b128 v[20:23], v145 offset:2048
    v_mfma_f32_16x16x32_bf16 v[80:83], v[48:51], v[44:47], v[80:83]
    ds_read_b64_tr_b16 v[24:25], v136 offset:24576
    ds_read_b64_tr_b16 v[26:27], v136 offset:28672
    v_mfma_f32_16x16x32_bf16 v[68:71], v[52:55], v[40:43], v[68:71]
    ds_read_b64_tr_b16 v[28:29], v137 offset:24576
    ds_read_b64_tr_b16 v[30:31], v137 offset:28672
    v_mfma_f32_16x16x32_bf16 v[84:87], v[52:55], v[44:47], v[84:87]
    ds_read_b64_tr_b16 v[32:33], v138 offset:24576
    ds_read_b64_tr_b16 v[34:35], v138 offset:28672
    v_mfma_f32_16x16x32_bf16 v[72:75], v[56:59], v[40:43], v[72:75]
    ds_read_b64_tr_b16 v[36:37], v139 offset:24576
    ds_read_b64_tr_b16 v[38:39], v139 offset:28672
    v_mfma_f32_16x16x32_bf16 v[88:91], v[56:59], v[44:47], v[88:91]
    v_mfma_f32_16x16x32_bf16 v[76:79], v[60:63], v[40:43], v[76:79]
    v_mfma_f32_16x16x32_bf16 v[92:95], v[60:63], v[44:47], v[92:95]
    s_waitcnt lgkmcnt(0)
    v_mfma_f32_16x16x32_bf16 v[64:67], v[24:27], v[16:19], v[64:67]
    ds_read_b128 v[40:43], v145 offset:1024
    ds_read_b128 v[44:47], v145 offset:3072
    v_mfma_f32_16x16x32_bf16 v[80:83], v[24:27], v[20:23], v[80:83]
    ds_read_b64_tr_b16 v[48:49], v136 offset:32768
    ds_read_b64_tr_b16 v[50:51], v136 offset:36864
    v_mfma_f32_16x16x32_bf16 v[68:71], v[28:31], v[16:19], v[68:71]
    ds_read_b64_tr_b16 v[52:53], v137 offset:32768
    ds_read_b64_tr_b16 v[54:55], v137 offset:36864
    v_mfma_f32_16x16x32_bf16 v[84:87], v[28:31], v[20:23], v[84:87]
    ds_read_b64_tr_b16 v[56:57], v138 offset:32768
    ds_read_b64_tr_b16 v[58:59], v138 offset:36864
    v_mfma_f32_16x16x32_bf16 v[72:75], v[32:35], v[16:19], v[72:75]
    ds_read_b64_tr_b16 v[60:61], v139 offset:32768
    ds_read_b64_tr_b16 v[62:63], v139 offset:36864
    v_mfma_f32_16x16x32_bf16 v[88:91], v[32:35], v[20:23], v[88:91]
    v_mfma_f32_16x16x32_bf16 v[76:79], v[36:39], v[16:19], v[76:79]
    v_mfma_f32_16x16x32_bf16 v[92:95], v[36:39], v[20:23], v[92:95]
    s_waitcnt lgkmcnt(0)
    s_add_u32 s43, s43, 1
    s_cmp_lt_u32 s43, 2
    s_cbranch_scc1 p4loop_39
    s_barrier
    v_mfma_f32_16x16x32_bf16 v[64:67], v[48:51], v[40:43], v[64:67]
    ds_read_b128 v[16:19], v140 offset:0
    ds_read_b128 v[20:23], v140 offset:2048
    v_mfma_f32_16x16x32_bf16 v[80:83], v[48:51], v[44:47], v[80:83]
    ds_read_b64_tr_b16 v[24:25], v128 offset:0
    ds_read_b64_tr_b16 v[26:27], v128 offset:4096
    v_mfma_f32_16x16x32_bf16 v[68:71], v[52:55], v[40:43], v[68:71]
    ds_read_b64_tr_b16 v[28:29], v129 offset:0
    ds_read_b64_tr_b16 v[30:31], v129 offset:4096
    v_mfma_f32_16x16x32_bf16 v[84:87], v[52:55], v[44:47], v[84:87]
    ds_read_b64_tr_b16 v[32:33], v130 offset:0
    ds_read_b64_tr_b16 v[34:35], v130 offset:4096
    v_mfma_f32_16x16x32_bf16 v[72:75], v[56:59], v[40:43], v[72:75]
    ds_read_b64_tr_b16 v[36:37], v131 offset:0
    ds_read_b64_tr_b16 v[38:39], v131 offset:4096
    v_mfma_f32_16x16x32_bf16 v[88:91], v[56:59], v[44:47], v[88:91]
    v_mfma_f32_16x16x32_bf16 v[76:79], v[60:63], v[40:43], v[76:79]
    v_mfma_f32_16x16x32_bf16 v[92:95], v[60:63], v[44:47], v[92:95]
    s_waitcnt lgkmcnt(0)
    v_mfma_f32_16x16x32_bf16 v[64:67], v[24:27], v[16:19], v[64:67]
    ds_read_b128 v[40:43], v140 offset:1024
    ds_read_b128 v[44:47], v140 offset:3072
    v_mfma_f32_16x16x32_bf16 v[80:83], v[24:27], v[20:23], v[80:83]
    ds_read_b64_tr_b16 v[48:49], v128 offset:8192
    ds_read_b64_tr_b16 v[50:51], v128 offset:12288
    v_mfma_f32_16x16x32_bf16 v[68:71], v[28:31], v[16:19], v[68:71]
    ds_read_b64_tr_b16 v[52:53], v129 offset:8192
    ds_read_b64_tr_b16 v[54:55], v129 offset:12288
    v_mfma_f32_16x16x32_bf16 v[84:87], v[28:31], v[20:23], v[84:87]
    ds_read_b64_tr_b16 v[56:57], v130 offset:8192
    ds_read_b64_tr_b16 v[58:59], v130 offset:12288
    v_mfma_f32_16x16x32_bf16 v[72:75], v[32:35], v[16:19], v[72:75]
    ds_read_b64_tr_b16 v[60:61], v131 offset:8192
    ds_read_b64_tr_b16 v[62:63], v131 offset:12288
    v_mfma_f32_16x16x32_bf16 v[88:91], v[32:35], v[20:23], v[88:91]
    v_mfma_f32_16x16x32_bf16 v[76:79], v[36:39], v[16:19], v[76:79]
    v_mfma_f32_16x16x32_bf16 v[92:95], v[36:39], v[20:23], v[92:95]
    s_waitcnt lgkmcnt(0)
    s_barrier
    v_mfma_f32_16x16x32_bf16 v[64:67], v[48:51], v[40:43], v[64:67]
    ds_read_b128 v[16:19], v141 offset:0
    ds_read_b128 v[20:23], v141 offset:2048
    v_mfma_f32_16x16x32_bf16 v[80:83], v[48:51], v[44:47], v[80:83]
    ds_read_b64_tr_b16 v[24:25], v128 offset:24576
    ds_read_b64_tr_b16 v[26:27], v128 offset:28672
    v_mfma_f32_16x16x32_bf16 v[68:71], v[52:55], v[40:43], v[68:71]
    ds_read_b64_tr_b16 v[28:29], v129 offset:24576
    ds_read_b64_tr_b16 v[30:31], v129 offset:28672
    v_mfma_f32_16x16x32_bf16 v[84:87], v[52:55], v[44:47], v[84:87]
    ds_read_b64_tr_b16 v[32:33], v130 offset:24576
    ds_read_b64_tr_b16 v[34:35], v130 offset:28672
    v_mfma_f32_16x16x32_bf16 v[72:75], v[56:59], v[40:43], v[72:75]
    ds_read_b64_tr_b16 v[36:37], v131 offset:24576
    ds_read_b64_tr_b16 v[38:39], v131 offset:28672
    v_mfma_f32_16x16x32_bf16 v[88:91], v[56:59], v[44:47], v[88:91]
    v_mfma_f32_16x16x32_bf16 v[76:79], v[60:63], v[40:43], v[76:79]
    v_mfma_f32_16x16x32_bf16 v[92:95], v[60:63], v[44:47], v[92:95]
    s_waitcnt lgkmcnt(0)
    v_mfma_f32_16x16x32_bf16 v[64:67], v[24:27], v[16:19], v[64:67]
    ds_read_b128 v[40:43], v141 offset:1024
    ds_read_b128 v[44:47], v141 offset:3072
    v_mfma_f32_16x16x32_bf16 v[80:83], v[24:27], v[20:23], v[80:83]
    ds_read_b64_tr_b16 v[48:49], v128 offset:32768
    ds_read_b64_tr_b16 v[50:51], v128 offset:36864
    v_mfma_f32_16x16x32_bf16 v[68:71], v[28:31], v[16:19], v[68:71]
    ds_read_b64_tr_b16 v[52:53], v129 offset:32768
    ds_read_b64_tr_b16 v[54:55], v129 offset:36864
    v_mfma_f32_16x16x32_bf16 v[84:87], v[28:31], v[20:23], v[84:87]
    ds_read_b64_tr_b16 v[56:57], v130 offset:32768
    ds_read_b64_tr_b16 v[58:59], v130 offset:36864
    v_mfma_f32_16x16x32_bf16 v[72:75], v[32:35], v[16:19], v[72:75]
    ds_read_b64_tr_b16 v[60:61], v131 offset:32768
    ds_read_b64_tr_b16 v[62:63], v131 offset:36864
    v_mfma_f32_16x16x32_bf16 v[88:91], v[32:35], v[20:23], v[88:91]
    v_mfma_f32_16x16x32_bf16 v[76:79], v[36:39], v[16:19], v[76:79]
    v_mfma_f32_16x16x32_bf16 v[92:95], v[36:39], v[20:23], v[92:95]
    s_waitcnt lgkmcnt(0)
    s_barrier
    v_mfma_f32_16x16x32_bf16 v[64:67], v[48:51], v[40:43], v[64:67]
    ds_read_b128 v[16:19], v142 offset:0
    ds_read_b128 v[20:23], v142 offset:2048
    v_mfma_f32_16x16x32_bf16 v[80:83], v[48:51], v[44:47], v[80:83]
    ds_read_b64_tr_b16 v[24:25], v132 offset:0
    ds_read_b64_tr_b16 v[26:27], v132 offset:4096
    v_mfma_f32_16x16x32_bf16 v[68:71], v[52:55], v[40:43], v[68:71]
    ds_read_b64_tr_b16 v[28:29], v133 offset:0
    ds_read_b64_tr_b16 v[30:31], v133 offset:4096
    v_mfma_f32_16x16x32_bf16 v[84:87], v[52:55], v[44:47], v[84:87]
    ds_read_b64_tr_b16 v[32:33], v134 offset:0
    ds_read_b64_tr_b16 v[34:35], v134 offset:4096
    v_mfma_f32_16x16x32_bf16 v[72:75], v[56:59], v[40:43], v[72:75]
    ds_read_b64_tr_b16 v[36:37], v135 offset:0
    ds_read_b64_tr_b16 v[38:39], v135 offset:4096
    v_mfma_f32_16x16x32_bf16 v[88:91], v[56:59], v[44:47], v[88:91]
    v_mfma_f32_16x16x32_bf16 v[76:79], v[60:63], v[40:43], v[76:79]
    v_mfma_f32_16x16x32_bf16 v[92:95], v[60:63], v[44:47], v[92:95]
    s_waitcnt lgkmcnt(0)
    v_mfma_f32_16x16x32_bf16 v[64:67], v[24:27], v[16:19], v[64:67]
    ds_read_b128 v[40:43], v142 offset:1024
    ds_read_b128 v[44:47], v142 offset:3072
    v_mfma_f32_16x16x32_bf16 v[80:83], v[24:27], v[20:23], v[80:83]
    ds_read_b64_tr_b16 v[48:49], v132 offset:8192
    ds_read_b64_tr_b16 v[50:51], v132 offset:12288
    v_mfma_f32_16x16x32_bf16 v[68:71], v[28:31], v[16:19], v[68:71]
    ds_read_b64_tr_b16 v[52:53], v133 offset:8192
    ds_read_b64_tr_b16 v[54:55], v133 offset:12288
    v_mfma_f32_16x16x32_bf16 v[84:87], v[28:31], v[20:23], v[84:87]
    ds_read_b64_tr_b16 v[56:57], v134 offset:8192
    ds_read_b64_tr_b16 v[58:59], v134 offset:12288
    v_mfma_f32_16x16x32_bf16 v[72:75], v[32:35], v[16:19], v[72:75]
    ds_read_b64_tr_b16 v[60:61], v135 offset:8192
    ds_read_b64_tr_b16 v[62:63], v135 offset:12288
    v_mfma_f32_16x16x32_bf16 v[88:91], v[32:35], v[20:23], v[88:91]
    v_mfma_f32_16x16x32_bf16 v[76:79], v[36:39], v[16:19], v[76:79]
    v_mfma_f32_16x16x32_bf16 v[92:95], v[36:39], v[20:23], v[92:95]
    s_waitcnt lgkmcnt(0)
    s_barrier
    v_mfma_f32_16x16x32_bf16 v[64:67], v[48:51], v[40:43], v[64:67]
    ds_read_b128 v[16:19], v143 offset:0
    ds_read_b128 v[20:23], v143 offset:2048
    v_mfma_f32_16x16x32_bf16 v[80:83], v[48:51], v[44:47], v[80:83]
    ds_read_b64_tr_b16 v[24:25], v132 offset:24576
    ds_read_b64_tr_b16 v[26:27], v132 offset:28672
    v_mfma_f32_16x16x32_bf16 v[68:71], v[52:55], v[40:43], v[68:71]
    ds_read_b64_tr_b16 v[28:29], v133 offset:24576
    ds_read_b64_tr_b16 v[30:31], v133 offset:28672
    v_mfma_f32_16x16x32_bf16 v[84:87], v[52:55], v[44:47], v[84:87]
    ds_read_b64_tr_b16 v[32:33], v134 offset:24576
    ds_read_b64_tr_b16 v[34:35], v134 offset:28672
    v_mfma_f32_16x16x32_bf16 v[72:75], v[56:59], v[40:43], v[72:75]
    ds_read_b64_tr_b16 v[36:37], v135 offset:24576
    ds_read_b64_tr_b16 v[38:39], v135 offset:28672
    v_mfma_f32_16x16x32_bf16 v[88:91], v[56:59], v[44:47], v[88:91]
    v_mfma_f32_16x16x32_bf16 v[76:79], v[60:63], v[40:43], v[76:79]
    v_mfma_f32_16x16x32_bf16 v[92:95], v[60:63], v[44:47], v[92:95]
    s_waitcnt lgkmcnt(0)
    v_mfma_f32_16x16x32_bf16 v[64:67], v[24:27], v[16:19], v[64:67]
    ds_read_b128 v[40:43], v143 offset:1024
    ds_read_b128 v[44:47], v143 offset:3072
    v_mfma_f32_16x16x32_bf16 v[80:83], v[24:27], v[20:23], v[80:83]
    ds_read_b64_tr_b16 v[48:49], v132 offset:32768
    ds_read_b64_tr_b16 v[50:51], v132 offset:36864
    v_mfma_f32_16x16x32_bf16 v[68:71], v[28:31], v[16:19], v[68:71]
    ds_read_b64_tr_b16 v[52:53], v133 offset:32768
    ds_read_b64_tr_b16 v[54:55], v133 offset:36864
    v_mfma_f32_16x16x32_bf16 v[84:87], v[28:31], v[20:23], v[84:87]
    ds_read_b64_tr_b16 v[56:57], v134 offset:32768
    ds_read_b64_tr_b16 v[58:59], v134 offset:36864
    v_mfma_f32_16x16x32_bf16 v[72:75], v[32:35], v[16:19], v[72:75]
    ds_read_b64_tr_b16 v[60:61], v135 offset:32768
    ds_read_b64_tr_b16 v[62:63], v135 offset:36864
    v_mfma_f32_16x16x32_bf16 v[88:91], v[32:35], v[20:23], v[88:91]
    v_mfma_f32_16x16x32_bf16 v[76:79], v[36:39], v[16:19], v[76:79]
    v_mfma_f32_16x16x32_bf16 v[92:95], v[36:39], v[20:23], v[92:95]
    s_waitcnt lgkmcnt(0)
    v_mfma_f32_16x16x32_bf16 v[64:67], v[48:51], v[40:43], v[64:67]
    v_mfma_f32_16x16x32_bf16 v[80:83], v[48:51], v[44:47], v[80:83]
    v_mfma_f32_16x16x32_bf16 v[68:71], v[52:55], v[40:43], v[68:71]
    v_mfma_f32_16x16x32_bf16 v[84:87], v[52:55], v[44:47], v[84:87]
    v_mfma_f32_16x16x32_bf16 v[72:75], v[56:59], v[40:43], v[72:75]
    v_mfma_f32_16x16x32_bf16 v[88:91], v[56:59], v[44:47], v[88:91]
    v_mfma_f32_16x16x32_bf16 v[76:79], v[60:63], v[40:43], v[76:79]
    v_mfma_f32_16x16x32_bf16 v[92:95], v[60:63], v[44:47], v[92:95]
    s_nop 7
    s_waitcnt vmcnt(0)
    v_permlane16_swap_b32 v64, v68
    v_permlane16_swap_b32 v65, v69
    v_permlane16_swap_b32 v66, v70
    v_permlane16_swap_b32 v67, v71
    v_permlane16_swap_b32 v72, v76
    v_permlane16_swap_b32 v73, v77
    v_permlane16_swap_b32 v74, v78
    v_permlane16_swap_b32 v75, v79
    v_permlane16_swap_b32 v80, v84
    v_permlane16_swap_b32 v81, v85
    v_permlane16_swap_b32 v82, v86
    v_permlane16_swap_b32 v83, v87
    v_permlane16_swap_b32 v88, v92
    v_permlane16_swap_b32 v89, v93
    v_permlane16_swap_b32 v90, v94
    v_permlane16_swap_b32 v91, v95
    s_nop 1
    v_lshlrev_b32 v16, 16, v96
    v_and_b32 v17, 0xffff0000, v96
    v_lshlrev_b32 v18, 16, v97
    v_and_b32 v19, 0xffff0000, v97
    v_lshlrev_b32 v20, 16, v98
    v_and_b32 v21, 0xffff0000, v98
    v_lshlrev_b32 v22, 16, v99
    v_and_b32 v23, 0xffff0000, v99
    v_pk_add_f32 v[64:65], v[64:65], v[16:17]
    v_pk_add_f32 v[66:67], v[66:67], v[18:19]
    v_pk_add_f32 v[68:69], v[68:69], v[20:21]
    v_pk_add_f32 v[70:71], v[70:71], v[22:23]
    v_cvt_pk_bf16_f32 v96, v64, v65
    v_cvt_pk_bf16_f32 v97, v66, v67
    v_cvt_pk_bf16_f32 v98, v68, v69
    v_cvt_pk_bf16_f32 v99, v70, v71
    v_lshlrev_b32 v16, 16, v100
    v_and_b32 v17, 0xffff0000, v100
    v_lshlrev_b32 v18, 16, v101
    v_and_b32 v19, 0xffff0000, v101
    v_lshlrev_b32 v20, 16, v102
    v_and_b32 v21, 0xffff0000, v102
    v_lshlrev_b32 v22, 16, v103
    v_and_b32 v23, 0xffff0000, v103
    v_pk_add_f32 v[72:73], v[72:73], v[16:17]
    v_pk_add_f32 v[74:75], v[74:75], v[18:19]
    v_pk_add_f32 v[76:77], v[76:77], v[20:21]
    v_pk_add_f32 v[78:79], v[78:79], v[22:23]
    v_cvt_pk_bf16_f32 v100, v72, v73
    v_cvt_pk_bf16_f32 v101, v74, v75
    v_cvt_pk_bf16_f32 v102, v76, v77
    v_cvt_pk_bf16_f32 v103, v78, v79
    v_lshlrev_b32 v16, 16, v104
    v_and_b32 v17, 0xffff0000, v104
    v_lshlrev_b32 v18, 16, v105
    v_and_b32 v19, 0xffff0000, v105
    v_lshlrev_b32 v20, 16, v106
    v_and_b32 v21, 0xffff0000, v106
    v_lshlrev_b32 v22, 16, v107
    v_and_b32 v23, 0xffff0000, v107
    v_pk_add_f32 v[80:81], v[80:81], v[16:17]
    v_pk_add_f32 v[82:83], v[82:83], v[18:19]
    v_pk_add_f32 v[84:85], v[84:85], v[20:21]
    v_pk_add_f32 v[86:87], v[86:87], v[22:23]
    v_cvt_pk_bf16_f32 v104, v80, v81
    v_cvt_pk_bf16_f32 v105, v82, v83
    v_cvt_pk_bf16_f32 v106, v84, v85
    v_cvt_pk_bf16_f32 v107, v86, v87
    v_lshlrev_b32 v16, 16, v108
    v_and_b32 v17, 0xffff0000, v108
    v_lshlrev_b32 v18, 16, v109
    v_and_b32 v19, 0xffff0000, v109
    v_lshlrev_b32 v20, 16, v110
    v_and_b32 v21, 0xffff0000, v110
    v_lshlrev_b32 v22, 16, v111
    v_and_b32 v23, 0xffff0000, v111
    v_pk_add_f32 v[88:89], v[88:89], v[16:17]
    v_pk_add_f32 v[90:91], v[90:91], v[18:19]
    v_pk_add_f32 v[92:93], v[92:93], v[20:21]
    v_pk_add_f32 v[94:95], v[94:95], v[22:23]
    v_cvt_pk_bf16_f32 v108, v88, v89
    v_cvt_pk_bf16_f32 v109, v90, v91
    v_cvt_pk_bf16_f32 v110, v92, v93
    v_cvt_pk_bf16_f32 v111, v94, v95
    v_lshlrev_b32 v64, 16, v96
    v_and_b32 v65, 0xffff0000, v96
    v_lshlrev_b32 v66, 16, v97
    v_and_b32 v67, 0xffff0000, v97
    v_lshlrev_b32 v68, 16, v98
    v_and_b32 v69, 0xffff0000, v98
    v_lshlrev_b32 v70, 16, v99
    v_and_b32 v71, 0xffff0000, v99
    v_lshlrev_b32 v72, 16, v100
    v_and_b32 v73, 0xffff0000, v100
    v_lshlrev_b32 v74, 16, v101
    v_and_b32 v75, 0xffff0000, v101
    v_lshlrev_b32 v76, 16, v102
    v_and_b32 v77, 0xffff0000, v102
    v_lshlrev_b32 v78, 16, v103
    v_and_b32 v79, 0xffff0000, v103
    v_lshlrev_b32 v80, 16, v104
    v_and_b32 v81, 0xffff0000, v104
    v_lshlrev_b32 v82, 16, v105
    v_and_b32 v83, 0xffff0000, v105
    v_lshlrev_b32 v84, 16, v106
    v_and_b32 v85, 0xffff0000, v106
    v_lshlrev_b32 v86, 16, v107
    v_and_b32 v87, 0xffff0000, v107
    v_lshlrev_b32 v88, 16, v108
    v_and_b32 v89, 0xffff0000, v108
    v_lshlrev_b32 v90, 16, v109
    v_and_b32 v91, 0xffff0000, v109
    v_lshlrev_b32 v92, 16, v110
    v_and_b32 v93, 0xffff0000, v110
    v_lshlrev_b32 v94, 16, v111
    v_and_b32 v95, 0xffff0000, v111
    v_and_b32 v14, 16, v1
    v_cmp_eq_u32 s[48:49], 0, v14
    v_lshrrev_b32 v14, 5, v1
    v_lshlrev_b32 v14, 2, v14
    v_lshl_add_u32 v14, v3, 3, v14
    s_lshl_b32 s45, s38, 9
    s_lshl_b32 s46, s37, 8
    s_add_u32 s45, s45, s46
    v_add_u32 v14, s45, v14
    v_pk_add_f32 v[36:37], v[64:65], v[66:67]
    v_pk_mul_f32 v[38:39], v[64:65], v[64:65]
    v_pk_fma_f32 v[38:39], v[66:67], v[66:67], v[38:39]
    v_pk_add_f32 v[36:37], v[36:37], v[68:69]
    v_pk_fma_f32 v[38:39], v[68:69], v[68:69], v[38:39]
    v_pk_add_f32 v[36:37], v[36:37], v[70:71]
    v_pk_fma_f32 v[38:39], v[70:71], v[70:71], v[38:39]
    v_pk_add_f32 v[36:37], v[36:37], v[72:73]
    v_pk_fma_f32 v[38:39], v[72:73], v[72:73], v[38:39]
    v_pk_add_f32 v[36:37], v[36:37], v[74:75]
    v_pk_fma_f32 v[38:39], v[74:75], v[74:75], v[38:39]
    v_pk_add_f32 v[36:37], v[36:37], v[76:77]
    v_pk_fma_f32 v[38:39], v[76:77], v[76:77], v[38:39]
    v_pk_add_f32 v[36:37], v[36:37], v[78:79]
    v_pk_fma_f32 v[38:39], v[78:79], v[78:79], v[38:39]
    v_add_f32 v32, v36, v37
    v_add_f32 v33, v38, v39
    v_pk_add_f32 v[36:37], v[80:81], v[82:83]
    v_pk_mul_f32 v[38:39], v[80:81], v[80:81]
    v_pk_fma_f32 v[38:39], v[82:83], v[82:83], v[38:39]
    v_pk_add_f32 v[36:37], v[36:37], v[84:85]
    v_pk_fma_f32 v[38:39], v[84:85], v[84:85], v[38:39]
    v_pk_add_f32 v[36:37], v[36:37], v[86:87]
    v_pk_fma_f32 v[38:39], v[86:87], v[86:87], v[38:39]
    v_pk_add_f32 v[36:37], v[36:37], v[88:89]
    v_pk_fma_f32 v[38:39], v[88:89], v[88:89], v[38:39]
    v_pk_add_f32 v[36:37], v[36:37], v[90:91]
    v_pk_fma_f32 v[38:39], v[90:91], v[90:91], v[38:39]
    v_pk_add_f32 v[36:37], v[36:37], v[92:93]
    v_pk_fma_f32 v[38:39], v[92:93], v[92:93], v[38:39]
    v_pk_add_f32 v[36:37], v[36:37], v[94:95]
    v_pk_fma_f32 v[38:39], v[94:95], v[94:95], v[38:39]
    v_add_f32 v34, v36, v37
    v_add_f32 v35, v38, v39
    s_nop 1
    v_permlane32_swap_b32 v32, v33
    v_permlane32_swap_b32 v34, v35
    s_nop 1
    v_add_f32 v32, v32, v33
    v_mov_b32 v33, v32
    v_add_f32 v34, v34, v35
    v_mov_b32 v35, v34
    s_nop 1
    v_permlane16_swap_b32 v32, v33
    v_permlane16_swap_b32 v34, v35
    s_nop 1
    v_add_f32 v32, v32, v33
    v_add_f32 v34, v34, v35
    s_mov_b64 exec, s[48:49]
    ds_write_b32 v14, v32 offset:0
    ds_write_b32 v14, v34 offset:128
    s_mov_b64 exec, -1
    s_waitcnt lgkmcnt(0)
    s_barrier
p4end_38_b:
    s_cmp_lg_u32 s3, 4
    s_cbranch_scc1 p4pub_40
    s_add_u32 s24, s64, 0x2800000
    s_addc_u32 s25, s65, 0
    s_mov_b32 s26, 0x20000
    s_mov_b32 s27, 0x20000
    v_and_b32 v1, 63, v0
    v_lshlrev_b32 v2, 3, v1
    ds_read_b64 v[4:5], v2
    ds_read_b64 v[6:7], v2 offset:512
    v_lshlrev_b32 v3, 6, v1
    s_lshl_b32 s45, s6, 12
    s_lshl_b32 s46, s7, 3
    s_add_u32 s45, s45, s46
    s_waitcnt lgkmcnt(0)
    v_pk_add_f32 v[4:5], v[4:5], v[6:7]
    buffer_store_dwordx2 v[4:5], v3, s[24:27], s45 offen sc1
p4pub_40:
    s_waitcnt vmcnt(0) lgkmcnt(0)
    s_barrier
    s_cmp_lg_u32 s3, 0
    s_cbranch_scc1 arr_41
    s_lshl_b32 s56, s6, 8
    s_add_u32 s56, s56, 16384
    v_mov_b32 v250, s56
    v_mov_b32 v251, 1
    s_mov_b64 exec, 1
    buffer_atomic_add v251, v250, s[88:91], 0 offen sc1
    s_mov_b64 exec, -1
arr_41:
    s_cmp_lg_u32 s3, 0
    s_cbranch_scc1 wt_42
    v_and_b32 v250, 63, v0
    v_lshlrev_b32 v250, 8, v250
    s_lshl_b32 s56, s6, 8
    s_add_u32 s56, s56, 16384
    v_add_u32 v250, s56, v250
    s_mov_b64 exec, 0x1
    s_mov_b32 s57, 0
wp_43:
    buffer_load_dword v251, v250, s[88:91], 0 offen sc1
    s_add_u32 s57, s57, 1
    s_cmp_gt_u32 s57, 30000
    s_cbranch_scc1 wd_44
    s_waitcnt vmcnt(0)
    v_cmp_le_u32 vcc, 8, v251
    s_nop 1
    s_cmp_eq_u64 vcc, exec
    s_cbranch_scc0 wp_43
wd_44:
    s_mov_b64 exec, -1
wt_42:
    s_barrier
    s_cmp_lt_u32 s3, 4
    s_cbranch_scc1 p4l3b_46
    s_mov_b32 s60, s45
    s_add_u32 s16, s64, 0x1000000
    s_addc_u32 s17, s65, 0
    s_mov_b32 s18, 0x600000
    s_mov_b32 s19, 0x20000
    s_sub_u32 s37, s3, 4
    s_lshl_b32 s38, s37, 12
    v_and_b32 v244, 63, v0
    v_lshlrev_b32 v244, 4, v244
    s_bfe_u32 s29, s2, 0x20001
    s_lshl_b32 s29, s29, 2
    s_lshr_b32 s39, s2, 6
    s_add_u32 s29, s29, s39
    s_mul_i32 s29, s29, 393216
    s_add_u32 s30, s29, s38
    s_add_u32 s30, s30, 8192
    s_add_u32 s41, s38, 16384
    s_add_u32 m0, s41, 0
    s_add_u32 s40, s30, 0
    buffer_load_dwordx4 v244, s[16:19], s40 offen offset:0 sc1 lds
    buffer_load_dwordx4 v244, s[16:19], s40 offen offset:1024 sc1 lds
    buffer_load_dwordx4 v244, s[16:19], s40 offen offset:2048 sc1 lds
    buffer_load_dwordx4 v244, s[16:19], s40 offen offset:3072 sc1 lds
    s_add_u32 m0, s41, 32768
    s_add_u32 s40, s30, 24576
    buffer_load_dwordx4 v244, s[16:19], s40 offen offset:0 sc1 lds
    buffer_load_dwordx4 v244, s[16:19], s40 offen offset:1024 sc1 lds
    buffer_load_dwordx4 v244, s[16:19], s40 offen offset:2048 sc1 lds
    buffer_load_dwordx4 v244, s[16:19], s40 offen offset:3072 sc1 lds
    s_add_u32 m0, s41, 65536
    s_add_u32 s40, s30, 49152
    buffer_load_dwordx4 v244, s[16:19], s40 offen offset:0 sc1 lds
    buffer_load_dwordx4 v244, s[16:19], s40 offen offset:1024 sc1 lds
    buffer_load_dwordx4 v244, s[16:19], s40 offen offset:2048 sc1 lds
    buffer_load_dwordx4 v244, s[16:19], s40 offen offset:3072 sc1 lds
    s_mov_b32 s45, s60
    s_branch p4l3_45
p4l3b_46:
    s_add_u32 s24, s64, 0x2800000
    s_addc_u32 s25, s65, 0
    s_mov_b32 s26, 0x20000
    s_mov_b32 s27, 0x20000
    v_lshlrev_b32 v6, 6, v3
    s_lshl_b32 s45, s6, 12
    s_lshl_b32 s46, s37, 11
    s_add_u32 s45, s45, s46
    buffer_load_dwordx4 v[144:147], v6, s[24:27], s45 offen offset:0 sc1
    buffer_load_dwordx4 v[148:151], v6, s[24:27], s45 offen offset:16 sc1
    buffer_load_dwordx4 v[152:155], v6, s[24:27], s45 offen offset:32 sc1
    buffer_load_dwordx4 v[156:159], v6, s[24:27], s45 offen offset:48 sc1
    buffer_load_dwordx4 v[160:163], v6, s[24:27], s45 offen offset:1024 sc1
    buffer_load_dwordx4 v[164:167], v6, s[24:27], s45 offen offset:1040 sc1
    buffer_load_dwordx4 v[168:171], v6, s[24:27], s45 offen offset:1056 sc1
    buffer_load_dwordx4 v[172:175], v6, s[24:27], s45 offen offset:1072 sc1
    s_add_u32 s24, s64, 0xc00000
    s_addc_u32 s25, s65, 0
    s_mov_b32 s26, 0x400000
    s_mov_b32 s27, 0x20000
    v_lshlrev_b32 v176, 16, v112
    v_and_b32 v177, 0xffff0000, v112
    v_lshlrev_b32 v178, 16, v113
    v_and_b32 v179, 0xffff0000, v113
    v_lshlrev_b32 v180, 16, v114
    v_and_b32 v181, 0xffff0000, v114
    v_lshlrev_b32 v182, 16, v115
    v_and_b32 v183, 0xffff0000, v115
    v_lshlrev_b32 v184, 16, v116
    v_and_b32 v185, 0xffff0000, v116
    v_lshlrev_b32 v186, 16, v117
    v_and_b32 v187, 0xffff0000, v117
    v_lshlrev_b32 v188, 16, v118
    v_and_b32 v189, 0xffff0000, v118
    v_lshlrev_b32 v190, 16, v119
    v_and_b32 v191, 0xffff0000, v119
    v_lshlrev_b32 v192, 16, v120
    v_and_b32 v193, 0xffff0000, v120
    v_lshlrev_b32 v194, 16, v121
    v_and_b32 v195, 0xffff0000, v121
    v_lshlrev_b32 v196, 16, v122
    v_and_b32 v197, 0xffff0000, v122
    v_lshlrev_b32 v198, 16, v123
    v_and_b32 v199, 0xffff0000, v123
    v_lshlrev_b32 v200, 16, v124
    v_and_b32 v201, 0xffff0000, v124
    v_lshlrev_b32 v202, 16, v125
    v_and_b32 v203, 0xffff0000, v125
    v_lshlrev_b32 v204, 16, v126
    v_and_b32 v205, 0xffff0000, v126
    v_lshlrev_b32 v206, 16, v127
    v_and_b32 v207, 0xffff0000, v127
    s_waitcnt vmcnt(0)
    v_pk_add_f32 v[144:145], v[144:145], v[152:153]
    v_pk_add_f32 v[146:147], v[146:147], v[154:155]
    v_pk_add_f32 v[148:149], v[148:149], v[156:157]
    v_pk_add_f32 v[150:151], v[150:151], v[158:159]
    v_pk_add_f32 v[144:145], v[144:145], v[148:149]
    v_pk_add_f32 v[146:147], v[146:147], v[150:151]
    v_pk_add_f32 v[144:145], v[144:145], v[146:147]
    v_mul_f32 v144, 0x3a800000, v144
    v_mul_f32 v145, 0x3a800000, v145
    v_fma_f32 v145, -v144, v144, v145
    v_max_f32 v145, 0, v145
    v_add_f32 v145, 0x3727c5ac, v145
    v_rsq_f32 v208, v145
    s_nop 0
    v_mul_f32 v209, v144, v208
    v_sub_f32 v209, 0, v209
    v_pk_add_f32 v[160:161], v[160:161], v[168:169]
    v_pk_add_f32 v[162:163], v[162:163], v[170:171]
    v_pk_add_f32 v[164:165], v[164:165], v[172:173]
    v_pk_add_f32 v[166:167], v[166:167], v[174:175]
    v_pk_add_f32 v[160:161], v[160:161], v[164:165]
    v_pk_add_f32 v[162:163], v[162:163], v[166:167]
    v_pk_add_f32 v[160:161], v[160:161], v[162:163]
    v_mul_f32 v160, 0x3a800000, v160
    v_mul_f32 v161, 0x3a800000, v161
    v_fma_f32 v161, -v160, v160, v161
    v_max_f32 v161, 0, v161
    v_add_f32 v161, 0x3727c5ac, v161
    v_rsq_f32 v210, v161
    s_nop 0
    v_mul_f32 v211, v160, v210
    v_sub_f32 v211, 0, v211
    v_pk_fma_f32 v[36:37], v[64:65], v[208:209], v[208:209] op_sel:[0,0,1] op_sel_hi:[1,0,1]
    v_pk_fma_f32 v[64:65], v[36:37], v[176:177], v[64:65]
    v_pk_fma_f32 v[36:37], v[66:67], v[208:209], v[208:209] op_sel:[0,0,1] op_sel_hi:[1,0,1]
    v_pk_fma_f32 v[66:67], v[36:37], v[178:179], v[66:67]
    v_pk_fma_f32 v[36:37], v[68:69], v[208:209], v[208:209] op_sel:[0,0,1] op_sel_hi:[1,0,1]
    v_pk_fma_f32 v[68:69], v[36:37], v[180:181], v[68:69]
    v_pk_fma_f32 v[36:37], v[70:71], v[208:209], v[208:209] op_sel:[0,0,1] op_sel_hi:[1,0,1]
    v_pk_fma_f32 v[70:71], v[36:37], v[182:183], v[70:71]
    v_pk_fma_f32 v[36:37], v[72:73], v[208:209], v[208:209] op_sel:[0,0,1] op_sel_hi:[1,0,1]
    v_pk_fma_f32 v[72:73], v[36:37], v[184:185], v[72:73]
    v_pk_fma_f32 v[36:37], v[74:75], v[208:209], v[208:209] op_sel:[0,0,1] op_sel_hi:[1,0,1]
    v_pk_fma_f32 v[74:75], v[36:37], v[186:187], v[74:75]
    v_pk_fma_f32 v[36:37], v[76:77], v[208:209], v[208:209] op_sel:[0,0,1] op_sel_hi:[1,0,1]
    v_pk_fma_f32 v[76:77], v[36:37], v[188:189], v[76:77]
    v_pk_fma_f32 v[36:37], v[78:79], v[208:209], v[208:209] op_sel:[0,0,1] op_sel_hi:[1,0,1]
    v_pk_fma_f32 v[78:79], v[36:37], v[190:191], v[78:79]
    v_cvt_pk_bf16_f32 v96, v64, v65
    v_cvt_pk_bf16_f32 v97, v66, v67
    v_cvt_pk_bf16_f32 v98, v68, v69
    v_cvt_pk_bf16_f32 v99, v70, v71
    buffer_store_dwordx4 v[96:99], v5, s[24:27], s44 offen offset:0 sc1
    v_cvt_pk_bf16_f32 v100, v72, v73
    v_cvt_pk_bf16_f32 v101, v74, v75
    v_cvt_pk_bf16_f32 v102, v76, v77
    v_cvt_pk_bf16_f32 v103, v78, v79
    buffer_store_dwordx4 v[100:103], v5, s[24:27], s44 offen offset:1024 sc1
    v_pk_fma_f32 v[36:37], v[80:81], v[210:211], v[210:211] op_sel:[0,0,1] op_sel_hi:[1,0,1]
    v_pk_fma_f32 v[80:81], v[36:37], v[192:193], v[80:81]
    v_pk_fma_f32 v[36:37], v[82:83], v[210:211], v[210:211] op_sel:[0,0,1] op_sel_hi:[1,0,1]
    v_pk_fma_f32 v[82:83], v[36:37], v[194:195], v[82:83]
    v_pk_fma_f32 v[36:37], v[84:85], v[210:211], v[210:211] op_sel:[0,0,1] op_sel_hi:[1,0,1]
    v_pk_fma_f32 v[84:85], v[36:37], v[196:197], v[84:85]
    v_pk_fma_f32 v[36:37], v[86:87], v[210:211], v[210:211] op_sel:[0,0,1] op_sel_hi:[1,0,1]
    v_pk_fma_f32 v[86:87], v[36:37], v[198:199], v[86:87]
    v_pk_fma_f32 v[36:37], v[88:89], v[210:211], v[210:211] op_sel:[0,0,1] op_sel_hi:[1,0,1]
    v_pk_fma_f32 v[88:89], v[36:37], v[200:201], v[88:89]
    v_pk_fma_f32 v[36:37], v[90:91], v[210:211], v[210:211] op_sel:[0,0,1] op_sel_hi:[1,0,1]
    v_pk_fma_f32 v[90:91], v[36:37], v[202:203], v[90:91]
    v_pk_fma_f32 v[36:37], v[92:93], v[210:211], v[210:211] op_sel:[0,0,1] op_sel_hi:[1,0,1]
    v_pk_fma_f32 v[92:93], v[36:37], v[204:205], v[92:93]
    v_pk_fma_f32 v[36:37], v[94:95], v[210:211], v[210:211] op_sel:[0,0,1] op_sel_hi:[1,0,1]
    v_pk_fma_f32 v[94:95], v[36:37], v[206:207], v[94:95]
    v_cvt_pk_bf16_f32 v104, v80, v81
    v_cvt_pk_bf16_f32 v105, v82, v83
    v_cvt_pk_bf16_f32 v106, v84, v85
    v_cvt_pk_bf16_f32 v107, v86, v87
    buffer_store_dwordx4 v[104:107], v5, s[24:27], s44 offen offset:2048 sc1
    v_cvt_pk_bf16_f32 v108, v88, v89
    v_cvt_pk_bf16_f32 v109, v90, v91
    v_cvt_pk_bf16_f32 v110, v92, v93
    v_cvt_pk_bf16_f32 v111, v94, v95
    buffer_store_dwordx4 v[108:111], v5, s[24:27], s44 offen offset:3072 sc1
    v_lshlrev_b32 v64, 16, v96
    v_and_b32 v65, 0xffff0000, v96
    v_lshlrev_b32 v66, 16, v97
    v_and_b32 v67, 0xffff0000, v97
    v_lshlrev_b32 v68, 16, v98
    v_and_b32 v69, 0xffff0000, v98
    v_lshlrev_b32 v70, 16, v99
    v_and_b32 v71, 0xffff0000, v99
    v_lshlrev_b32 v72, 16, v100
    v_and_b32 v73, 0xffff0000, v100
    v_lshlrev_b32 v74, 16, v101
    v_and_b32 v75, 0xffff0000, v101
    v_lshlrev_b32 v76, 16, v102
    v_and_b32 v77, 0xffff0000, v102
    v_lshlrev_b32 v78, 16, v103
    v_and_b32 v79, 0xffff0000, v103
    v_lshlrev_b32 v80, 16, v104
    v_and_b32 v81, 0xffff0000, v104
    v_lshlrev_b32 v82, 16, v105
    v_and_b32 v83, 0xffff0000, v105
    v_lshlrev_b32 v84, 16, v106
    v_and_b32 v85, 0xffff0000, v106
    v_lshlrev_b32 v86, 16, v107
    v_and_b32 v87, 0xffff0000, v107
    v_lshlrev_b32 v88, 16, v108
    v_and_b32 v89, 0xffff0000, v108
    v_lshlrev_b32 v90, 16, v109
    v_and_b32 v91, 0xffff0000, v109
    v_lshlrev_b32 v92, 16, v110
    v_and_b32 v93, 0xffff0000, v110
    v_lshlrev_b32 v94, 16, v111
    v_and_b32 v95, 0xffff0000, v111
    v_pk_add_f32 v[36:37], v[64:65], v[66:67]
    v_pk_mul_f32 v[38:39], v[64:65], v[64:65]
    v_pk_fma_f32 v[38:39], v[66:67], v[66:67], v[38:39]
    v_pk_add_f32 v[36:37], v[36:37], v[68:69]
    v_pk_fma_f32 v[38:39], v[68:69], v[68:69], v[38:39]
    v_pk_add_f32 v[36:37], v[36:37], v[70:71]
    v_pk_fma_f32 v[38:39], v[70:71], v[70:71], v[38:39]
    v_pk_add_f32 v[36:37], v[36:37], v[72:73]
    v_pk_fma_f32 v[38:39], v[72:73], v[72:73], v[38:39]
    v_pk_add_f32 v[36:37], v[36:37], v[74:75]
    v_pk_fma_f32 v[38:39], v[74:75], v[74:75], v[38:39]
    v_pk_add_f32 v[36:37], v[36:37], v[76:77]
    v_pk_fma_f32 v[38:39], v[76:77], v[76:77], v[38:39]
    v_pk_add_f32 v[36:37], v[36:37], v[78:79]
    v_pk_fma_f32 v[38:39], v[78:79], v[78:79], v[38:39]
    v_add_f32 v32, v36, v37
    v_add_f32 v33, v38, v39
    v_pk_add_f32 v[36:37], v[80:81], v[82:83]
    v_pk_mul_f32 v[38:39], v[80:81], v[80:81]
    v_pk_fma_f32 v[38:39], v[82:83], v[82:83], v[38:39]
    v_pk_add_f32 v[36:37], v[36:37], v[84:85]
    v_pk_fma_f32 v[38:39], v[84:85], v[84:85], v[38:39]
    v_pk_add_f32 v[36:37], v[36:37], v[86:87]
    v_pk_fma_f32 v[38:39], v[86:87], v[86:87], v[38:39]
    v_pk_add_f32 v[36:37], v[36:37], v[88:89]
    v_pk_fma_f32 v[38:39], v[88:89], v[88:89], v[38:39]
    v_pk_add_f32 v[36:37], v[36:37], v[90:91]
    v_pk_fma_f32 v[38:39], v[90:91], v[90:91], v[38:39]
    v_pk_add_f32 v[36:37], v[36:37], v[92:93]
    v_pk_fma_f32 v[38:39], v[92:93], v[92:93], v[38:39]
    v_pk_add_f32 v[36:37], v[36:37], v[94:95]
    v_pk_fma_f32 v[38:39], v[94:95], v[94:95], v[38:39]
    v_add_f32 v34, v36, v37
    v_add_f32 v35, v38, v39
    s_nop 1
    v_permlane32_swap_b32 v32, v33
    v_permlane32_swap_b32 v34, v35
    s_nop 1
    v_add_f32 v32, v32, v33
    v_mov_b32 v33, v32
    v_add_f32 v34, v34, v35
    v_mov_b32 v35, v34
    s_nop 1
    v_permlane16_swap_b32 v32, v33
    v_permlane16_swap_b32 v34, v35
    s_nop 1
    v_add_f32 v32, v32, v33
    v_add_f32 v34, v34, v35
    s_mov_b64 exec, s[48:49]
    ds_write_b32 v14, v32 offset:2048
    ds_write_b32 v14, v34 offset:2176
    s_mov_b64 exec, -1
    s_waitcnt lgkmcnt(0)
p4l3_45:
    s_barrier
    s_cmp_lg_u32 s3, 4
    s_cbranch_scc1 p4pub_47
    s_add_u32 s24, s64, 0x2900000
    s_addc_u32 s25, s65, 0
    s_mov_b32 s26, 0x20000
    s_mov_b32 s27, 0x20000
    ds_read_b64 v[4:5], v2 offset:2048
    ds_read_b64 v[6:7], v2 offset:2560
    s_waitcnt lgkmcnt(0)
    v_pk_add_f32 v[4:5], v[4:5], v[6:7]
    buffer_store_dwordx2 v[4:5], v3, s[24:27], s45 offen sc1
p4pub_47:
p4end_38:
    s_waitcnt vmcnt(0) lgkmcnt(0)
    s_barrier
    s_lshr_b32 s9, s6, 1
    s_cmp_lg_u32 s3, 0
    s_cbranch_scc1 arr_48
    s_lshl_b32 s56, s9, 8
    s_add_u32 s56, s56, 24576
    v_mov_b32 v250, s56
    v_mov_b32 v251, 1
    s_mov_b64 exec, 1
    buffer_atomic_add v251, v250, s[88:91], 0 offen sc1
    s_mov_b64 exec, -1
arr_48:
    s_and_b32 s4, s2, 7
    s_lshr_b32 s5, s2, 3
    s_and_b32 s6, s4, 1
    s_lshl_b32 s6, s6, 3
    s_and_b32 s7, s5, 7
    s_add_u32 s6, s6, s7
    s_lshr_b32 s7, s4, 1
    s_lshl_b32 s7, s7, 2
    s_lshr_b32 s8, s5, 3
    s_add_u32 s7, s7, s8
    s_cmp_lt_u32 s3, 4
    s_cbranch_scc1 p3pre_49
    s_add_u32 s12, s64, 0xc00000
    s_addc_u32 s13, s65, 0
    s_mov_b32 s14, 0x400000
    s_mov_b32 s15, 0x20000
    s_add_u32 s16, s64, 0x1000000
    s_addc_u32 s17, s65, 0
    s_mov_b32 s18, 0x600000
    s_mov_b32 s19, 0x20000
    s_sub_u32 s37, s3, 4
    s_lshl_b32 s38, s37, 12
    s_lshl_b32 s28, s6, 18
    s_add_u32 s28, s28, s38
    v_and_b32 v1, 63, v0
    v_lshlrev_b32 v2, 4, v1
    s_mul_i32 s29, s7, 393216
    s_add_u32 s30, s29, s38
    s_add_u32 s30, s30, 8192
    s_lshl_b32 s39, s37, 11
    s_add_u32 s31, s29, s39
    s_add_u32 s41, s38, 16384
    s_add_u32 s42, s39, 16384
p3pre_49:
    s_cmp_lg_u32 s3, 0
    s_cbranch_scc1 wt_50
    v_and_b32 v250, 63, v0
    v_lshlrev_b32 v250, 8, v250
    s_lshl_b32 s56, s6, 8
    s_add_u32 s56, s56, 24576
    v_add_u32 v250, s56, v250
    s_mov_b64 exec, 0x1
    s_mov_b32 s57, 0
wp_51:
    buffer_load_dword v251, v250, s[88:91], 0 offen sc1
    s_add_u32 s57, s57, 1
    s_cmp_gt_u32 s57, 30000
    s_cbranch_scc1 wd_52
    s_waitcnt vmcnt(0)
    v_cmp_le_u32 vcc, 16, v251
    s_nop 1
    s_cmp_eq_u64 vcc, exec
    s_cbranch_scc0 wp_51
wd_52:
    s_mov_b64 exec, -1
wt_50:
    s_barrier
    s_cmp_lt_u32 s3, 4
    s_cbranch_scc1 p3comp_53
    s_add_u32 m0, s38, 0
    s_add_u32 s40, s28, 0
    buffer_load_dwordx4 v2, s[12:15], s40 offen offset:0 sc1 lds
    buffer_load_dwordx4 v2, s[12:15], s40 offen offset:1024 sc1 lds
    buffer_load_dwordx4 v2, s[12:15], s40 offen offset:2048 sc1 lds
    buffer_load_dwordx4 v2, s[12:15], s40 offen offset:3072 sc1 lds
    s_add_u32 m0, s38, 32768
    s_add_u32 s40, s28, 16384
    buffer_load_dwordx4 v2, s[12:15], s40 offen offset:0 sc1 lds
    buffer_load_dwordx4 v2, s[12:15], s40 offen offset:1024 sc1 lds
    buffer_load_dwordx4 v2, s[12:15], s40 offen offset:2048 sc1 lds
    buffer_load_dwordx4 v2, s[12:15], s40 offen offset:3072 sc1 lds
    s_add_u32 m0, s38, 65536
    s_add_u32 s40, s28, 32768
    buffer_load_dwordx4 v2, s[12:15], s40 offen offset:0 sc1 lds
    buffer_load_dwordx4 v2, s[12:15], s40 offen offset:1024 sc1 lds
    buffer_load_dwordx4 v2, s[12:15], s40 offen offset:2048 sc1 lds
    buffer_load_dwordx4 v2, s[12:15], s40 offen offset:3072 sc1 lds
    s_lshl_b32 s43, s6, 7
    s_lshl_b32 s44, s37, 5
    s_add_u32 s43, s43, s44
    s_add_u32 s20, s64, 0x2900000
    s_addc_u32 s21, s65, 0
    s_mov_b32 s22, 0x20000
    s_mov_b32 s23, 0x20000
    v_lshlrev_b32 v3, 6, v1
    s_lshl_b32 s43, s43, 6
    s_add_u32 s24, s64, 0x2700000
    s_addc_u32 s25, s65, 0
    s_mov_b32 s26, 0xc000
    s_mov_b32 s27, 0x20000
    v_lshlrev_b32 v9, 2, v1
    s_lshl_b32 s45, s37, 12
    s_lshl_b32 s44, s7, 8
    s_add_u32 s45, s45, s44
    s_cmp_eq_u32 s37, 3
    s_cselect_b32 s45, 0x7f000000, s45
    s_waitcnt vmcnt(8)
    s_barrier
    s_add_u32 m0, s38, 98304
    s_add_u32 s40, s28, 49152
    buffer_load_dwordx4 v2, s[12:15], s40 offen offset:0 sc1 lds
    buffer_load_dwordx4 v2, s[12:15], s40 offen offset:1024 sc1 lds
    buffer_load_dwordx4 v2, s[12:15], s40 offen offset:2048 sc1 lds
    buffer_load_dwordx4 v2, s[12:15], s40 offen offset:3072 sc1 lds
    s_add_u32 m0, s41, 98304
    s_add_u32 s40, s30, 73728
    buffer_load_dwordx4 v2, s[16:19], s40 offen offset:0 sc1 lds
    buffer_load_dwordx4 v2, s[16:19], s40 offen offset:1024 sc1 lds
    buffer_load_dwordx4 v2, s[16:19], s40 offen offset:2048 sc1 lds
    buffer_load_dwordx4 v2, s[16:19], s40 offen offset:3072 sc1 lds
    s_waitcnt vmcnt(12)
    s_barrier
    s_add_u32 m0, s38, 0
    s_add_u32 s40, s28, 65536
    buffer_load_dwordx4 v2, s[12:15], s40 offen offset:0 sc1 lds
    buffer_load_dwordx4 v2, s[12:15], s40 offen offset:1024 sc1 lds
    buffer_load_dwordx4 v2, s[12:15], s40 offen offset:2048 sc1 lds
    buffer_load_dwordx4 v2, s[12:15], s40 offen offset:3072 sc1 lds
    s_add_u32 m0, s41, 0
    s_add_u32 s40, s30, 98304
    buffer_load_dwordx4 v2, s[16:19], s40 offen offset:0 sc1 lds
    buffer_load_dwordx4 v2, s[16:19], s40 offen offset:1024 sc1 lds
    buffer_load_dwordx4 v2, s[16:19], s40 offen offset:2048 sc1 lds
    buffer_load_dwordx4 v2, s[16:19], s40 offen offset:3072 sc1 lds
    s_waitcnt vmcnt(16)
    s_barrier
    s_add_u32 m0, s38, 32768
    s_add_u32 s40, s28, 81920
    buffer_load_dwordx4 v2, s[12:15], s40 offen offset:0 sc1 lds
    buffer_load_dwordx4 v2, s[12:15], s40 offen offset:1024 sc1 lds
    buffer_load_dwordx4 v2, s[12:15], s40 offen offset:2048 sc1 lds
    buffer_load_dwordx4 v2, s[12:15], s40 offen offset:3072 sc1 lds
    s_add_u32 m0, s41, 32768
    s_add_u32 s40, s30, 122880
    buffer_load_dwordx4 v2, s[16:19], s40 offen offset:0 sc1 lds
    buffer_load_dwordx4 v2, s[16:19], s40 offen offset:1024 sc1 lds
    buffer_load_dwordx4 v2, s[16:19], s40 offen offset:2048 sc1 lds
    buffer_load_dwordx4 v2, s[16:19], s40 offen offset:3072 sc1 lds
    s_waitcnt vmcnt(16)
    s_barrier
    s_add_u32 m0, s38, 65536
    s_add_u32 s40, s28, 98304
    buffer_load_dwordx4 v2, s[12:15], s40 offen offset:0 sc1 lds
    buffer_load_dwordx4 v2, s[12:15], s40 offen offset:1024 sc1 lds
    buffer_load_dwordx4 v2, s[12:15], s40 offen offset:2048 sc1 lds
    buffer_load_dwordx4 v2, s[12:15], s40 offen offset:3072 sc1 lds
    s_add_u32 m0, s41, 65536
    s_add_u32 s40, s30, 147456
    buffer_load_dwordx4 v2, s[16:19], s40 offen offset:0 sc1 lds
    buffer_load_dwordx4 v2, s[16:19], s40 offen offset:1024 sc1 lds
    buffer_load_dwordx4 v2, s[16:19], s40 offen offset:2048 sc1 lds
    buffer_load_dwordx4 v2, s[16:19], s40 offen offset:3072 sc1 lds
    s_waitcnt vmcnt(16)
    s_barrier
    s_add_u32 m0, s38, 98304
    s_add_u32 s40, s28, 114688
    buffer_load_dwordx4 v2, s[12:15], s40 offen offset:0 sc1 lds
    buffer_load_dwordx4 v2, s[12:15], s40 offen offset:1024 sc1 lds
    buffer_load_dwordx4 v2, s[12:15], s40 offen offset:2048 sc1 lds
    buffer_load_dwordx4 v2, s[12:15], s40 offen offset:3072 sc1 lds
    s_add_u32 m0, s41, 98304
    s_add_u32 s40, s30, 172032
    buffer_load_dwordx4 v2, s[16:19], s40 offen offset:0 sc1 lds
    buffer_load_dwordx4 v2, s[16:19], s40 offen offset:1024 sc1 lds
    buffer_load_dwordx4 v2, s[16:19], s40 offen offset:2048 sc1 lds
    buffer_load_dwordx4 v2, s[16:19], s40 offen offset:3072 sc1 lds
    s_waitcnt vmcnt(16)
    s_barrier
    s_add_u32 m0, s38, 0
    s_add_u32 s40, s28, 131072
    buffer_load_dwordx4 v2, s[12:15], s40 offen offset:0 sc1 lds
    buffer_load_dwordx4 v2, s[12:15], s40 offen offset:1024 sc1 lds
    buffer_load_dwordx4 v2, s[12:15], s40 offen offset:2048 sc1 lds
    buffer_load_dwordx4 v2, s[12:15], s40 offen offset:3072 sc1 lds
    s_add_u32 m0, s41, 0
    s_add_u32 s40, s30, 196608
    buffer_load_dwordx4 v2, s[16:19], s40 offen offset:0 sc1 lds
    buffer_load_dwordx4 v2, s[16:19], s40 offen offset:1024 sc1 lds
    buffer_load_dwordx4 v2, s[16:19], s40 offen offset:2048 sc1 lds
    buffer_load_dwordx4 v2, s[16:19], s40 offen offset:3072 sc1 lds
    s_waitcnt vmcnt(16)
    s_barrier
    s_add_u32 m0, s38, 32768
    s_add_u32 s40, s28, 147456
    buffer_load_dwordx4 v2, s[12:15], s40 offen offset:0 sc1 lds
    buffer_load_dwordx4 v2, s[12:15], s40 offen offset:1024 sc1 lds
    buffer_load_dwordx4 v2, s[12:15], s40 offen offset:2048 sc1 lds
    buffer_load_dwordx4 v2, s[12:15], s40 offen offset:3072 sc1 lds
    s_add_u32 m0, s41, 32768
    s_add_u32 s40, s30, 221184
    buffer_load_dwordx4 v2, s[16:19], s40 offen offset:0 sc1 lds
    buffer_load_dwordx4 v2, s[16:19], s40 offen offset:1024 sc1 lds
    buffer_load_dwordx4 v2, s[16:19], s40 offen offset:2048 sc1 lds
    buffer_load_dwordx4 v2, s[16:19], s40 offen offset:3072 sc1 lds
    s_waitcnt vmcnt(16)
    s_barrier
    s_add_u32 m0, s38, 65536
    s_add_u32 s40, s28, 163840
    buffer_load_dwordx4 v2, s[12:15], s40 offen offset:0 sc1 lds
    buffer_load_dwordx4 v2, s[12:15], s40 offen offset:1024 sc1 lds
    buffer_load_dwordx4 v2, s[12:15], s40 offen offset:2048 sc1 lds
    buffer_load_dwordx4 v2, s[12:15], s40 offen offset:3072 sc1 lds
    s_add_u32 m0, s41, 65536
    s_add_u32 s40, s30, 245760
    buffer_load_dwordx4 v2, s[16:19], s40 offen offset:0 sc1 lds
    buffer_load_dwordx4 v2, s[16:19], s40 offen offset:1024 sc1 lds
    buffer_load_dwordx4 v2, s[16:19], s40 offen offset:2048 sc1 lds
    buffer_load_dwordx4 v2, s[16:19], s40 offen offset:3072 sc1 lds
    s_waitcnt vmcnt(16)
    s_barrier
    s_add_u32 m0, s38, 98304
    s_add_u32 s40, s28, 180224
    buffer_load_dwordx4 v2, s[12:15], s40 offen offset:0 sc1 lds
    buffer_load_dwordx4 v2, s[12:15], s40 offen offset:1024 sc1 lds
    buffer_load_dwordx4 v2, s[12:15], s40 offen offset:2048 sc1 lds
    buffer_load_dwordx4 v2, s[12:15], s40 offen offset:3072 sc1 lds
    s_add_u32 m0, s41, 98304
    s_add_u32 s40, s30, 270336
    buffer_load_dwordx4 v2, s[16:19], s40 offen offset:0 sc1 lds
    buffer_load_dwordx4 v2, s[16:19], s40 offen offset:1024 sc1 lds
    buffer_load_dwordx4 v2, s[16:19], s40 offen offset:2048 sc1 lds
    buffer_load_dwordx4 v2, s[16:19], s40 offen offset:3072 sc1 lds
    s_waitcnt vmcnt(16)
    s_barrier
    s_add_u32 m0, s38, 0
    s_add_u32 s40, s28, 196608
    buffer_load_dwordx4 v2, s[12:15], s40 offen offset:0 sc1 lds
    buffer_load_dwordx4 v2, s[12:15], s40 offen offset:1024 sc1 lds
    buffer_load_dwordx4 v2, s[12:15], s40 offen offset:2048 sc1 lds
    buffer_load_dwordx4 v2, s[12:15], s40 offen offset:3072 sc1 lds
    s_add_u32 m0, s41, 0
    s_add_u32 s40, s30, 294912
    buffer_load_dwordx4 v2, s[16:19], s40 offen offset:0 sc1 lds
    buffer_load_dwordx4 v2, s[16:19], s40 offen offset:1024 sc1 lds
    buffer_load_dwordx4 v2, s[16:19], s40 offen offset:2048 sc1 lds
    buffer_load_dwordx4 v2, s[16:19], s40 offen offset:3072 sc1 lds
    s_waitcnt vmcnt(16)
    s_barrier
    s_add_u32 m0, s38, 32768
    s_add_u32 s40, s28, 212992
    buffer_load_dwordx4 v2, s[12:15], s40 offen offset:0 sc1 lds
    buffer_load_dwordx4 v2, s[12:15], s40 offen offset:1024 sc1 lds
    buffer_load_dwordx4 v2, s[12:15], s40 offen offset:2048 sc1 lds
    buffer_load_dwordx4 v2, s[12:15], s40 offen offset:3072 sc1 lds
    s_add_u32 m0, s41, 32768
    s_add_u32 s40, s30, 319488
    buffer_load_dwordx4 v2, s[16:19], s40 offen offset:0 sc1 lds
    buffer_load_dwordx4 v2, s[16:19], s40 offen offset:1024 sc1 lds
    buffer_load_dwordx4 v2, s[16:19], s40 offen offset:2048 sc1 lds
    buffer_load_dwordx4 v2, s[16:19], s40 offen offset:3072 sc1 lds
    s_waitcnt vmcnt(16)
    s_barrier
    s_add_u32 m0, s38, 65536
    s_add_u32 s40, s28, 229376
    buffer_load_dwordx4 v2, s[12:15], s40 offen offset:0 sc1 lds
    buffer_load_dwordx4 v2, s[12:15], s40 offen offset:1024 sc1 lds
    buffer_load_dwordx4 v2, s[12:15], s40 offen offset:2048 sc1 lds
    buffer_load_dwordx4 v2, s[12:15], s40 offen offset:3072 sc1 lds
    s_add_u32 m0, s41, 65536
    s_add_u32 s40, s30, 344064
    buffer_load_dwordx4 v2, s[16:19], s40 offen offset:0 sc1 lds
    buffer_load_dwordx4 v2, s[16:19], s40 offen offset:1024 sc1 lds
    buffer_load_dwordx4 v2, s[16:19], s40 offen offset:2048 sc1 lds
    buffer_load_dwordx4 v2, s[16:19], s40 offen offset:3072 sc1 lds
    s_waitcnt vmcnt(16)
    s_barrier
    s_add_u32 m0, s38, 98304
    s_add_u32 s40, s28, 245760
    buffer_load_dwordx4 v2, s[12:15], s40 offen offset:0 sc1 lds
    buffer_load_dwordx4 v2, s[12:15], s40 offen offset:1024 sc1 lds
    buffer_load_dwordx4 v2, s[12:15], s40 offen offset:2048 sc1 lds
    buffer_load_dwordx4 v2, s[12:15], s40 offen offset:3072 sc1 lds
    s_add_u32 m0, s41, 98304
    s_add_u32 s40, s30, 368640
    buffer_load_dwordx4 v2, s[16:19], s40 offen offset:0 sc1 lds
    buffer_load_dwordx4 v2, s[16:19], s40 offen offset:1024 sc1 lds
    buffer_load_dwordx4 v2, s[16:19], s40 offen offset:2048 sc1 lds
    buffer_load_dwordx4 v2, s[16:19], s40 offen offset:3072 sc1 lds
    s_mov_b64 exec, 0xffffffff
    buffer_load_dwordx4 v[16:19], v3, s[20:23], s43 offen offset:0 sc1
    buffer_load_dwordx4 v[20:23], v3, s[20:23], s43 offen offset:16 sc1
    buffer_load_dwordx4 v[24:27], v3, s[20:23], s43 offen offset:32 sc1
    buffer_load_dwordx4 v[28:31], v3, s[20:23], s43 offen offset:48 sc1
    s_mov_b64 exec, -1
    s_add_u32 s44, s45, 0
    buffer_load_dword v32, v9, s[24:27], s44 offen sc1
    s_add_u32 s44, s45, 12288
    buffer_load_dword v33, v9, s[24:27], s44 offen sc1
    s_add_u32 s44, s45, 24576
    buffer_load_dword v34, v9, s[24:27], s44 offen sc1
    s_add_u32 s44, s45, 36864
    buffer_load_dword v35, v9, s[24:27], s44 offen sc1
    s_waitcnt vmcnt(24)
    s_barrier
    s_add_u32 m0, s42, 0
    s_add_u32 s40, s31, 294912
    buffer_load_dwordx4 v2, s[16:19], s40 offen offset:0 sc1 lds
    buffer_load_dwordx4 v2, s[16:19], s40 offen offset:1024 sc1 lds
    s_waitcnt vmcnt(18)
    s_barrier
    s_add_u32 m0, s42, 32768
    s_add_u32 s40, s31, 319488
    buffer_load_dwordx4 v2, s[16:19], s40 offen offset:0 sc1 lds
    buffer_load_dwordx4 v2, s[16:19], s40 offen offset:1024 sc1 lds
    s_waitcnt vmcnt(12)
    s_barrier
    s_add_u32 m0, s42, 65536
    s_add_u32 s40, s31, 344064
    buffer_load_dwordx4 v2, s[16:19], s40 offen offset:0 sc1 lds
    buffer_load_dwordx4 v2, s[16:19], s40 offen offset:1024 sc1 lds
    s_waitcnt vmcnt(6)
    v_add_f32 v32, v32, v33
    v_add_f32 v34, v34, v35
    v_add_f32 v32, v32, v34
    s_lshl_b32 s44, s37, 8
    v_add_u32 v10, s44, v9
    v_add_u32 v10, 132096, v10
    ds_write_b32 v10, v32
    v_pk_add_f32 v[16:17], v[16:17], v[18:19]
    v_pk_add_f32 v[20:21], v[20:21], v[22:23]
    v_pk_add_f32 v[24:25], v[24:25], v[26:27]
    v_pk_add_f32 v[28:29], v[28:29], v[30:31]
    v_pk_add_f32 v[16:17], v[16:17], v[20:21]
    v_pk_add_f32 v[24:25], v[24:25], v[28:29]
    v_pk_add_f32 v[16:17], v[16:17], v[24:25]
    v_mul_f32 v16, 0x3a800000, v16
    v_mul_f32 v17, 0x3a800000, v17
    v_fma_f32 v17, -v16, v16, v17
    v_max_f32 v17, 0, v17
    v_add_f32 v17, 0x3727c5ac, v17
    v_rsq_f32 v18, v17
    s_nop 0
    v_mul_f32 v19, v16, v18
    v_sub_f32 v19, 0, v19
    v_lshlrev_b32 v4, 2, v1
    s_lshl_b32 s44, s37, 7
    s_add_u32 s44, s44, 131072
    v_add_u32 v4, s44, v4
    s_mov_b64 exec, 0xffffffff
    ds_write_b32 v4, v18
    ds_write_b32 v4, v19 offset:512
    s_mov_b64 exec, -1
    s_waitcnt lgkmcnt(0)
    s_barrier
    s_waitcnt vmcnt(4)
    s_barrier
    s_add_u32 m0, s42, 98304
    s_add_u32 s40, s31, 368640
    buffer_load_dwordx4 v2, s[16:19], s40 offen offset:0 sc1 lds
    buffer_load_dwordx4 v2, s[16:19], s40 offen offset:1024 sc1 lds
    s_add_u32 s24, s64, 0x2422000
    s_addc_u32 s25, s65, 0
    s_mov_b32 s26, 0x22000
    s_mov_b32 s27, 0x20000
    s_lshr_b32 s46, s37, 1
    s_and_b32 s47, s37, 1
    s_mul_i32 s48, s46, 12288
    s_lshl_b32 s49, s47, 11
    s_add_u32 s48, s48, s49
    s_add_u32 s48, s48, 133120
    v_add_u32 v5, s48, v9
    ds_read_b32 v16, v5 offset:0
    ds_read_b32 v24, v5 offset:6144
    ds_read_b32 v17, v5 offset:256
    ds_read_b32 v25, v5 offset:6400
    ds_read_b32 v18, v5 offset:512
    ds_read_b32 v26, v5 offset:6656
    ds_read_b32 v19, v5 offset:768
    ds_read_b32 v27, v5 offset:6912
    ds_read_b32 v20, v5 offset:1024
    ds_read_b32 v28, v5 offset:7168
    ds_read_b32 v21, v5 offset:1280
    ds_read_b32 v29, v5 offset:7424
    ds_read_b32 v22, v5 offset:1536
    ds_read_b32 v30, v5 offset:7680
    ds_read_b32 v23, v5 offset:1792
    ds_read_b32 v31, v5 offset:7936
    v_bfe_u32 v6, v1, 4, 1
    v_lshlrev_b32 v6, 10, v6
    v_bfe_u32 v7, v1, 2, 2
    v_lshl_add_u32 v6, v7, 8, v6
    v_and_b32 v7, 3, v1
    v_lshl_add_u32 v6, v7, 2, v6
    s_mul_i32 s50, s46, 12288
    s_add_u32 s50, s50, 137216
    v_add_u32 v6, s50, v6
    ds_read_b32 v32, v6
    ds_read_b32 v33, v6 offset:6144
    s_lshl_b32 s50, s7, 1
    s_add_u32 s50, s50, s46
    s_mul_i32 s50, s50, 4352
    s_add_u32 s51, s50, s49
    s_add_u32 s52, s50, 4096
    s_cmp_lg_u32 s47, 0
    s_cselect_b32 s52, 0x7f000000, s52
    s_waitcnt lgkmcnt(0)
    v_add_f32 v16, v16, v24
    buffer_atomic_add_f32 v16, v9, s[24:27], s51 offen offset:0 sc1
    v_add_f32 v17, v17, v25
    buffer_atomic_add_f32 v17, v9, s[24:27], s51 offen offset:256 sc1
    v_add_f32 v18, v18, v26
    buffer_atomic_add_f32 v18, v9, s[24:27], s51 offen offset:512 sc1
    v_add_f32 v19, v19, v27
    buffer_atomic_add_f32 v19, v9, s[24:27], s51 offen offset:768 sc1
    v_add_f32 v20, v20, v28
    buffer_atomic_add_f32 v20, v9, s[24:27], s51 offen offset:1024 sc1
    v_add_f32 v21, v21, v29
    buffer_atomic_add_f32 v21, v9, s[24:27], s51 offen offset:1280 sc1
    v_add_f32 v22, v22, v30
    buffer_atomic_add_f32 v22, v9, s[24:27], s51 offen offset:1536 sc1
    v_add_f32 v23, v23, v31
    buffer_atomic_add_f32 v23, v9, s[24:27], s51 offen offset:1792 sc1
    v_add_f32 v32, v32, v33
    s_mov_b64 exec, 0xffffffff
    buffer_atomic_add_f32 v32, v9, s[24:27], s52 offen sc1
    s_mov_b64 exec, -1
    s_waitcnt vmcnt(13)
    s_barrier
    s_add_u32 m0, s38, 0
    s_add_u32 s40, s28, 0
    buffer_load_dwordx4 v2, s[12:15], s40 offen offset:0 sc1 lds
    buffer_load_dwordx4 v2, s[12:15], s40 offen offset:1024 sc1 lds
    buffer_load_dwordx4 v2, s[12:15], s40 offen offset:2048 sc1 lds
    buffer_load_dwordx4 v2, s[12:15], s40 offen offset:3072 sc1 lds
    s_add_u32 m0, s42, 0
    s_add_u32 s40, s31, 0
    buffer_load_dwordx4 v2, s[16:19], s40 offen offset:0 sc1 lds
    buffer_load_dwordx4 v2, s[16:19], s40 offen offset:1024 sc1 lds
    s_waitcnt vmcnt(17)
    s_barrier
    s_add_u32 m0, s38, 32768
    s_add_u32 s40, s28, 16384
    buffer_load_dwordx4 v2, s[12:15], s40 offen offset:0 sc1 lds
    buffer_load_dwordx4 v2, s[12:15], s40 offen offset:1024 sc1 lds
    buffer_load_dwordx4 v2, s[12:15], s40 offen offset:2048 sc1 lds
    buffer_load_dwordx4 v2, s[12:15], s40 offen offset:3072 sc1 lds
    s_add_u32 m0, s42, 32768
    s_add_u32 s40, s31, 24576
    buffer_load_dwordx4 v2, s[16:19], s40 offen offset:0 sc1 lds
    buffer_load_dwordx4 v2, s[16:19], s40 offen offset:1024 sc1 lds
    s_waitcnt vmcnt(21)
    s_barrier
    s_add_u32 m0, s38, 65536
    s_add_u32 s40, s28, 32768
    buffer_load_dwordx4 v2, s[12:15], s40 offen offset:0 sc1 lds
    buffer_load_dwordx4 v2, s[12:15], s40 offen offset:1024 sc1 lds
    buffer_load_dwordx4 v2, s[12:15], s40 offen offset:2048 sc1 lds
    buffer_load_dwordx4 v2, s[12:15], s40 offen offset:3072 sc1 lds
    s_add_u32 m0, s42, 65536
    s_add_u32 s40, s31, 49152
    buffer_load_dwordx4 v2, s[16:19], s40 offen offset:0 sc1 lds
    buffer_load_dwordx4 v2, s[16:19], s40 offen offset:1024 sc1 lds
    s_waitcnt vmcnt(12)
    s_barrier
    s_add_u32 m0, s38, 98304
    s_add_u32 s40, s28, 49152
    buffer_load_dwordx4 v2, s[12:15], s40 offen offset:0 sc1 lds
    buffer_load_dwordx4 v2, s[12:15], s40 offen offset:1024 sc1 lds
    buffer_load_dwordx4 v2, s[12:15], s40 offen offset:2048 sc1 lds
    buffer_load_dwordx4 v2, s[12:15], s40 offen offset:3072 sc1 lds
    s_add_u32 m0, s42, 98304
    s_add_u32 s40, s31, 73728
    buffer_load_dwordx4 v2, s[16:19], s40 offen offset:0 sc1 lds
    buffer_load_dwordx4 v2, s[16:19], s40 offen offset:1024 sc1 lds
    s_cmp_lg_u32 s3, 4
    s_cbranch_scc1 p3ga_55
    s_lshl_b32 s56, s7, 8
    s_add_u32 s56, s56, 49152
    v_mov_b32 v40, s56
    v_mov_b32 v41, 1
    s_mov_b64 exec, 1
    buffer_atomic_add v41, v40, s[88:91], 0 offen sc1
    s_mov_b64 exec, -1
p3ga_55:
    s_waitcnt vmcnt(12)
    s_barrier
    s_add_u32 m0, s38, 0
    s_add_u32 s40, s28, 65536
    buffer_load_dwordx4 v2, s[12:15], s40 offen offset:0 sc1 lds
    buffer_load_dwordx4 v2, s[12:15], s40 offen offset:1024 sc1 lds
    buffer_load_dwordx4 v2, s[12:15], s40 offen offset:2048 sc1 lds
    buffer_load_dwordx4 v2, s[12:15], s40 offen offset:3072 sc1 lds
    s_add_u32 m0, s42, 0
    s_add_u32 s40, s31, 98304
    buffer_load_dwordx4 v2, s[16:19], s40 offen offset:0 sc1 lds
    buffer_load_dwordx4 v2, s[16:19], s40 offen offset:1024 sc1 lds
    s_waitcnt vmcnt(12)
    s_barrier
    s_add_u32 m0, s38, 32768
    s_add_u32 s40, s28, 81920
    buffer_load_dwordx4 v2, s[12:15], s40 offen offset:0 sc1 lds
    buffer_load_dwordx4 v2, s[12:15], s40 offen offset:1024 sc1 lds
    buffer_load_dwordx4 v2, s[12:15], s40 offen offset:2048 sc1 lds
    buffer_load_dwordx4 v2, s[12:15], s40 offen offset:3072 sc1 lds
    s_add_u32 m0, s42, 32768
    s_add_u32 s40, s31, 122880
    buffer_load_dwordx4 v2, s[16:19], s40 offen offset:0 sc1 lds
    buffer_load_dwordx4 v2, s[16:19], s40 offen offset:1024 sc1 lds
    s_waitcnt vmcnt(12)
    s_barrier
    s_add_u32 m0, s38, 65536
    s_add_u32 s40, s28, 98304
    buffer_load_dwordx4 v2, s[12:15], s40 offen offset:0 sc1 lds
    buffer_load_dwordx4 v2, s[12:15], s40 offen offset:1024 sc1 lds
    buffer_load_dwordx4 v2, s[12:15], s40 offen offset:2048 sc1 lds
    buffer_load_dwordx4 v2, s[12:15], s40 offen offset:3072 sc1 lds
    s_add_u32 m0, s42, 65536
    s_add_u32 s40, s31, 147456
    buffer_load_dwordx4 v2, s[16:19], s40 offen offset:0 sc1 lds
    buffer_load_dwordx4 v2, s[16:19], s40 offen offset:1024 sc1 lds
    s_waitcnt vmcnt(12)
    s_barrier
    s_add_u32 m0, s38, 98304
    s_add_u32 s40, s28, 114688
    buffer_load_dwordx4 v2, s[12:15], s40 offen offset:0 sc1 lds
    buffer_load_dwordx4 v2, s[12:15], s40 offen offset:1024 sc1 lds
    buffer_load_dwordx4 v2, s[12:15], s40 offen offset:2048 sc1 lds
    buffer_load_dwordx4 v2, s[12:15], s40 offen offset:3072 sc1 lds
    s_add_u32 m0, s42, 98304
    s_add_u32 s40, s31, 172032
    buffer_load_dwordx4 v2, s[16:19], s40 offen offset:0 sc1 lds
    buffer_load_dwordx4 v2, s[16:19], s40 offen offset:1024 sc1 lds
    s_waitcnt vmcnt(12)
    s_barrier
    s_add_u32 m0, s38, 0
    s_add_u32 s40, s28, 131072
    buffer_load_dwordx4 v2, s[12:15], s40 offen offset:0 sc1 lds
    buffer_load_dwordx4 v2, s[12:15], s40 offen offset:1024 sc1 lds
    buffer_load_dwordx4 v2, s[12:15], s40 offen offset:2048 sc1 lds
    buffer_load_dwordx4 v2, s[12:15], s40 offen offset:3072 sc1 lds
    s_add_u32 m0, s42, 0
    s_add_u32 s40, s31, 196608
    buffer_load_dwordx4 v2, s[16:19], s40 offen offset:0 sc1 lds
    buffer_load_dwordx4 v2, s[16:19], s40 offen offset:1024 sc1 lds
    s_waitcnt vmcnt(12)
    s_barrier
    s_add_u32 m0, s38, 32768
    s_add_u32 s40, s28, 147456
    buffer_load_dwordx4 v2, s[12:15], s40 offen offset:0 sc1 lds
    buffer_load_dwordx4 v2, s[12:15], s40 offen offset:1024 sc1 lds
    buffer_load_dwordx4 v2, s[12:15], s40 offen offset:2048 sc1 lds
    buffer_load_dwordx4 v2, s[12:15], s40 offen offset:3072 sc1 lds
    s_add_u32 m0, s42, 32768
    s_add_u32 s40, s31, 221184
    buffer_load_dwordx4 v2, s[16:19], s40 offen offset:0 sc1 lds
    buffer_load_dwordx4 v2, s[16:19], s40 offen offset:1024 sc1 lds
    s_waitcnt vmcnt(12)
    s_barrier
    s_add_u32 m0, s38, 65536
    s_add_u32 s40, s28, 163840
    buffer_load_dwordx4 v2, s[12:15], s40 offen offset:0 sc1 lds
    buffer_load_dwordx4 v2, s[12:15], s40 offen offset:1024 sc1 lds
    buffer_load_dwordx4 v2, s[12:15], s40 offen offset:2048 sc1 lds
    buffer_load_dwordx4 v2, s[12:15], s40 offen offset:3072 sc1 lds
    s_add_u32 m0, s42, 65536
    s_add_u32 s40, s31, 245760
    buffer_load_dwordx4 v2, s[16:19], s40 offen offset:0 sc1 lds
    buffer_load_dwordx4 v2, s[16:19], s40 offen offset:1024 sc1 lds
    s_waitcnt vmcnt(12)
    s_barrier
    s_add_u32 m0, s38, 98304
    s_add_u32 s40, s28, 180224
    buffer_load_dwordx4 v2, s[12:15], s40 offen offset:0 sc1 lds
    buffer_load_dwordx4 v2, s[12:15], s40 offen offset:1024 sc1 lds
    buffer_load_dwordx4 v2, s[12:15], s40 offen offset:2048 sc1 lds
    buffer_load_dwordx4 v2, s[12:15], s40 offen offset:3072 sc1 lds
    s_add_u32 m0, s42, 98304
    s_add_u32 s40, s31, 270336
    buffer_load_dwordx4 v2, s[16:19], s40 offen offset:0 sc1 lds
    buffer_load_dwordx4 v2, s[16:19], s40 offen offset:1024 sc1 lds
    s_waitcnt vmcnt(12)
    s_barrier
    s_cmp_lg_u32 s3, 4
    s_cbranch_scc1 p3gp_56
    s_lshl_b32 s56, s7, 8
    s_add_u32 s56, s56, 49152
    v_mov_b32 v40, s56
    s_mov_b64 exec, 1
    s_mov_b32 s57, 0
cgp_57:
    buffer_load_dword v41, v40, s[88:91], 0 offen sc1
    s_add_u32 s57, s57, 1
    s_cmp_gt_u32 s57, 30000
    s_cbranch_scc1 cgd_58
    s_waitcnt vmcnt(0)
    v_cmp_le_u32 vcc, 16, v41
    s_nop 1
    s_cmp_eq_u64 vcc, exec
    s_cbranch_scc0 cgp_57
cgd_58:
    s_mov_b64 exec, -1
p3gp_56:
    s_waitcnt vmcnt(6)
    s_barrier
    s_add_u32 s24, s64, 0x2422000
    s_addc_u32 s25, s65, 0
    s_mov_b32 s26, 0x22000
    s_mov_b32 s27, 0x20000
    s_lshl_b32 s50, s7, 1
    s_mul_i32 s50, s50, 4352
    s_lshl_b32 s51, s37, 10
    s_add_u32 s51, s51, s50
    s_add_u32 s52, s51, 0
    buffer_load_dwordx4 v[16:19], v2, s[24:27], s52 offen sc1
    s_add_u32 s52, s51, 4352
    buffer_load_dwordx4 v[20:23], v2, s[24:27], s52 offen sc1
    v_bfe_u32 v5, v1, 3, 1
    v_bfe_u32 v6, v1, 2, 1
    v_and_b32 v7, 3, v1
    v_mul_u32_u24 v8, 4352, v5
    v_lshl_add_u32 v8, v6, 6, v8
    v_lshl_add_u32 v8, v7, 4, v8
    s_add_u32 s52, s50, 4096
    s_mov_b64 exec, 0xffff
    buffer_load_dwordx4 v[24:27], v8, s[24:27], s52 offen sc1
    s_mov_b64 exec, -1
    v_lshlrev_b32 v10, 6, v5
    v_lshl_add_u32 v10, v7, 4, v10
    v_lshl_add_u32 v10, v6, 3, v10
    v_add_u32 v10, 161792, v10
    s_lshr_b32 s53, s37, 1
    s_lshl_b32 s53, s53, 10
    s_and_b32 s54, s37, 1
    s_lshl_b32 s54, s54, 3
    s_add_u32 s53, s53, s54
    s_add_u32 s53, s53, 157696
    v_add_u32 v11, s53, v2
    s_waitcnt vmcnt(3)
    s_barrier
    s_waitcnt vmcnt(0)
    v_cvt_pk_bf16_f32 v16, v16, v17
    v_cvt_pk_bf16_f32 v17, v18, v19
    ds_write_b64 v11, v[16:17] offset:0
    v_cvt_pk_bf16_f32 v20, v20, v21
    v_cvt_pk_bf16_f32 v21, v22, v23
    ds_write_b64 v11, v[20:21] offset:2048
    v_cvt_pk_bf16_f32 v24, v24, v25
    v_cvt_pk_bf16_f32 v25, v26, v27
    s_mov_b64 exec, 0xffff
    ds_write_b64 v10, v[24:25]
    s_mov_b64 exec, -1
    s_waitcnt lgkmcnt(0)
    s_barrier
    s_add_u32 s16, s64, 0x1800000
    s_addc_u32 s17, s65, 0
    s_mov_b32 s18, 0x200000
    s_mov_b32 s19, 0x20000
    s_sub_u32 s37, s3, 4
    v_and_b32 v1, 63, v0
    v_lshlrev_b32 v5, 4, v1
    s_bfe_u32 s29, s2, 0x10002
    s_lshl_b32 s29, s29, 2
    s_lshr_b32 s39, s2, 6
    s_add_u32 s29, s29, s39
    s_lshl_b32 s29, s29, 18
    s_lshl_b32 s39, s37, 12
    s_add_u32 s29, s29, s39
    s_add_u32 m0, s39, 8192
    s_add_u32 s40, s29, 0
    buffer_load_dwordx4 v5, s[16:19], s40 offen offset:0 sc1 lds
    buffer_load_dwordx4 v5, s[16:19], s40 offen offset:1024 sc1 lds
    buffer_load_dwordx4 v5, s[16:19], s40 offen offset:2048 sc1 lds
    buffer_load_dwordx4 v5, s[16:19], s40 offen offset:3072 sc1 lds
    s_add_u32 m0, s39, 32768
    s_add_u32 s40, s29, 16384
    buffer_load_dwordx4 v5, s[16:19], s40 offen offset:0 sc1 lds
    buffer_load_dwordx4 v5, s[16:19], s40 offen offset:1024 sc1 lds
    buffer_load_dwordx4 v5, s[16:19], s40 offen offset:2048 sc1 lds
    buffer_load_dwordx4 v5, s[16:19], s40 offen offset:3072 sc1 lds
    s_add_u32 m0, s39, 57344
    s_add_u32 s40, s29, 32768
    buffer_load_dwordx4 v5, s[16:19], s40 offen offset:0 sc1 lds
    buffer_load_dwordx4 v5, s[16:19], s40 offen offset:1024 sc1 lds
    buffer_load_dwordx4 v5, s[16:19], s40 offen offset:2048 sc1 lds
    buffer_load_dwordx4 v5, s[16:19], s40 offen offset:3072 sc1 lds
    s_add_u32 m0, s39, 81920
    s_add_u32 s40, s29, 49152
    buffer_load_dwordx4 v5, s[16:19], s40 offen offset:0 sc1 lds
    buffer_load_dwordx4 v5, s[16:19], s40 offen offset:1024 sc1 lds
    buffer_load_dwordx4 v5, s[16:19], s40 offen offset:2048 sc1 lds
    buffer_load_dwordx4 v5, s[16:19], s40 offen offset:3072 sc1 lds
    s_add_u32 m0, s39, 106496
    s_add_u32 s40, s29, 65536
    buffer_load_dwordx4 v5, s[16:19], s40 offen offset:0 sc1 lds
    buffer_load_dwordx4 v5, s[16:19], s40 offen offset:1024 sc1 lds
    buffer_load_dwordx4 v5, s[16:19], s40 offen offset:2048 sc1 lds
    buffer_load_dwordx4 v5, s[16:19], s40 offen offset:3072 sc1 lds
    s_branch p3end_54_nod
p3comp_53:
    v_and_b32 v1, 63, v0
    v_lshlrev_b32 v2, 4, v1
    s_lshr_b32 s37, s3, 1
    s_and_b32 s38, s3, 1
    s_lshl_b32 s39, s37, 13
    v_lshrrev_b32 v3, 4, v1
    v_bfe_u32 v4, v1, 2, 2
    v_lshl_add_u32 v5, v3, 3, v4
    v_lshlrev_b32 v5, 7, v5
    v_and_b32 v6, 3, v1
    v_lshl_add_u32 v5, v6, 3, v5
    v_bfe_u32 v6, v1, 3, 1
    v_bfe_u32 v7, v1, 4, 1
    v_lshl_or_b32 v6, v7, 1, v6
    s_lshl_b32 s40, s38, 1
    v_xor_b32 v7, s40, v6
    v_lshl_add_u32 v8, v7, 5, v5
    v_xor_b32 v7, 1, v7
    v_lshl_add_u32 v9, v7, 5, v5
    s_add_u32 s41, s39, 0
    v_add_u32 v16, s41, v2
    v_add_u32 v20, 16384, v8
    v_add_u32 v24, 16384, v9
    s_add_u32 s41, s39, 32768
    v_add_u32 v17, s41, v2
    v_add_u32 v21, 49152, v8
    v_add_u32 v25, 49152, v9
    s_add_u32 s41, s39, 65536
    v_add_u32 v18, s41, v2
    v_add_u32 v22, 81920, v8
    v_add_u32 v26, 81920, v9
    s_add_u32 s41, s39, 98304
    v_add_u32 v19, s41, v2
    v_add_u32 v23, 114688, v8
    v_add_u32 v27, 114688, v9
    v_lshlrev_b32 v10, 4, v3
    v_and_b32 v11, 15, v1
    v_lshlrev_b32 v11, 2, v11
    v_mov_b32 v92, 0
    v_mov_b32 v93, 0
    v_mov_b32 v94, 0
    v_mov_b32 v95, 0
    v_mov_b32 v96, 0
    v_mov_b32 v97, 0
    v_mov_b32 v98, 0
    v_mov_b32 v99, 0
    v_mov_b32 v100, 0
    v_mov_b32 v101, 0
    v_mov_b32 v102, 0
    v_mov_b32 v103, 0
    v_mov_b32 v104, 0
    v_mov_b32 v105, 0
    v_mov_b32 v106, 0
    v_mov_b32 v107, 0
    v_mov_b32 v108, 0
    v_mov_b32 v109, 0
    v_mov_b32 v110, 0
    v_mov_b32 v111, 0
    v_mov_b32 v112, 0
    v_mov_b32 v113, 0
    v_mov_b32 v114, 0
    v_mov_b32 v115, 0
    v_mov_b32 v116, 0
    v_mov_b32 v117, 0
    v_mov_b32 v118, 0
    v_mov_b32 v119, 0
    v_mov_b32 v120, 0
    v_mov_b32 v121, 0
    v_mov_b32 v122, 0
    v_mov_b32 v123, 0
    v_mov_b32 v124, 0
    v_mov_b32 v125, 0
    v_mov_b32 v126, 0
    v_mov_b32 v127, 0
    v_mov_b32 v128, 0
    v_mov_b32 v129, 0
    v_mov_b32 v130, 0
    v_mov_b32 v131, 0
    v_mov_b32 v132, 0
    v_mov_b32 v133, 0
    v_mov_b32 v134, 0
    v_mov_b32 v135, 0
    v_mov_b32 v136, 0
    v_mov_b32 v137, 0
    v_mov_b32 v138, 0
    v_mov_b32 v139, 0
    v_mov_b32 v140, 0
    v_mov_b32 v141, 0
    v_mov_b32 v142, 0
    v_mov_b32 v143, 0
    v_mov_b32 v144, 0
    v_mov_b32 v145, 0
    v_mov_b32 v146, 0
    v_mov_b32 v147, 0
    v_mov_b32 v148, 0
    v_mov_b32 v149, 0
    v_mov_b32 v150, 0
    v_mov_b32 v151, 0
    v_mov_b32 v152, 0
    v_mov_b32 v153, 0
    v_mov_b32 v154, 0
    v_mov_b32 v155, 0
    v_mov_b32 v156, 0
    v_mov_b32 v157, 0
    v_mov_b32 v158, 0
    v_mov_b32 v159, 0
    v_mov_b32 v160, 0
    v_mov_b32 v161, 0
    v_mov_b32 v162, 0
    v_mov_b32 v163, 0
    v_mov_b32 v164, 0
    v_mov_b32 v165, 0
    v_mov_b32 v166, 0
    v_mov_b32 v167, 0
    v_mov_b32 v168, 0
    v_mov_b32 v169, 0
    v_mov_b32 v170, 0
    v_mov_b32 v171, 0
    v_mov_b32 v172, 0
    v_mov_b32 v173, 0
    v_mov_b32 v174, 0
    v_mov_b32 v175, 0
    v_mov_b32 v176, 0
    v_mov_b32 v177, 0
    v_mov_b32 v178, 0
    v_mov_b32 v179, 0
    v_mov_b32 v180, 0
    v_mov_b32 v181, 0
    v_mov_b32 v182, 0
    v_mov_b32 v183, 0
    v_mov_b32 v184, 0
    v_mov_b32 v185, 0
    v_mov_b32 v186, 0
    v_mov_b32 v187, 0
    s_mov_b32 s44, 0x3fb8aa3b
    s_mov_b32 s45, 0x3fb8aa3b
    s_mov_b32 s46, 0x358637bd
    s_mov_b32 s47, 0x358637bd
    s_lshl_b32 s42, s37, 8
    s_add_u32 s42, s42, 131072
    v_add_u32 v12, s42, v10
    v_add_u32 v13, s42, v11
    s_lshl_b32 s42, s38, 7
    s_add_u32 s42, s42, 132096
    v_add_u32 v14, s42, v10
    v_add_u32 v15, s42, v11
    s_lshl_b32 s42, s38, 1
    s_add_u32 s42, s42, s37
    s_mul_i32 s42, s42, 6144
    s_add_u32 s42, s42, 133120
    v_add_u32 v3, s42, v2
    v_mov_b32 v60, 0
    v_mov_b32 v61, 0
    v_mov_b32 v62, 0
    v_mov_b32 v63, 0
    v_mov_b32 v64, 0
    v_mov_b32 v65, 0
    v_mov_b32 v66, 0
    v_mov_b32 v67, 0
    v_mov_b32 v68, 0
    v_mov_b32 v69, 0
    v_mov_b32 v70, 0
    v_mov_b32 v71, 0
    v_mov_b32 v72, 0
    v_mov_b32 v73, 0
    v_mov_b32 v74, 0
    v_mov_b32 v75, 0
    v_mov_b32 v76, 0
    v_mov_b32 v77, 0
    v_mov_b32 v78, 0
    v_mov_b32 v79, 0
    v_mov_b32 v80, 0
    v_mov_b32 v81, 0
    v_mov_b32 v82, 0
    v_mov_b32 v83, 0
    v_mov_b32 v84, 0
    v_mov_b32 v85, 0
    v_mov_b32 v86, 0
    v_mov_b32 v87, 0
    v_mov_b32 v88, 0
    v_mov_b32 v89, 0
    v_mov_b32 v90, 0
    v_mov_b32 v91, 0
    s_mov_b32 s43, 0
p3loop_59:
    s_barrier
    v_mfma_f32_16x16x32_bf16 v[92:95], v[60:63], v[76:79], v[92:95]
    ds_read_b128 v[28:31], v16 offset:0
    v_mfma_f32_16x16x32_bf16 v[108:111], v[64:67], v[76:79], v[108:111]
    ds_read_b128 v[32:35], v16 offset:2048
    v_mfma_f32_16x16x32_bf16 v[124:127], v[68:71], v[76:79], v[124:127]
    ds_read_b128 v[36:39], v16 offset:4096
    v_mfma_f32_16x16x32_bf16 v[140:143], v[72:75], v[76:79], v[140:143]
    ds_read_b128 v[40:43], v16 offset:6144
    v_mfma_f32_16x16x32_bf16 v[96:99], v[60:63], v[80:83], v[96:99]
    ds_read_b64_tr_b16 v[44:45], v20 offset:0
    v_mfma_f32_16x16x32_bf16 v[112:115], v[64:67], v[80:83], v[112:115]
    ds_read_b64_tr_b16 v[46:47], v20 offset:512
    v_mfma_f32_16x16x32_bf16 v[128:131], v[68:71], v[80:83], v[128:131]
    ds_read_b64_tr_b16 v[48:49], v24 offset:0
    v_mfma_f32_16x16x32_bf16 v[144:147], v[72:75], v[80:83], v[144:147]
    ds_read_b64_tr_b16 v[50:51], v24 offset:512
    v_mfma_f32_16x16x32_bf16 v[100:103], v[60:63], v[84:87], v[100:103]
    ds_read_b64_tr_b16 v[52:53], v20 offset:8192
    v_mfma_f32_16x16x32_bf16 v[116:119], v[64:67], v[84:87], v[116:119]
    ds_read_b64_tr_b16 v[54:55], v20 offset:8704
    v_mfma_f32_16x16x32_bf16 v[132:135], v[68:71], v[84:87], v[132:135]
    ds_read_b64_tr_b16 v[56:57], v24 offset:8192
    v_mfma_f32_16x16x32_bf16 v[148:151], v[72:75], v[84:87], v[148:151]
    ds_read_b64_tr_b16 v[58:59], v24 offset:8704
    v_mfma_f32_16x16x32_bf16 v[104:107], v[60:63], v[88:91], v[104:107]
    v_mfma_f32_16x16x32_bf16 v[120:123], v[64:67], v[88:91], v[120:123]
    v_mfma_f32_16x16x32_bf16 v[136:139], v[68:71], v[88:91], v[136:139]
    v_mfma_f32_16x16x32_bf16 v[152:155], v[72:75], v[88:91], v[152:155]
    s_waitcnt lgkmcnt(0)
    v_mfma_f32_16x16x32_bf16 v[92:95], v[28:31], v[44:47], v[92:95]
    ds_read_b128 v[60:63], v16 offset:1024
    v_mfma_f32_16x16x32_bf16 v[108:111], v[32:35], v[44:47], v[108:111]
    ds_read_b128 v[64:67], v16 offset:3072
    v_mfma_f32_16x16x32_bf16 v[124:127], v[36:39], v[44:47], v[124:127]
    ds_read_b128 v[68:71], v16 offset:5120
    v_mfma_f32_16x16x32_bf16 v[140:143], v[40:43], v[44:47], v[140:143]
    ds_read_b128 v[72:75], v16 offset:7168
    v_mfma_f32_16x16x32_bf16 v[96:99], v[28:31], v[48:51], v[96:99]
    ds_read_b64_tr_b16 v[76:77], v20 offset:4096
    v_mfma_f32_16x16x32_bf16 v[112:115], v[32:35], v[48:51], v[112:115]
    ds_read_b64_tr_b16 v[78:79], v20 offset:4608
    v_mfma_f32_16x16x32_bf16 v[128:131], v[36:39], v[48:51], v[128:131]
    ds_read_b64_tr_b16 v[80:81], v24 offset:4096
    v_mfma_f32_16x16x32_bf16 v[144:147], v[40:43], v[48:51], v[144:147]
    ds_read_b64_tr_b16 v[82:83], v24 offset:4608
    v_mfma_f32_16x16x32_bf16 v[100:103], v[28:31], v[52:55], v[100:103]
    ds_read_b64_tr_b16 v[84:85], v20 offset:12288
    v_mfma_f32_16x16x32_bf16 v[116:119], v[32:35], v[52:55], v[116:119]
    ds_read_b64_tr_b16 v[86:87], v20 offset:12800
    v_mfma_f32_16x16x32_bf16 v[132:135], v[36:39], v[52:55], v[132:135]
    ds_read_b64_tr_b16 v[88:89], v24 offset:12288
    v_mfma_f32_16x16x32_bf16 v[148:151], v[40:43], v[52:55], v[148:151]
    ds_read_b64_tr_b16 v[90:91], v24 offset:12800
    v_mfma_f32_16x16x32_bf16 v[104:107], v[28:31], v[56:59], v[104:107]
    v_mfma_f32_16x16x32_bf16 v[120:123], v[32:35], v[56:59], v[120:123]
    v_mfma_f32_16x16x32_bf16 v[136:139], v[36:39], v[56:59], v[136:139]
    v_mfma_f32_16x16x32_bf16 v[152:155], v[40:43], v[56:59], v[152:155]
    s_waitcnt lgkmcnt(0)
    s_barrier
    v_mfma_f32_16x16x32_bf16 v[92:95], v[60:63], v[76:79], v[92:95]
    ds_read_b128 v[28:31], v17 offset:0
    v_mfma_f32_16x16x32_bf16 v[108:111], v[64:67], v[76:79], v[108:111]
    ds_read_b128 v[32:35], v17 offset:2048
    v_mfma_f32_16x16x32_bf16 v[124:127], v[68:71], v[76:79], v[124:127]
    ds_read_b128 v[36:39], v17 offset:4096
    v_mfma_f32_16x16x32_bf16 v[140:143], v[72:75], v[76:79], v[140:143]
    ds_read_b128 v[40:43], v17 offset:6144
    v_mfma_f32_16x16x32_bf16 v[96:99], v[60:63], v[80:83], v[96:99]
    ds_read_b64_tr_b16 v[44:45], v21 offset:0
    v_mfma_f32_16x16x32_bf16 v[112:115], v[64:67], v[80:83], v[112:115]
    ds_read_b64_tr_b16 v[46:47], v21 offset:512
    v_mfma_f32_16x16x32_bf16 v[128:131], v[68:71], v[80:83], v[128:131]
    ds_read_b64_tr_b16 v[48:49], v25 offset:0
    v_mfma_f32_16x16x32_bf16 v[144:147], v[72:75], v[80:83], v[144:147]
    ds_read_b64_tr_b16 v[50:51], v25 offset:512
    v_mfma_f32_16x16x32_bf16 v[100:103], v[60:63], v[84:87], v[100:103]
    ds_read_b64_tr_b16 v[52:53], v21 offset:8192
    v_mfma_f32_16x16x32_bf16 v[116:119], v[64:67], v[84:87], v[116:119]
    ds_read_b64_tr_b16 v[54:55], v21 offset:8704
    v_mfma_f32_16x16x32_bf16 v[132:135], v[68:71], v[84:87], v[132:135]
    ds_read_b64_tr_b16 v[56:57], v25 offset:8192
    v_mfma_f32_16x16x32_bf16 v[148:151], v[72:75], v[84:87], v[148:151]
    ds_read_b64_tr_b16 v[58:59], v25 offset:8704
    v_mfma_f32_16x16x32_bf16 v[104:107], v[60:63], v[88:91], v[104:107]
    v_mfma_f32_16x16x32_bf16 v[120:123], v[64:67], v[88:91], v[120:123]
    v_mfma_f32_16x16x32_bf16 v[136:139], v[68:71], v[88:91], v[136:139]
    v_mfma_f32_16x16x32_bf16 v[152:155], v[72:75], v[88:91], v[152:155]
    s_waitcnt lgkmcnt(0)
    v_mfma_f32_16x16x32_bf16 v[92:95], v[28:31], v[44:47], v[92:95]
    ds_read_b128 v[60:63], v17 offset:1024
    v_mfma_f32_16x16x32_bf16 v[108:111], v[32:35], v[44:47], v[108:111]
    ds_read_b128 v[64:67], v17 offset:3072
    v_mfma_f32_16x16x32_bf16 v[124:127], v[36:39], v[44:47], v[124:127]
    ds_read_b128 v[68:71], v17 offset:5120
    v_mfma_f32_16x16x32_bf16 v[140:143], v[40:43], v[44:47], v[140:143]
    ds_read_b128 v[72:75], v17 offset:7168
    v_mfma_f32_16x16x32_bf16 v[96:99], v[28:31], v[48:51], v[96:99]
    ds_read_b64_tr_b16 v[76:77], v21 offset:4096
    v_mfma_f32_16x16x32_bf16 v[112:115], v[32:35], v[48:51], v[112:115]
    ds_read_b64_tr_b16 v[78:79], v21 offset:4608
    v_mfma_f32_16x16x32_bf16 v[128:131], v[36:39], v[48:51], v[128:131]
    ds_read_b64_tr_b16 v[80:81], v25 offset:4096
    v_mfma_f32_16x16x32_bf16 v[144:147], v[40:43], v[48:51], v[144:147]
    ds_read_b64_tr_b16 v[82:83], v25 offset:4608
    v_mfma_f32_16x16x32_bf16 v[100:103], v[28:31], v[52:55], v[100:103]
    ds_read_b64_tr_b16 v[84:85], v21 offset:12288
    v_mfma_f32_16x16x32_bf16 v[116:119], v[32:35], v[52:55], v[116:119]
    ds_read_b64_tr_b16 v[86:87], v21 offset:12800
    v_mfma_f32_16x16x32_bf16 v[132:135], v[36:39], v[52:55], v[132:135]
    ds_read_b64_tr_b16 v[88:89], v25 offset:12288
    v_mfma_f32_16x16x32_bf16 v[148:151], v[40:43], v[52:55], v[148:151]
    ds_read_b64_tr_b16 v[90:91], v25 offset:12800
    v_mfma_f32_16x16x32_bf16 v[104:107], v[28:31], v[56:59], v[104:107]
    v_mfma_f32_16x16x32_bf16 v[120:123], v[32:35], v[56:59], v[120:123]
    v_mfma_f32_16x16x32_bf16 v[136:139], v[36:39], v[56:59], v[136:139]
    v_mfma_f32_16x16x32_bf16 v[152:155], v[40:43], v[56:59], v[152:155]
    s_waitcnt lgkmcnt(0)
    s_barrier
    v_mfma_f32_16x16x32_bf16 v[92:95], v[60:63], v[76:79], v[92:95]
    ds_read_b128 v[28:31], v18 offset:0
    v_mfma_f32_16x16x32_bf16 v[108:111], v[64:67], v[76:79], v[108:111]
    ds_read_b128 v[32:35], v18 offset:2048
    v_mfma_f32_16x16x32_bf16 v[124:127], v[68:71], v[76:79], v[124:127]
    ds_read_b128 v[36:39], v18 offset:4096
    v_mfma_f32_16x16x32_bf16 v[140:143], v[72:75], v[76:79], v[140:143]
    ds_read_b128 v[40:43], v18 offset:6144
    v_mfma_f32_16x16x32_bf16 v[96:99], v[60:63], v[80:83], v[96:99]
    ds_read_b64_tr_b16 v[44:45], v22 offset:0
    v_mfma_f32_16x16x32_bf16 v[112:115], v[64:67], v[80:83], v[112:115]
    ds_read_b64_tr_b16 v[46:47], v22 offset:512
    v_mfma_f32_16x16x32_bf16 v[128:131], v[68:71], v[80:83], v[128:131]
    ds_read_b64_tr_b16 v[48:49], v26 offset:0
    v_mfma_f32_16x16x32_bf16 v[144:147], v[72:75], v[80:83], v[144:147]
    ds_read_b64_tr_b16 v[50:51], v26 offset:512
    v_mfma_f32_16x16x32_bf16 v[100:103], v[60:63], v[84:87], v[100:103]
    ds_read_b64_tr_b16 v[52:53], v22 offset:8192
    v_mfma_f32_16x16x32_bf16 v[116:119], v[64:67], v[84:87], v[116:119]
    ds_read_b64_tr_b16 v[54:55], v22 offset:8704
    v_mfma_f32_16x16x32_bf16 v[132:135], v[68:71], v[84:87], v[132:135]
    ds_read_b64_tr_b16 v[56:57], v26 offset:8192
    v_mfma_f32_16x16x32_bf16 v[148:151], v[72:75], v[84:87], v[148:151]
    ds_read_b64_tr_b16 v[58:59], v26 offset:8704
    v_mfma_f32_16x16x32_bf16 v[104:107], v[60:63], v[88:91], v[104:107]
    v_mfma_f32_16x16x32_bf16 v[120:123], v[64:67], v[88:91], v[120:123]
    v_mfma_f32_16x16x32_bf16 v[136:139], v[68:71], v[88:91], v[136:139]
    v_mfma_f32_16x16x32_bf16 v[152:155], v[72:75], v[88:91], v[152:155]
    s_waitcnt lgkmcnt(0)
    v_mfma_f32_16x16x32_bf16 v[92:95], v[28:31], v[44:47], v[92:95]
    ds_read_b128 v[60:63], v18 offset:1024
    v_mfma_f32_16x16x32_bf16 v[108:111], v[32:35], v[44:47], v[108:111]
    ds_read_b128 v[64:67], v18 offset:3072
    v_mfma_f32_16x16x32_bf16 v[124:127], v[36:39], v[44:47], v[124:127]
    ds_read_b128 v[68:71], v18 offset:5120
    v_mfma_f32_16x16x32_bf16 v[140:143], v[40:43], v[44:47], v[140:143]
    ds_read_b128 v[72:75], v18 offset:7168
    v_mfma_f32_16x16x32_bf16 v[96:99], v[28:31], v[48:51], v[96:99]
    ds_read_b64_tr_b16 v[76:77], v22 offset:4096
    v_mfma_f32_16x16x32_bf16 v[112:115], v[32:35], v[48:51], v[112:115]
    ds_read_b64_tr_b16 v[78:79], v22 offset:4608
    v_mfma_f32_16x16x32_bf16 v[128:131], v[36:39], v[48:51], v[128:131]
    ds_read_b64_tr_b16 v[80:81], v26 offset:4096
    v_mfma_f32_16x16x32_bf16 v[144:147], v[40:43], v[48:51], v[144:147]
    ds_read_b64_tr_b16 v[82:83], v26 offset:4608
    v_mfma_f32_16x16x32_bf16 v[100:103], v[28:31], v[52:55], v[100:103]
    ds_read_b64_tr_b16 v[84:85], v22 offset:12288
    v_mfma_f32_16x16x32_bf16 v[116:119], v[32:35], v[52:55], v[116:119]
    ds_read_b64_tr_b16 v[86:87], v22 offset:12800
    v_mfma_f32_16x16x32_bf16 v[132:135], v[36:39], v[52:55], v[132:135]
    ds_read_b64_tr_b16 v[88:89], v26 offset:12288
    v_mfma_f32_16x16x32_bf16 v[148:151], v[40:43], v[52:55], v[148:151]
    ds_read_b64_tr_b16 v[90:91], v26 offset:12800
    v_mfma_f32_16x16x32_bf16 v[104:107], v[28:31], v[56:59], v[104:107]
    v_mfma_f32_16x16x32_bf16 v[120:123], v[32:35], v[56:59], v[120:123]
    v_mfma_f32_16x16x32_bf16 v[136:139], v[36:39], v[56:59], v[136:139]
    v_mfma_f32_16x16x32_bf16 v[152:155], v[40:43], v[56:59], v[152:155]
    s_waitcnt lgkmcnt(0)
    s_barrier
    v_mfma_f32_16x16x32_bf16 v[92:95], v[60:63], v[76:79], v[92:95]
    ds_read_b128 v[28:31], v19 offset:0
    v_mfma_f32_16x16x32_bf16 v[108:111], v[64:67], v[76:79], v[108:111]
    ds_read_b128 v[32:35], v19 offset:2048
    v_mfma_f32_16x16x32_bf16 v[124:127], v[68:71], v[76:79], v[124:127]
    ds_read_b128 v[36:39], v19 offset:4096
    v_mfma_f32_16x16x32_bf16 v[140:143], v[72:75], v[76:79], v[140:143]
    ds_read_b128 v[40:43], v19 offset:6144
    v_mfma_f32_16x16x32_bf16 v[96:99], v[60:63], v[80:83], v[96:99]
    ds_read_b64_tr_b16 v[44:45], v23 offset:0
    v_mfma_f32_16x16x32_bf16 v[112:115], v[64:67], v[80:83], v[112:115]
    ds_read_b64_tr_b16 v[46:47], v23 offset:512
    v_mfma_f32_16x16x32_bf16 v[128:131], v[68:71], v[80:83], v[128:131]
    ds_read_b64_tr_b16 v[48:49], v27 offset:0
    v_mfma_f32_16x16x32_bf16 v[144:147], v[72:75], v[80:83], v[144:147]
    ds_read_b64_tr_b16 v[50:51], v27 offset:512
    v_mfma_f32_16x16x32_bf16 v[100:103], v[60:63], v[84:87], v[100:103]
    ds_read_b64_tr_b16 v[52:53], v23 offset:8192
    v_mfma_f32_16x16x32_bf16 v[116:119], v[64:67], v[84:87], v[116:119]
    ds_read_b64_tr_b16 v[54:55], v23 offset:8704
    v_mfma_f32_16x16x32_bf16 v[132:135], v[68:71], v[84:87], v[132:135]
    ds_read_b64_tr_b16 v[56:57], v27 offset:8192
    v_mfma_f32_16x16x32_bf16 v[148:151], v[72:75], v[84:87], v[148:151]
    ds_read_b64_tr_b16 v[58:59], v27 offset:8704
    v_mfma_f32_16x16x32_bf16 v[104:107], v[60:63], v[88:91], v[104:107]
    v_mfma_f32_16x16x32_bf16 v[120:123], v[64:67], v[88:91], v[120:123]
    v_mfma_f32_16x16x32_bf16 v[136:139], v[68:71], v[88:91], v[136:139]
    v_mfma_f32_16x16x32_bf16 v[152:155], v[72:75], v[88:91], v[152:155]
    s_waitcnt lgkmcnt(0)
    v_mfma_f32_16x16x32_bf16 v[92:95], v[28:31], v[44:47], v[92:95]
    ds_read_b128 v[60:63], v19 offset:1024
    v_mfma_f32_16x16x32_bf16 v[108:111], v[32:35], v[44:47], v[108:111]
    ds_read_b128 v[64:67], v19 offset:3072
    v_mfma_f32_16x16x32_bf16 v[124:127], v[36:39], v[44:47], v[124:127]
    ds_read_b128 v[68:71], v19 offset:5120
    v_mfma_f32_16x16x32_bf16 v[140:143], v[40:43], v[44:47], v[140:143]
    ds_read_b128 v[72:75], v19 offset:7168
    v_mfma_f32_16x16x32_bf16 v[96:99], v[28:31], v[48:51], v[96:99]
    ds_read_b64_tr_b16 v[76:77], v23 offset:4096
    v_mfma_f32_16x16x32_bf16 v[112:115], v[32:35], v[48:51], v[112:115]
    ds_read_b64_tr_b16 v[78:79], v23 offset:4608
    v_mfma_f32_16x16x32_bf16 v[128:131], v[36:39], v[48:51], v[128:131]
    ds_read_b64_tr_b16 v[80:81], v27 offset:4096
    v_mfma_f32_16x16x32_bf16 v[144:147], v[40:43], v[48:51], v[144:147]
    ds_read_b64_tr_b16 v[82:83], v27 offset:4608
    v_mfma_f32_16x16x32_bf16 v[100:103], v[28:31], v[52:55], v[100:103]
    ds_read_b64_tr_b16 v[84:85], v23 offset:12288
    v_mfma_f32_16x16x32_bf16 v[116:119], v[32:35], v[52:55], v[116:119]
    ds_read_b64_tr_b16 v[86:87], v23 offset:12800
    v_mfma_f32_16x16x32_bf16 v[132:135], v[36:39], v[52:55], v[132:135]
    ds_read_b64_tr_b16 v[88:89], v27 offset:12288
    v_mfma_f32_16x16x32_bf16 v[148:151], v[40:43], v[52:55], v[148:151]
    ds_read_b64_tr_b16 v[90:91], v27 offset:12800
    v_mfma_f32_16x16x32_bf16 v[104:107], v[28:31], v[56:59], v[104:107]
    v_mfma_f32_16x16x32_bf16 v[120:123], v[32:35], v[56:59], v[120:123]
    v_mfma_f32_16x16x32_bf16 v[136:139], v[36:39], v[56:59], v[136:139]
    v_mfma_f32_16x16x32_bf16 v[152:155], v[40:43], v[56:59], v[152:155]
    s_add_u32 s43, s43, 1
    s_waitcnt lgkmcnt(0)
    s_cmp_lt_u32 s43, 4
    s_cbranch_scc1 p3loop_59
    v_mfma_f32_16x16x32_bf16 v[92:95], v[60:63], v[76:79], v[92:95]
    v_mfma_f32_16x16x32_bf16 v[108:111], v[64:67], v[76:79], v[108:111]
    v_mfma_f32_16x16x32_bf16 v[124:127], v[68:71], v[76:79], v[124:127]
    v_mfma_f32_16x16x32_bf16 v[140:143], v[72:75], v[76:79], v[140:143]
    v_mfma_f32_16x16x32_bf16 v[96:99], v[60:63], v[80:83], v[96:99]
    v_mfma_f32_16x16x32_bf16 v[112:115], v[64:67], v[80:83], v[112:115]
    v_mfma_f32_16x16x32_bf16 v[128:131], v[68:71], v[80:83], v[128:131]
    v_mfma_f32_16x16x32_bf16 v[144:147], v[72:75], v[80:83], v[144:147]
    v_mfma_f32_16x16x32_bf16 v[100:103], v[60:63], v[84:87], v[100:103]
    v_mfma_f32_16x16x32_bf16 v[116:119], v[64:67], v[84:87], v[116:119]
    v_mfma_f32_16x16x32_bf16 v[132:135], v[68:71], v[84:87], v[132:135]
    v_mfma_f32_16x16x32_bf16 v[148:151], v[72:75], v[84:87], v[148:151]
    v_mfma_f32_16x16x32_bf16 v[104:107], v[60:63], v[88:91], v[104:107]
    v_mfma_f32_16x16x32_bf16 v[120:123], v[64:67], v[88:91], v[120:123]
    v_mfma_f32_16x16x32_bf16 v[136:139], v[68:71], v[88:91], v[136:139]
    v_mfma_f32_16x16x32_bf16 v[152:155], v[72:75], v[88:91], v[152:155]
    s_barrier
    ds_read_b128 v[208:211], v12 offset:0
    ds_read_b128 v[224:227], v12 offset:512
    ds_read_b32 v188, v13 offset:0
    ds_read_b32 v192, v13 offset:512
    ds_read_b128 v[212:215], v12 offset:64
    ds_read_b128 v[228:231], v12 offset:576
    ds_read_b32 v189, v13 offset:64
    ds_read_b32 v193, v13 offset:576
    ds_read_b128 v[216:219], v12 offset:128
    ds_read_b128 v[232:235], v12 offset:640
    ds_read_b32 v190, v13 offset:128
    ds_read_b32 v194, v13 offset:640
    ds_read_b128 v[220:223], v12 offset:192
    ds_read_b128 v[236:239], v12 offset:704
    ds_read_b32 v191, v13 offset:192
    ds_read_b32 v195, v13 offset:704
    ds_read_b128 v[196:199], v14 offset:0
    ds_read_b128 v[200:203], v14 offset:64
    ds_read_b32 v204, v15 offset:256
    ds_read_b32 v205, v15 offset:320
    ds_read_b32 v206, v15 offset:512
    ds_read_b32 v207, v15 offset:576
    s_waitcnt lgkmcnt(0)
    v_pk_mul_f32 v[52:53], v[224:225], v[204:205] op_sel:[0,0] op_sel_hi:[1,0]
    v_pk_fma_f32 v[92:93], v[92:93], v[208:209], v[52:53]
    v_pk_mul_f32 v[54:55], v[226:227], v[204:205] op_sel:[0,0] op_sel_hi:[1,0]
    v_pk_fma_f32 v[94:95], v[94:95], v[210:211], v[54:55]
    v_pk_mul_f32 v[56:57], v[224:225], v[204:205] op_sel:[0,1] op_sel_hi:[1,1]
    v_pk_fma_f32 v[96:97], v[96:97], v[208:209], v[56:57]
    v_pk_mul_f32 v[58:59], v[226:227], v[204:205] op_sel:[0,1] op_sel_hi:[1,1]
    v_pk_fma_f32 v[98:99], v[98:99], v[210:211], v[58:59]
    v_pk_mul_f32 v[52:53], v[224:225], v[206:207] op_sel:[0,0] op_sel_hi:[1,0]
    v_pk_fma_f32 v[100:101], v[100:101], v[208:209], v[52:53]
    v_pk_mul_f32 v[54:55], v[226:227], v[206:207] op_sel:[0,0] op_sel_hi:[1,0]
    v_pk_fma_f32 v[102:103], v[102:103], v[210:211], v[54:55]
    v_pk_mul_f32 v[56:57], v[224:225], v[206:207] op_sel:[0,1] op_sel_hi:[1,1]
    v_pk_fma_f32 v[104:105], v[104:105], v[208:209], v[56:57]
    v_pk_mul_f32 v[58:59], v[226:227], v[206:207] op_sel:[0,1] op_sel_hi:[1,1]
    v_pk_fma_f32 v[106:107], v[106:107], v[210:211], v[58:59]
    v_pk_mul_f32 v[52:53], v[228:229], v[204:205] op_sel:[0,0] op_sel_hi:[1,0]
    v_pk_fma_f32 v[108:109], v[108:109], v[212:213], v[52:53]
    v_pk_mul_f32 v[54:55], v[230:231], v[204:205] op_sel:[0,0] op_sel_hi:[1,0]
    v_pk_fma_f32 v[110:111], v[110:111], v[214:215], v[54:55]
    v_pk_mul_f32 v[56:57], v[228:229], v[204:205] op_sel:[0,1] op_sel_hi:[1,1]
    v_pk_fma_f32 v[112:113], v[112:113], v[212:213], v[56:57]
    v_pk_mul_f32 v[58:59], v[230:231], v[204:205] op_sel:[0,1] op_sel_hi:[1,1]
    v_pk_fma_f32 v[114:115], v[114:115], v[214:215], v[58:59]
    v_pk_mul_f32 v[52:53], v[228:229], v[206:207] op_sel:[0,0] op_sel_hi:[1,0]
    v_pk_fma_f32 v[116:117], v[116:117], v[212:213], v[52:53]
    v_pk_mul_f32 v[54:55], v[230:231], v[206:207] op_sel:[0,0] op_sel_hi:[1,0]
    v_pk_fma_f32 v[118:119], v[118:119], v[214:215], v[54:55]
    v_pk_mul_f32 v[56:57], v[228:229], v[206:207] op_sel:[0,1] op_sel_hi:[1,1]
    v_pk_fma_f32 v[120:121], v[120:121], v[212:213], v[56:57]
    v_pk_mul_f32 v[58:59], v[230:231], v[206:207] op_sel:[0,1] op_sel_hi:[1,1]
    v_pk_fma_f32 v[122:123], v[122:123], v[214:215], v[58:59]
    v_pk_mul_f32 v[52:53], v[232:233], v[204:205] op_sel:[0,0] op_sel_hi:[1,0]
    v_pk_fma_f32 v[124:125], v[124:125], v[216:217], v[52:53]
    v_pk_mul_f32 v[54:55], v[234:235], v[204:205] op_sel:[0,0] op_sel_hi:[1,0]
    v_pk_fma_f32 v[126:127], v[126:127], v[218:219], v[54:55]
    v_pk_mul_f32 v[56:57], v[232:233], v[204:205] op_sel:[0,1] op_sel_hi:[1,1]
    v_pk_fma_f32 v[128:129], v[128:129], v[216:217], v[56:57]
    v_pk_mul_f32 v[58:59], v[234:235], v[204:205] op_sel:[0,1] op_sel_hi:[1,1]
    v_pk_fma_f32 v[130:131], v[130:131], v[218:219], v[58:59]
    v_pk_mul_f32 v[52:53], v[232:233], v[206:207] op_sel:[0,0] op_sel_hi:[1,0]
    v_pk_fma_f32 v[132:133], v[132:133], v[216:217], v[52:53]
    v_pk_mul_f32 v[54:55], v[234:235], v[206:207] op_sel:[0,0] op_sel_hi:[1,0]
    v_pk_fma_f32 v[134:135], v[134:135], v[218:219], v[54:55]
    v_pk_mul_f32 v[56:57], v[232:233], v[206:207] op_sel:[0,1] op_sel_hi:[1,1]
    v_pk_fma_f32 v[136:137], v[136:137], v[216:217], v[56:57]
    v_pk_mul_f32 v[58:59], v[234:235], v[206:207] op_sel:[0,1] op_sel_hi:[1,1]
    v_pk_fma_f32 v[138:139], v[138:139], v[218:219], v[58:59]
    v_pk_mul_f32 v[52:53], v[236:237], v[204:205] op_sel:[0,0] op_sel_hi:[1,0]
    v_pk_fma_f32 v[140:141], v[140:141], v[220:221], v[52:53]
    v_pk_mul_f32 v[54:55], v[238:239], v[204:205] op_sel:[0,0] op_sel_hi:[1,0]
    v_pk_fma_f32 v[142:143], v[142:143], v[222:223], v[54:55]
    v_pk_mul_f32 v[56:57], v[236:237], v[204:205] op_sel:[0,1] op_sel_hi:[1,1]
    v_pk_fma_f32 v[144:145], v[144:145], v[220:221], v[56:57]
    v_pk_mul_f32 v[58:59], v[238:239], v[204:205] op_sel:[0,1] op_sel_hi:[1,1]
    v_pk_fma_f32 v[146:147], v[146:147], v[222:223], v[58:59]
    v_pk_mul_f32 v[52:53], v[236:237], v[206:207] op_sel:[0,0] op_sel_hi:[1,0]
    v_pk_fma_f32 v[148:149], v[148:149], v[220:221], v[52:53]
    v_pk_mul_f32 v[54:55], v[238:239], v[206:207] op_sel:[0,0] op_sel_hi:[1,0]
    v_pk_fma_f32 v[150:151], v[150:151], v[222:223], v[54:55]
    v_pk_mul_f32 v[56:57], v[236:237], v[206:207] op_sel:[0,1] op_sel_hi:[1,1]
    v_pk_fma_f32 v[152:153], v[152:153], v[220:221], v[56:57]
    v_pk_mul_f32 v[58:59], v[238:239], v[206:207] op_sel:[0,1] op_sel_hi:[1,1]
    v_pk_fma_f32 v[154:155], v[154:155], v[222:223], v[58:59]
    v_pk_mul_f32 v[52:53], v[92:93], s[44:45]
    v_min_f32 v52, 0, v52
    v_min_f32 v53, 0, v53
    v_exp_f32 v52, v52
    v_exp_f32 v53, v53
    v_max_f32 v92, 0, v92
    v_max_f32 v93, 0, v93
    v_pk_add_f32 v[92:93], v[92:93], s[46:47]
    v_pk_add_f32 v[92:93], v[92:93], v[52:53]
    v_pk_mul_f32 v[56:57], v[94:95], s[44:45]
    v_min_f32 v56, 0, v56
    v_min_f32 v57, 0, v57
    v_exp_f32 v56, v56
    v_exp_f32 v57, v57
    v_max_f32 v94, 0, v94
    v_max_f32 v95, 0, v95
    v_pk_add_f32 v[94:95], v[94:95], s[46:47]
    v_pk_add_f32 v[94:95], v[94:95], v[56:57]
    v_pk_mul_f32 v[52:53], v[96:97], s[44:45]
    v_min_f32 v52, 0, v52
    v_min_f32 v53, 0, v53
    v_exp_f32 v52, v52
    v_exp_f32 v53, v53
    v_max_f32 v96, 0, v96
    v_max_f32 v97, 0, v97
    v_pk_add_f32 v[96:97], v[96:97], s[46:47]
    v_pk_add_f32 v[96:97], v[96:97], v[52:53]
    v_pk_mul_f32 v[56:57], v[98:99], s[44:45]
    v_min_f32 v56, 0, v56
    v_min_f32 v57, 0, v57
    v_exp_f32 v56, v56
    v_exp_f32 v57, v57
    v_max_f32 v98, 0, v98
    v_max_f32 v99, 0, v99
    v_pk_add_f32 v[98:99], v[98:99], s[46:47]
    v_pk_add_f32 v[98:99], v[98:99], v[56:57]
    v_pk_mul_f32 v[52:53], v[108:109], s[44:45]
    v_min_f32 v52, 0, v52
    v_min_f32 v53, 0, v53
    v_exp_f32 v52, v52
    v_exp_f32 v53, v53
    v_max_f32 v108, 0, v108
    v_max_f32 v109, 0, v109
    v_pk_add_f32 v[108:109], v[108:109], s[46:47]
    v_pk_add_f32 v[108:109], v[108:109], v[52:53]
    v_pk_mul_f32 v[56:57], v[110:111], s[44:45]
    v_min_f32 v56, 0, v56
    v_min_f32 v57, 0, v57
    v_exp_f32 v56, v56
    v_exp_f32 v57, v57
    v_max_f32 v110, 0, v110
    v_max_f32 v111, 0, v111
    v_pk_add_f32 v[110:111], v[110:111], s[46:47]
    v_pk_add_f32 v[110:111], v[110:111], v[56:57]
    v_pk_mul_f32 v[52:53], v[112:113], s[44:45]
    v_min_f32 v52, 0, v52
    v_min_f32 v53, 0, v53
    v_exp_f32 v52, v52
    v_exp_f32 v53, v53
    v_max_f32 v112, 0, v112
    v_max_f32 v113, 0, v113
    v_pk_add_f32 v[112:113], v[112:113], s[46:47]
    v_pk_add_f32 v[112:113], v[112:113], v[52:53]
    v_pk_mul_f32 v[56:57], v[114:115], s[44:45]
    v_min_f32 v56, 0, v56
    v_min_f32 v57, 0, v57
    v_exp_f32 v56, v56
    v_exp_f32 v57, v57
    v_max_f32 v114, 0, v114
    v_max_f32 v115, 0, v115
    v_pk_add_f32 v[114:115], v[114:115], s[46:47]
    v_pk_add_f32 v[114:115], v[114:115], v[56:57]
    v_pk_mul_f32 v[52:53], v[124:125], s[44:45]
    v_min_f32 v52, 0, v52
    v_min_f32 v53, 0, v53
    v_exp_f32 v52, v52
    v_exp_f32 v53, v53
    v_max_f32 v124, 0, v124
    v_max_f32 v125, 0, v125
    v_pk_add_f32 v[124:125], v[124:125], s[46:47]
    v_pk_add_f32 v[124:125], v[124:125], v[52:53]
    v_pk_mul_f32 v[56:57], v[126:127], s[44:45]
    v_min_f32 v56, 0, v56
    v_min_f32 v57, 0, v57
    v_exp_f32 v56, v56
    v_exp_f32 v57, v57
    v_max_f32 v126, 0, v126
    v_max_f32 v127, 0, v127
    v_pk_add_f32 v[126:127], v[126:127], s[46:47]
    v_pk_add_f32 v[126:127], v[126:127], v[56:57]
    v_pk_mul_f32 v[52:53], v[128:129], s[44:45]
    v_min_f32 v52, 0, v52
    v_min_f32 v53, 0, v53
    v_exp_f32 v52, v52
    v_exp_f32 v53, v53
    v_max_f32 v128, 0, v128
    v_max_f32 v129, 0, v129
    v_pk_add_f32 v[128:129], v[128:129], s[46:47]
    v_pk_add_f32 v[128:129], v[128:129], v[52:53]
    v_pk_mul_f32 v[56:57], v[130:131], s[44:45]
    v_min_f32 v56, 0, v56
    v_min_f32 v57, 0, v57
    v_exp_f32 v56, v56
    v_exp_f32 v57, v57
    v_max_f32 v130, 0, v130
    v_max_f32 v131, 0, v131
    v_pk_add_f32 v[130:131], v[130:131], s[46:47]
    v_pk_add_f32 v[130:131], v[130:131], v[56:57]
    v_pk_mul_f32 v[52:53], v[140:141], s[44:45]
    v_min_f32 v52, 0, v52
    v_min_f32 v53, 0, v53
    v_exp_f32 v52, v52
    v_exp_f32 v53, v53
    v_max_f32 v140, 0, v140
    v_max_f32 v141, 0, v141
    v_pk_add_f32 v[140:141], v[140:141], s[46:47]
    v_pk_add_f32 v[140:141], v[140:141], v[52:53]
    v_pk_mul_f32 v[56:57], v[142:143], s[44:45]
    v_min_f32 v56, 0, v56
    v_min_f32 v57, 0, v57
    v_exp_f32 v56, v56
    v_exp_f32 v57, v57
    v_max_f32 v142, 0, v142
    v_max_f32 v143, 0, v143
    v_pk_add_f32 v[142:143], v[142:143], s[46:47]
    v_pk_add_f32 v[142:143], v[142:143], v[56:57]
    v_pk_mul_f32 v[52:53], v[144:145], s[44:45]
    v_min_f32 v52, 0, v52
    v_min_f32 v53, 0, v53
    v_exp_f32 v52, v52
    v_exp_f32 v53, v53
    v_max_f32 v144, 0, v144
    v_max_f32 v145, 0, v145
    v_pk_add_f32 v[144:145], v[144:145], s[46:47]
    v_pk_add_f32 v[144:145], v[144:145], v[52:53]
    v_pk_mul_f32 v[56:57], v[146:147], s[44:45]
    v_min_f32 v56, 0, v56
    v_min_f32 v57, 0, v57
    v_exp_f32 v56, v56
    v_exp_f32 v57, v57
    v_max_f32 v146, 0, v146
    v_max_f32 v147, 0, v147
    v_pk_add_f32 v[146:147], v[146:147], s[46:47]
    v_pk_add_f32 v[146:147], v[146:147], v[56:57]
    v_cvt_pk_bf16_f32 v208, v92, v93
    v_cvt_pk_bf16_f32 v209, v94, v95
    v_cvt_pk_bf16_f32 v224, v100, v101
    v_cvt_pk_bf16_f32 v225, v102, v103
    v_cvt_pk_bf16_f32 v210, v108, v109
    v_cvt_pk_bf16_f32 v211, v110, v111
    v_cvt_pk_bf16_f32 v226, v116, v117
    v_cvt_pk_bf16_f32 v227, v118, v119
    v_cvt_pk_bf16_f32 v212, v96, v97
    v_cvt_pk_bf16_f32 v213, v98, v99
    v_cvt_pk_bf16_f32 v228, v104, v105
    v_cvt_pk_bf16_f32 v229, v106, v107
    v_cvt_pk_bf16_f32 v214, v112, v113
    v_cvt_pk_bf16_f32 v215, v114, v115
    v_cvt_pk_bf16_f32 v230, v120, v121
    v_cvt_pk_bf16_f32 v231, v122, v123
    v_cvt_pk_bf16_f32 v216, v124, v125
    v_cvt_pk_bf16_f32 v217, v126, v127
    v_cvt_pk_bf16_f32 v232, v132, v133
    v_cvt_pk_bf16_f32 v233, v134, v135
    v_cvt_pk_bf16_f32 v218, v140, v141
    v_cvt_pk_bf16_f32 v219, v142, v143
    v_cvt_pk_bf16_f32 v234, v148, v149
    v_cvt_pk_bf16_f32 v235, v150, v151
    v_cvt_pk_bf16_f32 v220, v128, v129
    v_cvt_pk_bf16_f32 v221, v130, v131
    v_cvt_pk_bf16_f32 v236, v136, v137
    v_cvt_pk_bf16_f32 v237, v138, v139
    v_cvt_pk_bf16_f32 v222, v144, v145
    v_cvt_pk_bf16_f32 v223, v146, v147
    v_cvt_pk_bf16_f32 v238, v152, v153
    v_cvt_pk_bf16_f32 v239, v154, v155
    v_mov_b32 v84, 0x3f803f80
    v_mov_b32 v85, 0x3f803f80
    v_mov_b32 v86, 0x3f803f80
    v_mov_b32 v87, 0x3f803f80
    s_nop 1
    v_mfma_f32_16x16x32_bf16 v[92:95], v[208:211], v[224:227], 0
    v_mfma_f32_16x16x32_bf16 v[100:103], v[208:211], v[228:231], 0
    v_mfma_f32_16x16x32_bf16 v[108:111], v[208:211], v[84:87], 0
    v_mfma_f32_16x16x32_bf16 v[96:99], v[212:215], v[224:227], 0
    v_mfma_f32_16x16x32_bf16 v[104:107], v[212:215], v[228:231], 0
    v_mfma_f32_16x16x32_bf16 v[112:115], v[212:215], v[84:87], 0
    v_mfma_f32_16x16x32_bf16 v[92:95], v[216:219], v[232:235], v[92:95]
    v_mfma_f32_16x16x32_bf16 v[100:103], v[216:219], v[236:239], v[100:103]
    v_mfma_f32_16x16x32_bf16 v[108:111], v[216:219], v[84:87], v[108:111]
    v_mfma_f32_16x16x32_bf16 v[96:99], v[220:223], v[232:235], v[96:99]
    v_mfma_f32_16x16x32_bf16 v[104:107], v[220:223], v[236:239], v[104:107]
    v_mfma_f32_16x16x32_bf16 v[112:115], v[220:223], v[84:87], v[112:115]
    s_nop 3
    s_nop 3
    s_nop 3
    ds_write_b128 v3, v[92:95] offset:0
    ds_write_b128 v3, v[96:99] offset:1024
    ds_write_b128 v3, v[100:103] offset:2048
    ds_write_b128 v3, v[104:107] offset:3072
    ds_write_b128 v3, v[108:111] offset:4096
    ds_write_b128 v3, v[112:115] offset:5120
    s_waitcnt lgkmcnt(0)
    v_mov_b32 v60, 0
    v_mov_b32 v61, 0
    v_mov_b32 v62, 0
    v_mov_b32 v63, 0
    v_mov_b32 v64, 0
    v_mov_b32 v65, 0
    v_mov_b32 v66, 0
    v_mov_b32 v67, 0
    v_mov_b32 v68, 0
    v_mov_b32 v69, 0
    v_mov_b32 v70, 0
    v_mov_b32 v71, 0
    v_mov_b32 v72, 0
    v_mov_b32 v73, 0
    v_mov_b32 v74, 0
    v_mov_b32 v75, 0
    v_mov_b32 v76, 0
    v_mov_b32 v77, 0
    v_mov_b32 v78, 0
    v_mov_b32 v79, 0
    v_mov_b32 v80, 0
    v_mov_b32 v81, 0
    v_mov_b32 v82, 0
    v_mov_b32 v83, 0
    s_mov_b32 s43, 0
p3loop_60:
    s_barrier
    v_mfma_f32_16x16x32_bf16 v[156:159], v[76:79], v[60:63], v[156:159]
    ds_read_b128 v[28:31], v16 offset:0
    v_mfma_f32_16x16x32_bf16 v[164:167], v[76:79], v[64:67], v[164:167]
    ds_read_b128 v[32:35], v16 offset:2048
    v_mfma_f32_16x16x32_bf16 v[172:175], v[76:79], v[68:71], v[172:175]
    ds_read_b128 v[36:39], v16 offset:4096
    v_mfma_f32_16x16x32_bf16 v[180:183], v[76:79], v[72:75], v[180:183]
    ds_read_b128 v[40:43], v16 offset:6144
    v_mfma_f32_16x16x32_bf16 v[160:163], v[80:83], v[60:63], v[160:163]
    ds_read_b64_tr_b16 v[44:45], v20 offset:0
    v_mfma_f32_16x16x32_bf16 v[168:171], v[80:83], v[64:67], v[168:171]
    ds_read_b64_tr_b16 v[46:47], v20 offset:512
    v_mfma_f32_16x16x32_bf16 v[176:179], v[80:83], v[68:71], v[176:179]
    ds_read_b64_tr_b16 v[48:49], v24 offset:0
    v_mfma_f32_16x16x32_bf16 v[184:187], v[80:83], v[72:75], v[184:187]
    ds_read_b64_tr_b16 v[50:51], v24 offset:512
    s_waitcnt lgkmcnt(0)
    v_mfma_f32_16x16x32_bf16 v[156:159], v[44:47], v[28:31], v[156:159]
    ds_read_b128 v[60:63], v16 offset:1024
    v_mfma_f32_16x16x32_bf16 v[164:167], v[44:47], v[32:35], v[164:167]
    ds_read_b128 v[64:67], v16 offset:3072
    v_mfma_f32_16x16x32_bf16 v[172:175], v[44:47], v[36:39], v[172:175]
    ds_read_b128 v[68:71], v16 offset:5120
    v_mfma_f32_16x16x32_bf16 v[180:183], v[44:47], v[40:43], v[180:183]
    ds_read_b128 v[72:75], v16 offset:7168
    v_mfma_f32_16x16x32_bf16 v[160:163], v[48:51], v[28:31], v[160:163]
    ds_read_b64_tr_b16 v[76:77], v20 offset:4096
    v_mfma_f32_16x16x32_bf16 v[168:171], v[48:51], v[32:35], v[168:171]
    ds_read_b64_tr_b16 v[78:79], v20 offset:4608
    v_mfma_f32_16x16x32_bf16 v[176:179], v[48:51], v[36:39], v[176:179]
    ds_read_b64_tr_b16 v[80:81], v24 offset:4096
    v_mfma_f32_16x16x32_bf16 v[184:187], v[48:51], v[40:43], v[184:187]
    ds_read_b64_tr_b16 v[82:83], v24 offset:4608
    s_waitcnt lgkmcnt(0)
    s_barrier
    v_mfma_f32_16x16x32_bf16 v[156:159], v[76:79], v[60:63], v[156:159]
    ds_read_b128 v[28:31], v17 offset:0
    v_mfma_f32_16x16x32_bf16 v[164:167], v[76:79], v[64:67], v[164:167]
    ds_read_b128 v[32:35], v17 offset:2048
    v_mfma_f32_16x16x32_bf16 v[172:175], v[76:79], v[68:71], v[172:175]
    ds_read_b128 v[36:39], v17 offset:4096
    v_mfma_f32_16x16x32_bf16 v[180:183], v[76:79], v[72:75], v[180:183]
    ds_read_b128 v[40:43], v17 offset:6144
    v_mfma_f32_16x16x32_bf16 v[160:163], v[80:83], v[60:63], v[160:163]
    ds_read_b64_tr_b16 v[44:45], v21 offset:0
    v_mfma_f32_16x16x32_bf16 v[168:171], v[80:83], v[64:67], v[168:171]
    ds_read_b64_tr_b16 v[46:47], v21 offset:512
    v_mfma_f32_16x16x32_bf16 v[176:179], v[80:83], v[68:71], v[176:179]
    ds_read_b64_tr_b16 v[48:49], v25 offset:0
    v_mfma_f32_16x16x32_bf16 v[184:187], v[80:83], v[72:75], v[184:187]
    ds_read_b64_tr_b16 v[50:51], v25 offset:512
    s_waitcnt lgkmcnt(0)
    v_mfma_f32_16x16x32_bf16 v[156:159], v[44:47], v[28:31], v[156:159]
    ds_read_b128 v[60:63], v17 offset:1024
    v_mfma_f32_16x16x32_bf16 v[164:167], v[44:47], v[32:35], v[164:167]
    ds_read_b128 v[64:67], v17 offset:3072
    v_mfma_f32_16x16x32_bf16 v[172:175], v[44:47], v[36:39], v[172:175]
    ds_read_b128 v[68:71], v17 offset:5120
    v_mfma_f32_16x16x32_bf16 v[180:183], v[44:47], v[40:43], v[180:183]
    ds_read_b128 v[72:75], v17 offset:7168
    v_mfma_f32_16x16x32_bf16 v[160:163], v[48:51], v[28:31], v[160:163]
    ds_read_b64_tr_b16 v[76:77], v21 offset:4096
    v_mfma_f32_16x16x32_bf16 v[168:171], v[48:51], v[32:35], v[168:171]
    ds_read_b64_tr_b16 v[78:79], v21 offset:4608
    v_mfma_f32_16x16x32_bf16 v[176:179], v[48:51], v[36:39], v[176:179]
    ds_read_b64_tr_b16 v[80:81], v25 offset:4096
    v_mfma_f32_16x16x32_bf16 v[184:187], v[48:51], v[40:43], v[184:187]
    ds_read_b64_tr_b16 v[82:83], v25 offset:4608
    s_waitcnt lgkmcnt(0)
    s_barrier
    v_mfma_f32_16x16x32_bf16 v[156:159], v[76:79], v[60:63], v[156:159]
    ds_read_b128 v[28:31], v18 offset:0
    v_mfma_f32_16x16x32_bf16 v[164:167], v[76:79], v[64:67], v[164:167]
    ds_read_b128 v[32:35], v18 offset:2048
    v_mfma_f32_16x16x32_bf16 v[172:175], v[76:79], v[68:71], v[172:175]
    ds_read_b128 v[36:39], v18 offset:4096
    v_mfma_f32_16x16x32_bf16 v[180:183], v[76:79], v[72:75], v[180:183]
    ds_read_b128 v[40:43], v18 offset:6144
    v_mfma_f32_16x16x32_bf16 v[160:163], v[80:83], v[60:63], v[160:163]
    ds_read_b64_tr_b16 v[44:45], v22 offset:0
    v_mfma_f32_16x16x32_bf16 v[168:171], v[80:83], v[64:67], v[168:171]
    ds_read_b64_tr_b16 v[46:47], v22 offset:512
    v_mfma_f32_16x16x32_bf16 v[176:179], v[80:83], v[68:71], v[176:179]
    ds_read_b64_tr_b16 v[48:49], v26 offset:0
    v_mfma_f32_16x16x32_bf16 v[184:187], v[80:83], v[72:75], v[184:187]
    ds_read_b64_tr_b16 v[50:51], v26 offset:512
    s_waitcnt lgkmcnt(0)
    v_mfma_f32_16x16x32_bf16 v[156:159], v[44:47], v[28:31], v[156:159]
    ds_read_b128 v[60:63], v18 offset:1024
    v_mfma_f32_16x16x32_bf16 v[164:167], v[44:47], v[32:35], v[164:167]
    ds_read_b128 v[64:67], v18 offset:3072
    v_mfma_f32_16x16x32_bf16 v[172:175], v[44:47], v[36:39], v[172:175]
    ds_read_b128 v[68:71], v18 offset:5120
    v_mfma_f32_16x16x32_bf16 v[180:183], v[44:47], v[40:43], v[180:183]
    ds_read_b128 v[72:75], v18 offset:7168
    v_mfma_f32_16x16x32_bf16 v[160:163], v[48:51], v[28:31], v[160:163]
    ds_read_b64_tr_b16 v[76:77], v22 offset:4096
    v_mfma_f32_16x16x32_bf16 v[168:171], v[48:51], v[32:35], v[168:171]
    ds_read_b64_tr_b16 v[78:79], v22 offset:4608
    v_mfma_f32_16x16x32_bf16 v[176:179], v[48:51], v[36:39], v[176:179]
    ds_read_b64_tr_b16 v[80:81], v26 offset:4096
    v_mfma_f32_16x16x32_bf16 v[184:187], v[48:51], v[40:43], v[184:187]
    ds_read_b64_tr_b16 v[82:83], v26 offset:4608
    s_waitcnt lgkmcnt(0)
    s_barrier
    v_mfma_f32_16x16x32_bf16 v[156:159], v[76:79], v[60:63], v[156:159]
    ds_read_b128 v[28:31], v19 offset:0
    v_mfma_f32_16x16x32_bf16 v[164:167], v[76:79], v[64:67], v[164:167]
    ds_read_b128 v[32:35], v19 offset:2048
    v_mfma_f32_16x16x32_bf16 v[172:175], v[76:79], v[68:71], v[172:175]
    ds_read_b128 v[36:39], v19 offset:4096
    v_mfma_f32_16x16x32_bf16 v[180:183], v[76:79], v[72:75], v[180:183]
    ds_read_b128 v[40:43], v19 offset:6144
    v_mfma_f32_16x16x32_bf16 v[160:163], v[80:83], v[60:63], v[160:163]
    ds_read_b64_tr_b16 v[44:45], v23 offset:0
    v_mfma_f32_16x16x32_bf16 v[168:171], v[80:83], v[64:67], v[168:171]
    ds_read_b64_tr_b16 v[46:47], v23 offset:512
    v_mfma_f32_16x16x32_bf16 v[176:179], v[80:83], v[68:71], v[176:179]
    ds_read_b64_tr_b16 v[48:49], v27 offset:0
    v_mfma_f32_16x16x32_bf16 v[184:187], v[80:83], v[72:75], v[184:187]
    ds_read_b64_tr_b16 v[50:51], v27 offset:512
    s_waitcnt lgkmcnt(0)
    v_mfma_f32_16x16x32_bf16 v[156:159], v[44:47], v[28:31], v[156:159]
    ds_read_b128 v[60:63], v19 offset:1024
    v_mfma_f32_16x16x32_bf16 v[164:167], v[44:47], v[32:35], v[164:167]
    ds_read_b128 v[64:67], v19 offset:3072
    v_mfma_f32_16x16x32_bf16 v[172:175], v[44:47], v[36:39], v[172:175]
    ds_read_b128 v[68:71], v19 offset:5120
    v_mfma_f32_16x16x32_bf16 v[180:183], v[44:47], v[40:43], v[180:183]
    ds_read_b128 v[72:75], v19 offset:7168
    v_mfma_f32_16x16x32_bf16 v[160:163], v[48:51], v[28:31], v[160:163]
    ds_read_b64_tr_b16 v[76:77], v23 offset:4096
    v_mfma_f32_16x16x32_bf16 v[168:171], v[48:51], v[32:35], v[168:171]
    ds_read_b64_tr_b16 v[78:79], v23 offset:4608
    v_mfma_f32_16x16x32_bf16 v[176:179], v[48:51], v[36:39], v[176:179]
    ds_read_b64_tr_b16 v[80:81], v27 offset:4096
    v_mfma_f32_16x16x32_bf16 v[184:187], v[48:51], v[40:43], v[184:187]
    ds_read_b64_tr_b16 v[82:83], v27 offset:4608
    s_add_u32 s43, s43, 1
    s_waitcnt lgkmcnt(0)
    s_cmp_lt_u32 s43, 4
    s_cbranch_scc1 p3loop_60
    v_mfma_f32_16x16x32_bf16 v[156:159], v[76:79], v[60:63], v[156:159]
    v_mfma_f32_16x16x32_bf16 v[164:167], v[76:79], v[64:67], v[164:167]
    v_mfma_f32_16x16x32_bf16 v[172:175], v[76:79], v[68:71], v[172:175]
    v_mfma_f32_16x16x32_bf16 v[180:183], v[76:79], v[72:75], v[180:183]
    v_mfma_f32_16x16x32_bf16 v[160:163], v[80:83], v[60:63], v[160:163]
    v_mfma_f32_16x16x32_bf16 v[168:171], v[80:83], v[64:67], v[168:171]
    v_mfma_f32_16x16x32_bf16 v[176:179], v[80:83], v[68:71], v[176:179]
    v_mfma_f32_16x16x32_bf16 v[184:187], v[80:83], v[72:75], v[184:187]
    s_add_u32 s20, s64, 0x2000000
    s_addc_u32 s21, s65, 0
    s_mov_b32 s22, 0x400000
    s_mov_b32 s23, 0x20000
    s_nop 4
    v_pk_mul_f32 v[28:29], v[196:197], v[192:193] op_sel:[0,0] op_sel_hi:[1,0]
    v_pk_fma_f32 v[156:157], v[156:157], v[188:189], v[28:29] op_sel:[0,0,0] op_sel_hi:[1,0,1]
    v_pk_mul_f32 v[28:29], v[198:199], v[192:193] op_sel:[0,0] op_sel_hi:[1,0]
    v_pk_fma_f32 v[158:159], v[158:159], v[188:189], v[28:29] op_sel:[0,0,0] op_sel_hi:[1,0,1]
    v_pk_mul_f32 v[28:29], v[200:201], v[192:193] op_sel:[0,0] op_sel_hi:[1,0]
    v_pk_fma_f32 v[160:161], v[160:161], v[188:189], v[28:29] op_sel:[0,0,0] op_sel_hi:[1,0,1]
    v_pk_mul_f32 v[28:29], v[202:203], v[192:193] op_sel:[0,0] op_sel_hi:[1,0]
    v_pk_fma_f32 v[162:163], v[162:163], v[188:189], v[28:29] op_sel:[0,0,0] op_sel_hi:[1,0,1]
    v_pk_mul_f32 v[28:29], v[196:197], v[192:193] op_sel:[0,1] op_sel_hi:[1,1]
    v_pk_fma_f32 v[164:165], v[164:165], v[188:189], v[28:29] op_sel:[0,1,0] op_sel_hi:[1,1,1]
    v_pk_mul_f32 v[28:29], v[198:199], v[192:193] op_sel:[0,1] op_sel_hi:[1,1]
    v_pk_fma_f32 v[166:167], v[166:167], v[188:189], v[28:29] op_sel:[0,1,0] op_sel_hi:[1,1,1]
    v_pk_mul_f32 v[28:29], v[200:201], v[192:193] op_sel:[0,1] op_sel_hi:[1,1]
    v_pk_fma_f32 v[168:169], v[168:169], v[188:189], v[28:29] op_sel:[0,1,0] op_sel_hi:[1,1,1]
    v_pk_mul_f32 v[28:29], v[202:203], v[192:193] op_sel:[0,1] op_sel_hi:[1,1]
    v_pk_fma_f32 v[170:171], v[170:171], v[188:189], v[28:29] op_sel:[0,1,0] op_sel_hi:[1,1,1]
    v_pk_mul_f32 v[28:29], v[196:197], v[194:195] op_sel:[0,0] op_sel_hi:[1,0]
    v_pk_fma_f32 v[172:173], v[172:173], v[190:191], v[28:29] op_sel:[0,0,0] op_sel_hi:[1,0,1]
    v_pk_mul_f32 v[28:29], v[198:199], v[194:195] op_sel:[0,0] op_sel_hi:[1,0]
    v_pk_fma_f32 v[174:175], v[174:175], v[190:191], v[28:29] op_sel:[0,0,0] op_sel_hi:[1,0,1]
    v_pk_mul_f32 v[28:29], v[200:201], v[194:195] op_sel:[0,0] op_sel_hi:[1,0]
    v_pk_fma_f32 v[176:177], v[176:177], v[190:191], v[28:29] op_sel:[0,0,0] op_sel_hi:[1,0,1]
    v_pk_mul_f32 v[28:29], v[202:203], v[194:195] op_sel:[0,0] op_sel_hi:[1,0]
    v_pk_fma_f32 v[178:179], v[178:179], v[190:191], v[28:29] op_sel:[0,0,0] op_sel_hi:[1,0,1]
    v_pk_mul_f32 v[28:29], v[196:197], v[194:195] op_sel:[0,1] op_sel_hi:[1,1]
    v_pk_fma_f32 v[180:181], v[180:181], v[190:191], v[28:29] op_sel:[0,1,0] op_sel_hi:[1,1,1]
    v_pk_mul_f32 v[28:29], v[198:199], v[194:195] op_sel:[0,1] op_sel_hi:[1,1]
    v_pk_fma_f32 v[182:183], v[182:183], v[190:191], v[28:29] op_sel:[0,1,0] op_sel_hi:[1,1,1]
    v_pk_mul_f32 v[28:29], v[200:201], v[194:195] op_sel:[0,1] op_sel_hi:[1,1]
    v_pk_fma_f32 v[184:185], v[184:185], v[190:191], v[28:29] op_sel:[0,1,0] op_sel_hi:[1,1,1]
    v_pk_mul_f32 v[28:29], v[202:203], v[194:195] op_sel:[0,1] op_sel_hi:[1,1]
    v_pk_fma_f32 v[186:187], v[186:187], v[190:191], v[28:29] op_sel:[0,1,0] op_sel_hi:[1,1,1]
    v_pk_mul_f32 v[28:29], v[156:157], s[44:45]
    v_min_f32 v28, 0, v28
    v_min_f32 v29, 0, v29
    v_exp_f32 v28, v28
    v_exp_f32 v29, v29
    v_max_f32 v156, 0, v156
    v_max_f32 v157, 0, v157
    v_pk_add_f32 v[156:157], v[156:157], s[46:47]
    v_pk_add_f32 v[156:157], v[156:157], v[28:29]
    v_pk_mul_f32 v[32:33], v[158:159], s[44:45]
    v_min_f32 v32, 0, v32
    v_min_f32 v33, 0, v33
    v_exp_f32 v32, v32
    v_exp_f32 v33, v33
    v_max_f32 v158, 0, v158
    v_max_f32 v159, 0, v159
    v_pk_add_f32 v[158:159], v[158:159], s[46:47]
    v_pk_add_f32 v[158:159], v[158:159], v[32:33]
    v_pk_mul_f32 v[28:29], v[160:161], s[44:45]
    v_min_f32 v28, 0, v28
    v_min_f32 v29, 0, v29
    v_exp_f32 v28, v28
    v_exp_f32 v29, v29
    v_max_f32 v160, 0, v160
    v_max_f32 v161, 0, v161
    v_pk_add_f32 v[160:161], v[160:161], s[46:47]
    v_pk_add_f32 v[160:161], v[160:161], v[28:29]
    v_pk_mul_f32 v[32:33], v[162:163], s[44:45]
    v_min_f32 v32, 0, v32
    v_min_f32 v33, 0, v33
    v_exp_f32 v32, v32
    v_exp_f32 v33, v33
    v_max_f32 v162, 0, v162
    v_max_f32 v163, 0, v163
    v_pk_add_f32 v[162:163], v[162:163], s[46:47]
    v_pk_add_f32 v[162:163], v[162:163], v[32:33]
    v_cvt_pk_bf16_f32 v36, v156, v157
    v_cvt_pk_bf16_f32 v37, v158, v159
    v_cvt_pk_bf16_f32 v38, v160, v161
    v_cvt_pk_bf16_f32 v39, v162, v163
    v_pk_mul_f32 v[28:29], v[164:165], s[44:45]
    v_min_f32 v28, 0, v28
    v_min_f32 v29, 0, v29
    v_exp_f32 v28, v28
    v_exp_f32 v29, v29
    v_max_f32 v164, 0, v164
    v_max_f32 v165, 0, v165
    v_pk_add_f32 v[164:165], v[164:165], s[46:47]
    v_pk_add_f32 v[164:165], v[164:165], v[28:29]
    v_pk_mul_f32 v[32:33], v[166:167], s[44:45]
    v_min_f32 v32, 0, v32
    v_min_f32 v33, 0, v33
    v_exp_f32 v32, v32
    v_exp_f32 v33, v33
    v_max_f32 v166, 0, v166
    v_max_f32 v167, 0, v167
    v_pk_add_f32 v[166:167], v[166:167], s[46:47]
    v_pk_add_f32 v[166:167], v[166:167], v[32:33]
    v_pk_mul_f32 v[28:29], v[168:169], s[44:45]
    v_min_f32 v28, 0, v28
    v_min_f32 v29, 0, v29
    v_exp_f32 v28, v28
    v_exp_f32 v29, v29
    v_max_f32 v168, 0, v168
    v_max_f32 v169, 0, v169
    v_pk_add_f32 v[168:169], v[168:169], s[46:47]
    v_pk_add_f32 v[168:169], v[168:169], v[28:29]
    v_pk_mul_f32 v[32:33], v[170:171], s[44:45]
    v_min_f32 v32, 0, v32
    v_min_f32 v33, 0, v33
    v_exp_f32 v32, v32
    v_exp_f32 v33, v33
    v_max_f32 v170, 0, v170
    v_max_f32 v171, 0, v171
    v_pk_add_f32 v[170:171], v[170:171], s[46:47]
    v_pk_add_f32 v[170:171], v[170:171], v[32:33]
    v_cvt_pk_bf16_f32 v40, v164, v165
    v_cvt_pk_bf16_f32 v41, v166, v167
    v_cvt_pk_bf16_f32 v42, v168, v169
    v_cvt_pk_bf16_f32 v43, v170, v171
    v_pk_mul_f32 v[28:29], v[172:173], s[44:45]
    v_min_f32 v28, 0, v28
    v_min_f32 v29, 0, v29
    v_exp_f32 v28, v28
    v_exp_f32 v29, v29
    v_max_f32 v172, 0, v172
    v_max_f32 v173, 0, v173
    v_pk_add_f32 v[172:173], v[172:173], s[46:47]
    v_pk_add_f32 v[172:173], v[172:173], v[28:29]
    v_pk_mul_f32 v[32:33], v[174:175], s[44:45]
    v_min_f32 v32, 0, v32
    v_min_f32 v33, 0, v33
    v_exp_f32 v32, v32
    v_exp_f32 v33, v33
    v_max_f32 v174, 0, v174
    v_max_f32 v175, 0, v175
    v_pk_add_f32 v[174:175], v[174:175], s[46:47]
    v_pk_add_f32 v[174:175], v[174:175], v[32:33]
    v_pk_mul_f32 v[28:29], v[176:177], s[44:45]
    v_min_f32 v28, 0, v28
    v_min_f32 v29, 0, v29
    v_exp_f32 v28, v28
    v_exp_f32 v29, v29
    v_max_f32 v176, 0, v176
    v_max_f32 v177, 0, v177
    v_pk_add_f32 v[176:177], v[176:177], s[46:47]
    v_pk_add_f32 v[176:177], v[176:177], v[28:29]
    v_pk_mul_f32 v[32:33], v[178:179], s[44:45]
    v_min_f32 v32, 0, v32
    v_min_f32 v33, 0, v33
    v_exp_f32 v32, v32
    v_exp_f32 v33, v33
    v_max_f32 v178, 0, v178
    v_max_f32 v179, 0, v179
    v_pk_add_f32 v[178:179], v[178:179], s[46:47]
    v_pk_add_f32 v[178:179], v[178:179], v[32:33]
    v_cvt_pk_bf16_f32 v44, v172, v173
    v_cvt_pk_bf16_f32 v45, v174, v175
    v_cvt_pk_bf16_f32 v46, v176, v177
    v_cvt_pk_bf16_f32 v47, v178, v179
    v_pk_mul_f32 v[28:29], v[180:181], s[44:45]
    v_min_f32 v28, 0, v28
    v_min_f32 v29, 0, v29
    v_exp_f32 v28, v28
    v_exp_f32 v29, v29
    v_max_f32 v180, 0, v180
    v_max_f32 v181, 0, v181
    v_pk_add_f32 v[180:181], v[180:181], s[46:47]
    v_pk_add_f32 v[180:181], v[180:181], v[28:29]
    v_pk_mul_f32 v[32:33], v[182:183], s[44:45]
    v_min_f32 v32, 0, v32
    v_min_f32 v33, 0, v33
    v_exp_f32 v32, v32
    v_exp_f32 v33, v33
    v_max_f32 v182, 0, v182
    v_max_f32 v183, 0, v183
    v_pk_add_f32 v[182:183], v[182:183], s[46:47]
    v_pk_add_f32 v[182:183], v[182:183], v[32:33]
    v_pk_mul_f32 v[28:29], v[184:185], s[44:45]
    v_min_f32 v28, 0, v28
    v_min_f32 v29, 0, v29
    v_exp_f32 v28, v28
    v_exp_f32 v29, v29
    v_max_f32 v184, 0, v184
    v_max_f32 v185, 0, v185
    v_pk_add_f32 v[184:185], v[184:185], s[46:47]
    v_pk_add_f32 v[184:185], v[184:185], v[28:29]
    v_pk_mul_f32 v[32:33], v[186:187], s[44:45]
    v_min_f32 v32, 0, v32
    v_min_f32 v33, 0, v33
    v_exp_f32 v32, v32
    v_exp_f32 v33, v33
    v_max_f32 v186, 0, v186
    v_max_f32 v187, 0, v187
    v_pk_add_f32 v[186:187], v[186:187], s[46:47]
    v_pk_add_f32 v[186:187], v[186:187], v[32:33]
    v_cvt_pk_bf16_f32 v48, v180, v181
    v_cvt_pk_bf16_f32 v49, v182, v183
    v_cvt_pk_bf16_f32 v50, v184, v185
    v_cvt_pk_bf16_f32 v51, v186, v187
    s_lshl_b32 s41, s6, 4
    s_add_u32 s41, s41, s7
    s_lshl_b32 s41, s41, 14
    s_lshl_b32 s42, s37, 13
    s_add_u32 s41, s41, s42
    s_lshl_b32 s42, s38, 10
    s_add_u32 s41, s41, s42
    s_lshl_b32 s42, s38, 11
    s_add_u32 s42, s42, 157696
    v_add_u32 v12, s42, v2
    s_lshl_b32 s42, s38, 6
    s_add_u32 s42, s42, 161792
    v_add_u32 v13, s42, v10
    v_mov_b32 v52, 0x358637bd
    v_mov_b32 v53, 0x358637bd
    v_mov_b32 v54, 0x358637bd
    v_mov_b32 v55, 0x358637bd
    s_barrier
    ds_read_b128 v[56:59], v12
    ds_read_b128 v[60:63], v12 offset:1024
    ds_read_b128 v[64:67], v13
    s_waitcnt lgkmcnt(0)
    v_mfma_f32_16x16x32_bf16 v[100:103], v[64:67], v[36:39], v[52:55]
    v_mfma_f32_16x16x32_bf16 v[92:95], v[56:59], v[36:39], 0
    v_mfma_f32_16x16x32_bf16 v[96:99], v[60:63], v[36:39], 0
    v_mfma_f32_16x16x32_bf16 v[112:115], v[64:67], v[40:43], v[52:55]
    v_mfma_f32_16x16x32_bf16 v[104:107], v[56:59], v[40:43], 0
    v_mfma_f32_16x16x32_bf16 v[108:111], v[60:63], v[40:43], 0
    v_mfma_f32_16x16x32_bf16 v[124:127], v[64:67], v[44:47], v[52:55]
    v_mfma_f32_16x16x32_bf16 v[116:119], v[56:59], v[44:47], 0
    v_mfma_f32_16x16x32_bf16 v[120:123], v[60:63], v[44:47], 0
    v_mfma_f32_16x16x32_bf16 v[136:139], v[64:67], v[48:51], v[52:55]
    v_mfma_f32_16x16x32_bf16 v[128:131], v[56:59], v[48:51], 0
    v_mfma_f32_16x16x32_bf16 v[132:135], v[60:63], v[48:51], 0
    s_nop 7
    v_rcp_f32 v100, v100
    v_rcp_f32 v112, v112
    v_rcp_f32 v124, v124
    v_rcp_f32 v136, v136
    v_pk_mul_f32 v[92:93], v[92:93], v[100:101] op_sel_hi:[1,0]
    v_pk_mul_f32 v[94:95], v[94:95], v[100:101] op_sel_hi:[1,0]
    v_pk_mul_f32 v[96:97], v[96:97], v[100:101] op_sel_hi:[1,0]
    v_pk_mul_f32 v[98:99], v[98:99], v[100:101] op_sel_hi:[1,0]
    v_cvt_pk_bf16_f32 v36, v92, v93
    v_cvt_pk_bf16_f32 v37, v94, v95
    v_cvt_pk_bf16_f32 v38, v96, v97
    v_cvt_pk_bf16_f32 v39, v98, v99
    s_add_u32 s42, s41, 0
    buffer_store_dwordx4 v[36:39], v2, s[20:23], s42 offen sc1
    v_pk_mul_f32 v[104:105], v[104:105], v[112:113] op_sel_hi:[1,0]
    v_pk_mul_f32 v[106:107], v[106:107], v[112:113] op_sel_hi:[1,0]
    v_pk_mul_f32 v[108:109], v[108:109], v[112:113] op_sel_hi:[1,0]
    v_pk_mul_f32 v[110:111], v[110:111], v[112:113] op_sel_hi:[1,0]
    v_cvt_pk_bf16_f32 v40, v104, v105
    v_cvt_pk_bf16_f32 v41, v106, v107
    v_cvt_pk_bf16_f32 v42, v108, v109
    v_cvt_pk_bf16_f32 v43, v110, v111
    s_add_u32 s42, s41, 2048
    buffer_store_dwordx4 v[40:43], v2, s[20:23], s42 offen sc1
    v_pk_mul_f32 v[116:117], v[116:117], v[124:125] op_sel_hi:[1,0]
    v_pk_mul_f32 v[118:119], v[118:119], v[124:125] op_sel_hi:[1,0]
    v_pk_mul_f32 v[120:121], v[120:121], v[124:125] op_sel_hi:[1,0]
    v_pk_mul_f32 v[122:123], v[122:123], v[124:125] op_sel_hi:[1,0]
    v_cvt_pk_bf16_f32 v44, v116, v117
    v_cvt_pk_bf16_f32 v45, v118, v119
    v_cvt_pk_bf16_f32 v46, v120, v121
    v_cvt_pk_bf16_f32 v47, v122, v123
    s_add_u32 s42, s41, 4096
    buffer_store_dwordx4 v[44:47], v2, s[20:23], s42 offen sc1
    v_pk_mul_f32 v[128:129], v[128:129], v[136:137] op_sel_hi:[1,0]
    v_pk_mul_f32 v[130:131], v[130:131], v[136:137] op_sel_hi:[1,0]
    v_pk_mul_f32 v[132:133], v[132:133], v[136:137] op_sel_hi:[1,0]
    v_pk_mul_f32 v[134:135], v[134:135], v[136:137] op_sel_hi:[1,0]
    v_cvt_pk_bf16_f32 v48, v128, v129
    v_cvt_pk_bf16_f32 v49, v130, v131
    v_cvt_pk_bf16_f32 v50, v132, v133
    v_cvt_pk_bf16_f32 v51, v134, v135
    s_add_u32 s42, s41, 6144
    buffer_store_dwordx4 v[48:51], v2, s[20:23], s42 offen sc1
    s_waitcnt vmcnt(0)
p3end_54_nod:
    s_waitcnt lgkmcnt(0)
    s_barrier
    s_cmp_lg_u32 s3, 0
    s_cbranch_scc1 arr_61
    s_lshl_b32 s56, s6, 8
    s_add_u32 s56, s56, 32768
    v_mov_b32 v250, s56
    v_mov_b32 v251, 1
    s_mov_b64 exec, 1
    buffer_atomic_add v251, v250, s[88:91], 0 offen sc1
    s_mov_b64 exec, -1
arr_61:
    s_and_b32 s4, s2, 7
    s_lshr_b32 s5, s2, 3
    s_and_b32 s6, s4, 3
    s_lshl_b32 s6, s6, 3
    s_and_b32 s7, s5, 7
    s_add_u32 s6, s6, s7
    s_lshr_b32 s7, s4, 2
    s_lshl_b32 s7, s7, 2
    s_lshr_b32 s8, s5, 3
    s_add_u32 s7, s7, s8
    s_cmp_ge_u32 s3, 4
    s_cbranch_scc1 p4pre_63
    s_add_u32 s20, s64, 0xc00000
    s_addc_u32 s21, s65, 0
    s_mov_b32 s22, 0x400000
    s_mov_b32 s23, 0x20000
    v_and_b32 v1, 63, v0
    v_lshlrev_b32 v2, 4, v1
    v_and_b32 v3, 15, v1
    v_lshrrev_b32 v4, 4, v1
    s_lshr_b32 s37, s3, 1
    s_and_b32 s38, s3, 1
    v_and_b32 v5, 1, v4
    v_lshlrev_b32 v5, 1, v5
    v_lshrrev_b32 v6, 1, v4
    v_add_u32 v5, v5, v6
    v_lshlrev_b32 v5, 8, v5
    v_lshl_add_u32 v5, v3, 4, v5
    s_lshr_b32 s44, s6, 1
    s_lshl_b32 s44, s44, 18
    s_lshl_b32 s45, s7, 1
    s_add_u32 s45, s45, s38
    s_lshl_b32 s45, s45, 14
    s_add_u32 s44, s44, s45
    s_and_b32 s45, s6, 1
    s_lshl_b32 s45, s45, 13
    s_add_u32 s44, s44, s45
    s_lshl_b32 s45, s37, 12
    s_add_u32 s44, s44, s45
    buffer_load_dwordx4 v[96:99], v5, s[20:23], s44 offen offset:0 sc1
    buffer_load_dwordx4 v[100:103], v5, s[20:23], s44 offen offset:1024 sc1
    buffer_load_dwordx4 v[104:107], v5, s[20:23], s44 offen offset:2048 sc1
    buffer_load_dwordx4 v[108:111], v5, s[20:23], s44 offen offset:3072 sc1
    s_branch p4pre_62
p4pre_63:
    s_add_u32 s12, s64, 0x2000000
    s_addc_u32 s13, s65, 0
    s_mov_b32 s14, 0x400000
    s_mov_b32 s15, 0x20000
    s_lshr_b32 s28, s6, 1
    s_lshl_b32 s28, s28, 18
    s_and_b32 s40, s6, 1
    s_lshl_b32 s40, s40, 13
    s_add_u32 s28, s28, s40
    s_lshl_b32 s41, s37, 11
    s_add_u32 s28, s28, s41
p4pre_62:
    s_lshr_b32 s9, s6, 1
    s_cmp_lg_u32 s3, 0
    s_cbranch_scc1 wt_64
    v_and_b32 v250, 63, v0
    v_lshlrev_b32 v250, 8, v250
    s_lshl_b32 s56, s9, 8
    s_add_u32 s56, s56, 32768
    v_add_u32 v250, s56, v250
    s_mov_b64 exec, 0x1
    s_mov_b32 s57, 0
wp_65:
    buffer_load_dword v251, v250, s[88:91], 0 offen sc1
    s_add_u32 s57, s57, 1
    s_cmp_gt_u32 s57, 30000
    s_cbranch_scc1 wd_66
    s_waitcnt vmcnt(0)
    v_cmp_le_u32 vcc, 16, v251
    s_nop 1
    s_cmp_eq_u64 vcc, exec
    s_cbranch_scc0 wp_65
wd_66:
    s_mov_b64 exec, -1
wt_64:
    s_barrier
    s_cmp_lt_u32 s3, 4
    s_cbranch_scc1 p4comp_67
    s_add_u32 m0, s41, 0
    s_add_u32 s40, s28, 0
    buffer_load_dwordx4 v5, s[12:15], s40 offen offset:0 sc1 lds
    buffer_load_dwordx4 v5, s[12:15], s40 offen offset:1024 sc1 lds
    s_add_u32 m0, s41, 24576
    s_add_u32 s40, s28, 16384
    buffer_load_dwordx4 v5, s[12:15], s40 offen offset:0 sc1 lds
    buffer_load_dwordx4 v5, s[12:15], s40 offen offset:1024 sc1 lds
    s_add_u32 m0, s41, 49152
    s_add_u32 s40, s28, 32768
    buffer_load_dwordx4 v5, s[12:15], s40 offen offset:0 sc1 lds
    buffer_load_dwordx4 v5, s[12:15], s40 offen offset:1024 sc1 lds
    s_add_u32 m0, s41, 73728
    s_add_u32 s40, s28, 49152
    buffer_load_dwordx4 v5, s[12:15], s40 offen offset:0 sc1 lds
    buffer_load_dwordx4 v5, s[12:15], s40 offen offset:1024 sc1 lds
    s_add_u32 m0, s41, 98304
    s_add_u32 s40, s28, 65536
    buffer_load_dwordx4 v5, s[12:15], s40 offen offset:0 sc1 lds
    buffer_load_dwordx4 v5, s[12:15], s40 offen offset:1024 sc1 lds
    s_waitcnt vmcnt(8)
    s_barrier
    s_add_u32 m0, s39, 131072
    s_add_u32 s40, s29, 81920
    buffer_load_dwordx4 v5, s[16:19], s40 offen offset:0 sc1 lds
    buffer_load_dwordx4 v5, s[16:19], s40 offen offset:1024 sc1 lds
    buffer_load_dwordx4 v5, s[16:19], s40 offen offset:2048 sc1 lds
    buffer_load_dwordx4 v5, s[16:19], s40 offen offset:3072 sc1 lds
    s_add_u32 m0, s41, 122880
    s_add_u32 s40, s28, 81920
    buffer_load_dwordx4 v5, s[12:15], s40 offen offset:0 sc1 lds
    buffer_load_dwordx4 v5, s[12:15], s40 offen offset:1024 sc1 lds
    s_waitcnt vmcnt(12)
    s_barrier
    s_add_u32 m0, s39, 8192
    s_add_u32 s40, s29, 98304
    buffer_load_dwordx4 v5, s[16:19], s40 offen offset:0 sc1 lds
    buffer_load_dwordx4 v5, s[16:19], s40 offen offset:1024 sc1 lds
    buffer_load_dwordx4 v5, s[16:19], s40 offen offset:2048 sc1 lds
    buffer_load_dwordx4 v5, s[16:19], s40 offen offset:3072 sc1 lds
    s_add_u32 m0, s41, 0
    s_add_u32 s40, s28, 98304
    buffer_load_dwordx4 v5, s[12:15], s40 offen offset:0 sc1 lds
    buffer_load_dwordx4 v5, s[12:15], s40 offen offset:1024 sc1 lds
    s_waitcnt vmcnt(16)
    s_barrier
    s_add_u32 m0, s39, 32768
    s_add_u32 s40, s29, 114688
    buffer_load_dwordx4 v5, s[16:19], s40 offen offset:0 sc1 lds
    buffer_load_dwordx4 v5, s[16:19], s40 offen offset:1024 sc1 lds
    buffer_load_dwordx4 v5, s[16:19], s40 offen offset:2048 sc1 lds
    buffer_load_dwordx4 v5, s[16:19], s40 offen offset:3072 sc1 lds
    s_add_u32 m0, s41, 24576
    s_add_u32 s40, s28, 114688
    buffer_load_dwordx4 v5, s[12:15], s40 offen offset:0 sc1 lds
    buffer_load_dwordx4 v5, s[12:15], s40 offen offset:1024 sc1 lds
    s_waitcnt vmcnt(20)
    s_barrier
    s_add_u32 m0, s39, 57344
    s_add_u32 s40, s29, 131072
    buffer_load_dwordx4 v5, s[16:19], s40 offen offset:0 sc1 lds
    buffer_load_dwordx4 v5, s[16:19], s40 offen offset:1024 sc1 lds
    buffer_load_dwordx4 v5, s[16:19], s40 offen offset:2048 sc1 lds
    buffer_load_dwordx4 v5, s[16:19], s40 offen offset:3072 sc1 lds
    s_add_u32 m0, s41, 49152
    s_add_u32 s40, s28, 131072
    buffer_load_dwordx4 v5, s[12:15], s40 offen offset:0 sc1 lds
    buffer_load_dwordx4 v5, s[12:15], s40 offen offset:1024 sc1 lds
    s_waitcnt vmcnt(24)
    s_barrier
    s_add_u32 m0, s39, 81920
    s_add_u32 s40, s29, 147456
    buffer_load_dwordx4 v5, s[16:19], s40 offen offset:0 sc1 lds
    buffer_load_dwordx4 v5, s[16:19], s40 offen offset:1024 sc1 lds
    buffer_load_dwordx4 v5, s[16:19], s40 offen offset:2048 sc1 lds
    buffer_load_dwordx4 v5, s[16:19], s40 offen offset:3072 sc1 lds
    s_add_u32 m0, s41, 73728
    s_add_u32 s40, s28, 147456
    buffer_load_dwordx4 v5, s[12:15], s40 offen offset:0 sc1 lds
    buffer_load_dwordx4 v5, s[12:15], s40 offen offset:1024 sc1 lds
    s_waitcnt vmcnt(24)
    s_barrier
    s_add_u32 m0, s39, 106496
    s_add_u32 s40, s29, 163840
    buffer_load_dwordx4 v5, s[16:19], s40 offen offset:0 sc1 lds
    buffer_load_dwordx4 v5, s[16:19], s40 offen offset:1024 sc1 lds
    buffer_load_dwordx4 v5, s[16:19], s40 offen offset:2048 sc1 lds
    buffer_load_dwordx4 v5, s[16:19], s40 offen offset:3072 sc1 lds
    s_add_u32 m0, s41, 98304
    s_add_u32 s40, s28, 163840
    buffer_load_dwordx4 v5, s[12:15], s40 offen offset:0 sc1 lds
    buffer_load_dwordx4 v5, s[12:15], s40 offen offset:1024 sc1 lds
    s_waitcnt vmcnt(24)
    s_barrier
    s_add_u32 m0, s39, 131072
    s_add_u32 s40, s29, 180224
    buffer_load_dwordx4 v5, s[16:19], s40 offen offset:0 sc1 lds
    buffer_load_dwordx4 v5, s[16:19], s40 offen offset:1024 sc1 lds
    buffer_load_dwordx4 v5, s[16:19], s40 offen offset:2048 sc1 lds
    buffer_load_dwordx4 v5, s[16:19], s40 offen offset:3072 sc1 lds
    s_add_u32 m0, s41, 122880
    s_add_u32 s40, s28, 180224
    buffer_load_dwordx4 v5, s[12:15], s40 offen offset:0 sc1 lds
    buffer_load_dwordx4 v5, s[12:15], s40 offen offset:1024 sc1 lds
    s_waitcnt vmcnt(24)
    s_barrier
    s_add_u32 m0, s39, 8192
    s_add_u32 s40, s29, 196608
    buffer_load_dwordx4 v5, s[16:19], s40 offen offset:0 sc1 lds
    buffer_load_dwordx4 v5, s[16:19], s40 offen offset:1024 sc1 lds
    buffer_load_dwordx4 v5, s[16:19], s40 offen offset:2048 sc1 lds
    buffer_load_dwordx4 v5, s[16:19], s40 offen offset:3072 sc1 lds
    s_add_u32 m0, s41, 0
    s_add_u32 s40, s28, 196608
    buffer_load_dwordx4 v5, s[12:15], s40 offen offset:0 sc1 lds
    buffer_load_dwordx4 v5, s[12:15], s40 offen offset:1024 sc1 lds
    s_waitcnt vmcnt(24)
    s_barrier
    s_add_u32 m0, s39, 32768
    s_add_u32 s40, s29, 212992
    buffer_load_dwordx4 v5, s[16:19], s40 offen offset:0 sc1 lds
    buffer_load_dwordx4 v5, s[16:19], s40 offen offset:1024 sc1 lds
    buffer_load_dwordx4 v5, s[16:19], s40 offen offset:2048 sc1 lds
    buffer_load_dwordx4 v5, s[16:19], s40 offen offset:3072 sc1 lds
    s_add_u32 m0, s41, 24576
    s_add_u32 s40, s28, 212992
    buffer_load_dwordx4 v5, s[12:15], s40 offen offset:0 sc1 lds
    buffer_load_dwordx4 v5, s[12:15], s40 offen offset:1024 sc1 lds
    s_waitcnt vmcnt(24)
    s_barrier
    s_add_u32 m0, s39, 57344
    s_add_u32 s40, s29, 229376
    buffer_load_dwordx4 v5, s[16:19], s40 offen offset:0 sc1 lds
    buffer_load_dwordx4 v5, s[16:19], s40 offen offset:1024 sc1 lds
    buffer_load_dwordx4 v5, s[16:19], s40 offen offset:2048 sc1 lds
    buffer_load_dwordx4 v5, s[16:19], s40 offen offset:3072 sc1 lds
    s_add_u32 m0, s41, 49152
    s_add_u32 s40, s28, 229376
    buffer_load_dwordx4 v5, s[12:15], s40 offen offset:0 sc1 lds
    buffer_load_dwordx4 v5, s[12:15], s40 offen offset:1024 sc1 lds
    s_waitcnt vmcnt(24)
    s_barrier
    s_add_u32 m0, s39, 81920
    s_add_u32 s40, s29, 245760
    buffer_load_dwordx4 v5, s[16:19], s40 offen offset:0 sc1 lds
    buffer_load_dwordx4 v5, s[16:19], s40 offen offset:1024 sc1 lds
    buffer_load_dwordx4 v5, s[16:19], s40 offen offset:2048 sc1 lds
    buffer_load_dwordx4 v5, s[16:19], s40 offen offset:3072 sc1 lds
    s_add_u32 m0, s41, 73728
    s_add_u32 s40, s28, 245760
    buffer_load_dwordx4 v5, s[12:15], s40 offen offset:0 sc1 lds
    buffer_load_dwordx4 v5, s[12:15], s40 offen offset:1024 sc1 lds
    s_waitcnt vmcnt(24)
    s_barrier
    s_waitcnt vmcnt(18)
    s_barrier
    s_waitcnt vmcnt(12)
    s_barrier
    s_waitcnt vmcnt(6)
    s_barrier
    s_waitcnt vmcnt(0)
    s_barrier
    s_branch p4end_68
p4comp_67:
    s_lshl_b32 s45, s37, 12
    s_add_u32 s46, s45, 0
    v_add_u32 v140, s46, v2
    s_add_u32 s46, s45, 24576
    v_add_u32 v141, s46, v2
    s_add_u32 s46, s45, 49152
    v_add_u32 v142, s46, v2
    s_add_u32 s46, s45, 73728
    v_add_u32 v143, s46, v2
    s_add_u32 s46, s45, 98304
    v_add_u32 v144, s46, v2
    s_add_u32 s46, s45, 122880
    v_add_u32 v145, s46, v2
    v_bfe_u32 v6, v1, 2, 2
    v_lshl_add_u32 v7, v4, 2, v6
    v_lshlrev_b32 v8, 8, v7
    v_and_b32 v7, 7, v7
    v_lshl_add_u32 v8, v7, 5, v8
    v_and_b32 v7, 3, v1
    v_lshl_add_u32 v8, v7, 3, v8
    s_lshl_b32 s45, s38, 7
    v_xor_b32 v8, s45, v8
    v_xor_b32 v128, 0, v8
    v_add_u32 v128, 8192, v128
    v_xor_b32 v129, 32, v8
    v_add_u32 v129, 8192, v129
    v_xor_b32 v130, 64, v8
    v_add_u32 v130, 8192, v130
    v_xor_b32 v131, 96, v8
    v_add_u32 v131, 8192, v131
    v_xor_b32 v132, 0, v8
    v_add_u32 v132, 57344, v132
    v_xor_b32 v133, 32, v8
    v_add_u32 v133, 57344, v133
    v_xor_b32 v134, 64, v8
    v_add_u32 v134, 57344, v134
    v_xor_b32 v135, 96, v8
    v_add_u32 v135, 57344, v135
    v_xor_b32 v136, 0, v8
    v_add_u32 v136, 106496, v136
    v_xor_b32 v137, 32, v8
    v_add_u32 v137, 106496, v137
    v_xor_b32 v138, 64, v8
    v_add_u32 v138, 106496, v138
    v_xor_b32 v139, 96, v8
    v_add_u32 v139, 106496, v139
    v_mov_b32 v64, 0
    v_mov_b32 v65, 0
    v_mov_b32 v66, 0
    v_mov_b32 v67, 0
    v_mov_b32 v68, 0
    v_mov_b32 v69, 0
    v_mov_b32 v70, 0
    v_mov_b32 v71, 0
    v_mov_b32 v72, 0
    v_mov_b32 v73, 0
    v_mov_b32 v74, 0
    v_mov_b32 v75, 0
    v_mov_b32 v76, 0
    v_mov_b32 v77, 0
    v_mov_b32 v78, 0
    v_mov_b32 v79, 0
    v_mov_b32 v80, 0
    v_mov_b32 v81, 0
    v_mov_b32 v82, 0
    v_mov_b32 v83, 0
    v_mov_b32 v84, 0
    v_mov_b32 v85, 0
    v_mov_b32 v86, 0
    v_mov_b32 v87, 0
    v_mov_b32 v88, 0
    v_mov_b32 v89, 0
    v_mov_b32 v90, 0
    v_mov_b32 v91, 0
    v_mov_b32 v92, 0
    v_mov_b32 v93, 0
    v_mov_b32 v94, 0
    v_mov_b32 v95, 0
    v_mov_b32 v40, 0
    v_mov_b32 v41, 0
    v_mov_b32 v42, 0
    v_mov_b32 v43, 0
    v_mov_b32 v44, 0
    v_mov_b32 v45, 0
    v_mov_b32 v46, 0
    v_mov_b32 v47, 0
    v_mov_b32 v48, 0
    v_mov_b32 v49, 0
    v_mov_b32 v50, 0
    v_mov_b32 v51, 0
    v_mov_b32 v52, 0
    v_mov_b32 v53, 0
    v_mov_b32 v54, 0
    v_mov_b32 v55, 0
    v_mov_b32 v56, 0
    v_mov_b32 v57, 0
    v_mov_b32 v58, 0
    v_mov_b32 v59, 0
    v_mov_b32 v60, 0
    v_mov_b32 v61, 0
    v_mov_b32 v62, 0
    v_mov_b32 v63, 0
    s_mov_b32 s43, 0
p4loop_69:
    s_barrier
    v_mfma_f32_16x16x32_bf16 v[64:67], v[48:51], v[40:43], v[64:67]
    ds_read_b128 v[16:19], v140 offset:0
    ds_read_b128 v[20:23], v140 offset:2048
    v_mfma_f32_16x16x32_bf16 v[80:83], v[48:51], v[44:47], v[80:83]
    ds_read_b64_tr_b16 v[24:25], v128 offset:0
    ds_read_b64_tr_b16 v[26:27], v128 offset:4096
    v_mfma_f32_16x16x32_bf16 v[68:71], v[52:55], v[40:43], v[68:71]
    ds_read_b64_tr_b16 v[28:29], v129 offset:0
    ds_read_b64_tr_b16 v[30:31], v129 offset:4096
    v_mfma_f32_16x16x32_bf16 v[84:87], v[52:55], v[44:47], v[84:87]
    ds_read_b64_tr_b16 v[32:33], v130 offset:0
    ds_read_b64_tr_b16 v[34:35], v130 offset:4096
    v_mfma_f32_16x16x32_bf16 v[72:75], v[56:59], v[40:43], v[72:75]
    ds_read_b64_tr_b16 v[36:37], v131 offset:0
    ds_read_b64_tr_b16 v[38:39], v131 offset:4096
    v_mfma_f32_16x16x32_bf16 v[88:91], v[56:59], v[44:47], v[88:91]
    v_mfma_f32_16x16x32_bf16 v[76:79], v[60:63], v[40:43], v[76:79]
    v_mfma_f32_16x16x32_bf16 v[92:95], v[60:63], v[44:47], v[92:95]
    s_waitcnt lgkmcnt(0)
    v_mfma_f32_16x16x32_bf16 v[64:67], v[24:27], v[16:19], v[64:67]
    ds_read_b128 v[40:43], v140 offset:1024
    ds_read_b128 v[44:47], v140 offset:3072
    v_mfma_f32_16x16x32_bf16 v[80:83], v[24:27], v[20:23], v[80:83]
    ds_read_b64_tr_b16 v[48:49], v128 offset:8192
    ds_read_b64_tr_b16 v[50:51], v128 offset:12288
    v_mfma_f32_16x16x32_bf16 v[68:71], v[28:31], v[16:19], v[68:71]
    ds_read_b64_tr_b16 v[52:53], v129 offset:8192
    ds_read_b64_tr_b16 v[54:55], v129 offset:12288
    v_mfma_f32_16x16x32_bf16 v[84:87], v[28:31], v[20:23], v[84:87]
    ds_read_b64_tr_b16 v[56:57], v130 offset:8192
    ds_read_b64_tr_b16 v[58:59], v130 offset:12288
    v_mfma_f32_16x16x32_bf16 v[72:75], v[32:35], v[16:19], v[72:75]
    ds_read_b64_tr_b16 v[60:61], v131 offset:8192
    ds_read_b64_tr_b16 v[62:63], v131 offset:12288
    v_mfma_f32_16x16x32_bf16 v[88:91], v[32:35], v[20:23], v[88:91]
    v_mfma_f32_16x16x32_bf16 v[76:79], v[36:39], v[16:19], v[76:79]
    v_mfma_f32_16x16x32_bf16 v[92:95], v[36:39], v[20:23], v[92:95]
    s_waitcnt lgkmcnt(0)
    s_barrier
    v_mfma_f32_16x16x32_bf16 v[64:67], v[48:51], v[40:43], v[64:67]
    ds_read_b128 v[16:19], v141 offset:0
    ds_read_b128 v[20:23], v141 offset:2048
    v_mfma_f32_16x16x32_bf16 v[80:83], v[48:51], v[44:47], v[80:83]
    ds_read_b64_tr_b16 v[24:25], v128 offset:24576
    ds_read_b64_tr_b16 v[26:27], v128 offset:28672
    v_mfma_f32_16x16x32_bf16 v[68:71], v[52:55], v[40:43], v[68:71]
    ds_read_b64_tr_b16 v[28:29], v129 offset:24576
    ds_read_b64_tr_b16 v[30:31], v129 offset:28672
    v_mfma_f32_16x16x32_bf16 v[84:87], v[52:55], v[44:47], v[84:87]
    ds_read_b64_tr_b16 v[32:33], v130 offset:24576
    ds_read_b64_tr_b16 v[34:35], v130 offset:28672
    v_mfma_f32_16x16x32_bf16 v[72:75], v[56:59], v[40:43], v[72:75]
    ds_read_b64_tr_b16 v[36:37], v131 offset:24576
    ds_read_b64_tr_b16 v[38:39], v131 offset:28672
    v_mfma_f32_16x16x32_bf16 v[88:91], v[56:59], v[44:47], v[88:91]
    v_mfma_f32_16x16x32_bf16 v[76:79], v[60:63], v[40:43], v[76:79]
    v_mfma_f32_16x16x32_bf16 v[92:95], v[60:63], v[44:47], v[92:95]
    s_waitcnt lgkmcnt(0)
    v_mfma_f32_16x16x32_bf16 v[64:67], v[24:27], v[16:19], v[64:67]
    ds_read_b128 v[40:43], v141 offset:1024
    ds_read_b128 v[44:47], v141 offset:3072
    v_mfma_f32_16x16x32_bf16 v[80:83], v[24:27], v[20:23], v[80:83]
    ds_read_b64_tr_b16 v[48:49], v128 offset:32768
    ds_read_b64_tr_b16 v[50:51], v128 offset:36864
    v_mfma_f32_16x16x32_bf16 v[68:71], v[28:31], v[16:19], v[68:71]
    ds_read_b64_tr_b16 v[52:53], v129 offset:32768
    ds_read_b64_tr_b16 v[54:55], v129 offset:36864
    v_mfma_f32_16x16x32_bf16 v[84:87], v[28:31], v[20:23], v[84:87]
    ds_read_b64_tr_b16 v[56:57], v130 offset:32768
    ds_read_b64_tr_b16 v[58:59], v130 offset:36864
    v_mfma_f32_16x16x32_bf16 v[72:75], v[32:35], v[16:19], v[72:75]
    ds_read_b64_tr_b16 v[60:61], v131 offset:32768
    ds_read_b64_tr_b16 v[62:63], v131 offset:36864
    v_mfma_f32_16x16x32_bf16 v[88:91], v[32:35], v[20:23], v[88:91]
    v_mfma_f32_16x16x32_bf16 v[76:79], v[36:39], v[16:19], v[76:79]
    v_mfma_f32_16x16x32_bf16 v[92:95], v[36:39], v[20:23], v[92:95]
    s_waitcnt lgkmcnt(0)
    s_barrier
    v_mfma_f32_16x16x32_bf16 v[64:67], v[48:51], v[40:43], v[64:67]
    ds_read_b128 v[16:19], v142 offset:0
    ds_read_b128 v[20:23], v142 offset:2048
    v_mfma_f32_16x16x32_bf16 v[80:83], v[48:51], v[44:47], v[80:83]
    ds_read_b64_tr_b16 v[24:25], v132 offset:0
    ds_read_b64_tr_b16 v[26:27], v132 offset:4096
    v_mfma_f32_16x16x32_bf16 v[68:71], v[52:55], v[40:43], v[68:71]
    ds_read_b64_tr_b16 v[28:29], v133 offset:0
    ds_read_b64_tr_b16 v[30:31], v133 offset:4096
    v_mfma_f32_16x16x32_bf16 v[84:87], v[52:55], v[44:47], v[84:87]
    ds_read_b64_tr_b16 v[32:33], v134 offset:0
    ds_read_b64_tr_b16 v[34:35], v134 offset:4096
    v_mfma_f32_16x16x32_bf16 v[72:75], v[56:59], v[40:43], v[72:75]
    ds_read_b64_tr_b16 v[36:37], v135 offset:0
    ds_read_b64_tr_b16 v[38:39], v135 offset:4096
    v_mfma_f32_16x16x32_bf16 v[88:91], v[56:59], v[44:47], v[88:91]
    v_mfma_f32_16x16x32_bf16 v[76:79], v[60:63], v[40:43], v[76:79]
    v_mfma_f32_16x16x32_bf16 v[92:95], v[60:63], v[44:47], v[92:95]
    s_waitcnt lgkmcnt(0)
    v_mfma_f32_16x16x32_bf16 v[64:67], v[24:27], v[16:19], v[64:67]
    ds_read_b128 v[40:43], v142 offset:1024
    ds_read_b128 v[44:47], v142 offset:3072
    v_mfma_f32_16x16x32_bf16 v[80:83], v[24:27], v[20:23], v[80:83]
    ds_read_b64_tr_b16 v[48:49], v132 offset:8192
    ds_read_b64_tr_b16 v[50:51], v132 offset:12288
    v_mfma_f32_16x16x32_bf16 v[68:71], v[28:31], v[16:19], v[68:71]
    ds_read_b64_tr_b16 v[52:53], v133 offset:8192
    ds_read_b64_tr_b16 v[54:55], v133 offset:12288
    v_mfma_f32_16x16x32_bf16 v[84:87], v[28:31], v[20:23], v[84:87]
    ds_read_b64_tr_b16 v[56:57], v134 offset:8192
    ds_read_b64_tr_b16 v[58:59], v134 offset:12288
    v_mfma_f32_16x16x32_bf16 v[72:75], v[32:35], v[16:19], v[72:75]
    ds_read_b64_tr_b16 v[60:61], v135 offset:8192
    ds_read_b64_tr_b16 v[62:63], v135 offset:12288
    v_mfma_f32_16x16x32_bf16 v[88:91], v[32:35], v[20:23], v[88:91]
    v_mfma_f32_16x16x32_bf16 v[76:79], v[36:39], v[16:19], v[76:79]
    v_mfma_f32_16x16x32_bf16 v[92:95], v[36:39], v[20:23], v[92:95]
    s_waitcnt lgkmcnt(0)
    s_barrier
    v_mfma_f32_16x16x32_bf16 v[64:67], v[48:51], v[40:43], v[64:67]
    ds_read_b128 v[16:19], v143 offset:0
    ds_read_b128 v[20:23], v143 offset:2048
    v_mfma_f32_16x16x32_bf16 v[80:83], v[48:51], v[44:47], v[80:83]
    ds_read_b64_tr_b16 v[24:25], v132 offset:24576
    ds_read_b64_tr_b16 v[26:27], v132 offset:28672
    v_mfma_f32_16x16x32_bf16 v[68:71], v[52:55], v[40:43], v[68:71]
    ds_read_b64_tr_b16 v[28:29], v133 offset:24576
    ds_read_b64_tr_b16 v[30:31], v133 offset:28672
    v_mfma_f32_16x16x32_bf16 v[84:87], v[52:55], v[44:47], v[84:87]
    ds_read_b64_tr_b16 v[32:33], v134 offset:24576
    ds_read_b64_tr_b16 v[34:35], v134 offset:28672
    v_mfma_f32_16x16x32_bf16 v[72:75], v[56:59], v[40:43], v[72:75]
    ds_read_b64_tr_b16 v[36:37], v135 offset:24576
    ds_read_b64_tr_b16 v[38:39], v135 offset:28672
    v_mfma_f32_16x16x32_bf16 v[88:91], v[56:59], v[44:47], v[88:91]
    v_mfma_f32_16x16x32_bf16 v[76:79], v[60:63], v[40:43], v[76:79]
    v_mfma_f32_16x16x32_bf16 v[92:95], v[60:63], v[44:47], v[92:95]
    s_waitcnt lgkmcnt(0)
    v_mfma_f32_16x16x32_bf16 v[64:67], v[24:27], v[16:19], v[64:67]
    ds_read_b128 v[40:43], v143 offset:1024
    ds_read_b128 v[44:47], v143 offset:3072
    v_mfma_f32_16x16x32_bf16 v[80:83], v[24:27], v[20:23], v[80:83]
    ds_read_b64_tr_b16 v[48:49], v132 offset:32768
    ds_read_b64_tr_b16 v[50:51], v132 offset:36864
    v_mfma_f32_16x16x32_bf16 v[68:71], v[28:31], v[16:19], v[68:71]
    ds_read_b64_tr_b16 v[52:53], v133 offset:32768
    ds_read_b64_tr_b16 v[54:55], v133 offset:36864
    v_mfma_f32_16x16x32_bf16 v[84:87], v[28:31], v[20:23], v[84:87]
    ds_read_b64_tr_b16 v[56:57], v134 offset:32768
    ds_read_b64_tr_b16 v[58:59], v134 offset:36864
    v_mfma_f32_16x16x32_bf16 v[72:75], v[32:35], v[16:19], v[72:75]
    ds_read_b64_tr_b16 v[60:61], v135 offset:32768
    ds_read_b64_tr_b16 v[62:63], v135 offset:36864
    v_mfma_f32_16x16x32_bf16 v[88:91], v[32:35], v[20:23], v[88:91]
    v_mfma_f32_16x16x32_bf16 v[76:79], v[36:39], v[16:19], v[76:79]
    v_mfma_f32_16x16x32_bf16 v[92:95], v[36:39], v[20:23], v[92:95]
    s_waitcnt lgkmcnt(0)
    s_barrier
    v_mfma_f32_16x16x32_bf16 v[64:67], v[48:51], v[40:43], v[64:67]
    ds_read_b128 v[16:19], v144 offset:0
    ds_read_b128 v[20:23], v144 offset:2048
    v_mfma_f32_16x16x32_bf16 v[80:83], v[48:51], v[44:47], v[80:83]
    ds_read_b64_tr_b16 v[24:25], v136 offset:0
    ds_read_b64_tr_b16 v[26:27], v136 offset:4096
    v_mfma_f32_16x16x32_bf16 v[68:71], v[52:55], v[40:43], v[68:71]
    ds_read_b64_tr_b16 v[28:29], v137 offset:0
    ds_read_b64_tr_b16 v[30:31], v137 offset:4096
    v_mfma_f32_16x16x32_bf16 v[84:87], v[52:55], v[44:47], v[84:87]
    ds_read_b64_tr_b16 v[32:33], v138 offset:0
    ds_read_b64_tr_b16 v[34:35], v138 offset:4096
    v_mfma_f32_16x16x32_bf16 v[72:75], v[56:59], v[40:43], v[72:75]
    ds_read_b64_tr_b16 v[36:37], v139 offset:0
    ds_read_b64_tr_b16 v[38:39], v139 offset:4096
    v_mfma_f32_16x16x32_bf16 v[88:91], v[56:59], v[44:47], v[88:91]
    v_mfma_f32_16x16x32_bf16 v[76:79], v[60:63], v[40:43], v[76:79]
    v_mfma_f32_16x16x32_bf16 v[92:95], v[60:63], v[44:47], v[92:95]
    s_waitcnt lgkmcnt(0)
    v_mfma_f32_16x16x32_bf16 v[64:67], v[24:27], v[16:19], v[64:67]
    ds_read_b128 v[40:43], v144 offset:1024
    ds_read_b128 v[44:47], v144 offset:3072
    v_mfma_f32_16x16x32_bf16 v[80:83], v[24:27], v[20:23], v[80:83]
    ds_read_b64_tr_b16 v[48:49], v136 offset:8192
    ds_read_b64_tr_b16 v[50:51], v136 offset:12288
    v_mfma_f32_16x16x32_bf16 v[68:71], v[28:31], v[16:19], v[68:71]
    ds_read_b64_tr_b16 v[52:53], v137 offset:8192
    ds_read_b64_tr_b16 v[54:55], v137 offset:12288
    v_mfma_f32_16x16x32_bf16 v[84:87], v[28:31], v[20:23], v[84:87]
    ds_read_b64_tr_b16 v[56:57], v138 offset:8192
    ds_read_b64_tr_b16 v[58:59], v138 offset:12288
    v_mfma_f32_16x16x32_bf16 v[72:75], v[32:35], v[16:19], v[72:75]
    ds_read_b64_tr_b16 v[60:61], v139 offset:8192
    ds_read_b64_tr_b16 v[62:63], v139 offset:12288
    v_mfma_f32_16x16x32_bf16 v[88:91], v[32:35], v[20:23], v[88:91]
    v_mfma_f32_16x16x32_bf16 v[76:79], v[36:39], v[16:19], v[76:79]
    v_mfma_f32_16x16x32_bf16 v[92:95], v[36:39], v[20:23], v[92:95]
    s_waitcnt lgkmcnt(0)
    s_barrier
    v_mfma_f32_16x16x32_bf16 v[64:67], v[48:51], v[40:43], v[64:67]
    ds_read_b128 v[16:19], v145 offset:0
    ds_read_b128 v[20:23], v145 offset:2048
    v_mfma_f32_16x16x32_bf16 v[80:83], v[48:51], v[44:47], v[80:83]
    ds_read_b64_tr_b16 v[24:25], v136 offset:24576
    ds_read_b64_tr_b16 v[26:27], v136 offset:28672
    v_mfma_f32_16x16x32_bf16 v[68:71], v[52:55], v[40:43], v[68:71]
    ds_read_b64_tr_b16 v[28:29], v137 offset:24576
    ds_read_b64_tr_b16 v[30:31], v137 offset:28672
    v_mfma_f32_16x16x32_bf16 v[84:87], v[52:55], v[44:47], v[84:87]
    ds_read_b64_tr_b16 v[32:33], v138 offset:24576
    ds_read_b64_tr_b16 v[34:35], v138 offset:28672
    v_mfma_f32_16x16x32_bf16 v[72:75], v[56:59], v[40:43], v[72:75]
    ds_read_b64_tr_b16 v[36:37], v139 offset:24576
    ds_read_b64_tr_b16 v[38:39], v139 offset:28672
    v_mfma_f32_16x16x32_bf16 v[88:91], v[56:59], v[44:47], v[88:91]
    v_mfma_f32_16x16x32_bf16 v[76:79], v[60:63], v[40:43], v[76:79]
    v_mfma_f32_16x16x32_bf16 v[92:95], v[60:63], v[44:47], v[92:95]
    s_waitcnt lgkmcnt(0)
    v_mfma_f32_16x16x32_bf16 v[64:67], v[24:27], v[16:19], v[64:67]
    ds_read_b128 v[40:43], v145 offset:1024
    ds_read_b128 v[44:47], v145 offset:3072
    v_mfma_f32_16x16x32_bf16 v[80:83], v[24:27], v[20:23], v[80:83]
    ds_read_b64_tr_b16 v[48:49], v136 offset:32768
    ds_read_b64_tr_b16 v[50:51], v136 offset:36864
    v_mfma_f32_16x16x32_bf16 v[68:71], v[28:31], v[16:19], v[68:71]
    ds_read_b64_tr_b16 v[52:53], v137 offset:32768
    ds_read_b64_tr_b16 v[54:55], v137 offset:36864
    v_mfma_f32_16x16x32_bf16 v[84:87], v[28:31], v[20:23], v[84:87]
    ds_read_b64_tr_b16 v[56:57], v138 offset:32768
    ds_read_b64_tr_b16 v[58:59], v138 offset:36864
    v_mfma_f32_16x16x32_bf16 v[72:75], v[32:35], v[16:19], v[72:75]
    ds_read_b64_tr_b16 v[60:61], v139 offset:32768
    ds_read_b64_tr_b16 v[62:63], v139 offset:36864
    v_mfma_f32_16x16x32_bf16 v[88:91], v[32:35], v[20:23], v[88:91]
    v_mfma_f32_16x16x32_bf16 v[76:79], v[36:39], v[16:19], v[76:79]
    v_mfma_f32_16x16x32_bf16 v[92:95], v[36:39], v[20:23], v[92:95]
    s_waitcnt lgkmcnt(0)
    s_add_u32 s43, s43, 1
    s_cmp_lt_u32 s43, 2
    s_cbranch_scc1 p4loop_69
    s_barrier
    v_mfma_f32_16x16x32_bf16 v[64:67], v[48:51], v[40:43], v[64:67]
    ds_read_b128 v[16:19], v140 offset:0
    ds_read_b128 v[20:23], v140 offset:2048
    v_mfma_f32_16x16x32_bf16 v[80:83], v[48:51], v[44:47], v[80:83]
    ds_read_b64_tr_b16 v[24:25], v128 offset:0
    ds_read_b64_tr_b16 v[26:27], v128 offset:4096
    v_mfma_f32_16x16x32_bf16 v[68:71], v[52:55], v[40:43], v[68:71]
    ds_read_b64_tr_b16 v[28:29], v129 offset:0
    ds_read_b64_tr_b16 v[30:31], v129 offset:4096
    v_mfma_f32_16x16x32_bf16 v[84:87], v[52:55], v[44:47], v[84:87]
    ds_read_b64_tr_b16 v[32:33], v130 offset:0
    ds_read_b64_tr_b16 v[34:35], v130 offset:4096
    v_mfma_f32_16x16x32_bf16 v[72:75], v[56:59], v[40:43], v[72:75]
    ds_read_b64_tr_b16 v[36:37], v131 offset:0
    ds_read_b64_tr_b16 v[38:39], v131 offset:4096
    v_mfma_f32_16x16x32_bf16 v[88:91], v[56:59], v[44:47], v[88:91]
    v_mfma_f32_16x16x32_bf16 v[76:79], v[60:63], v[40:43], v[76:79]
    v_mfma_f32_16x16x32_bf16 v[92:95], v[60:63], v[44:47], v[92:95]
    s_waitcnt lgkmcnt(0)
    v_mfma_f32_16x16x32_bf16 v[64:67], v[24:27], v[16:19], v[64:67]
    ds_read_b128 v[40:43], v140 offset:1024
    ds_read_b128 v[44:47], v140 offset:3072
    v_mfma_f32_16x16x32_bf16 v[80:83], v[24:27], v[20:23], v[80:83]
    ds_read_b64_tr_b16 v[48:49], v128 offset:8192
    ds_read_b64_tr_b16 v[50:51], v128 offset:12288
    v_mfma_f32_16x16x32_bf16 v[68:71], v[28:31], v[16:19], v[68:71]
    ds_read_b64_tr_b16 v[52:53], v129 offset:8192
    ds_read_b64_tr_b16 v[54:55], v129 offset:12288
    v_mfma_f32_16x16x32_bf16 v[84:87], v[28:31], v[20:23], v[84:87]
    ds_read_b64_tr_b16 v[56:57], v130 offset:8192
    ds_read_b64_tr_b16 v[58:59], v130 offset:12288
    v_mfma_f32_16x16x32_bf16 v[72:75], v[32:35], v[16:19], v[72:75]
    ds_read_b64_tr_b16 v[60:61], v131 offset:8192
    ds_read_b64_tr_b16 v[62:63], v131 offset:12288
    v_mfma_f32_16x16x32_bf16 v[88:91], v[32:35], v[20:23], v[88:91]
    v_mfma_f32_16x16x32_bf16 v[76:79], v[36:39], v[16:19], v[76:79]
    v_mfma_f32_16x16x32_bf16 v[92:95], v[36:39], v[20:23], v[92:95]
    s_waitcnt lgkmcnt(0)
    s_barrier
    v_mfma_f32_16x16x32_bf16 v[64:67], v[48:51], v[40:43], v[64:67]
    ds_read_b128 v[16:19], v141 offset:0
    ds_read_b128 v[20:23], v141 offset:2048
    v_mfma_f32_16x16x32_bf16 v[80:83], v[48:51], v[44:47], v[80:83]
    ds_read_b64_tr_b16 v[24:25], v128 offset:24576
    ds_read_b64_tr_b16 v[26:27], v128 offset:28672
    v_mfma_f32_16x16x32_bf16 v[68:71], v[52:55], v[40:43], v[68:71]
    ds_read_b64_tr_b16 v[28:29], v129 offset:24576
    ds_read_b64_tr_b16 v[30:31], v129 offset:28672
    v_mfma_f32_16x16x32_bf16 v[84:87], v[52:55], v[44:47], v[84:87]
    ds_read_b64_tr_b16 v[32:33], v130 offset:24576
    ds_read_b64_tr_b16 v[34:35], v130 offset:28672
    v_mfma_f32_16x16x32_bf16 v[72:75], v[56:59], v[40:43], v[72:75]
    ds_read_b64_tr_b16 v[36:37], v131 offset:24576
    ds_read_b64_tr_b16 v[38:39], v131 offset:28672
    v_mfma_f32_16x16x32_bf16 v[88:91], v[56:59], v[44:47], v[88:91]
    v_mfma_f32_16x16x32_bf16 v[76:79], v[60:63], v[40:43], v[76:79]
    v_mfma_f32_16x16x32_bf16 v[92:95], v[60:63], v[44:47], v[92:95]
    s_waitcnt lgkmcnt(0)
    v_mfma_f32_16x16x32_bf16 v[64:67], v[24:27], v[16:19], v[64:67]
    ds_read_b128 v[40:43], v141 offset:1024
    ds_read_b128 v[44:47], v141 offset:3072
    v_mfma_f32_16x16x32_bf16 v[80:83], v[24:27], v[20:23], v[80:83]
    ds_read_b64_tr_b16 v[48:49], v128 offset:32768
    ds_read_b64_tr_b16 v[50:51], v128 offset:36864
    v_mfma_f32_16x16x32_bf16 v[68:71], v[28:31], v[16:19], v[68:71]
    ds_read_b64_tr_b16 v[52:53], v129 offset:32768
    ds_read_b64_tr_b16 v[54:55], v129 offset:36864
    v_mfma_f32_16x16x32_bf16 v[84:87], v[28:31], v[20:23], v[84:87]
    ds_read_b64_tr_b16 v[56:57], v130 offset:32768
    ds_read_b64_tr_b16 v[58:59], v130 offset:36864
    v_mfma_f32_16x16x32_bf16 v[72:75], v[32:35], v[16:19], v[72:75]
    ds_read_b64_tr_b16 v[60:61], v131 offset:32768
    ds_read_b64_tr_b16 v[62:63], v131 offset:36864
    v_mfma_f32_16x16x32_bf16 v[88:91], v[32:35], v[20:23], v[88:91]
    v_mfma_f32_16x16x32_bf16 v[76:79], v[36:39], v[16:19], v[76:79]
    v_mfma_f32_16x16x32_bf16 v[92:95], v[36:39], v[20:23], v[92:95]
    s_waitcnt lgkmcnt(0)
    s_barrier
    v_mfma_f32_16x16x32_bf16 v[64:67], v[48:51], v[40:43], v[64:67]
    ds_read_b128 v[16:19], v142 offset:0
    ds_read_b128 v[20:23], v142 offset:2048
    v_mfma_f32_16x16x32_bf16 v[80:83], v[48:51], v[44:47], v[80:83]
    ds_read_b64_tr_b16 v[24:25], v132 offset:0
    ds_read_b64_tr_b16 v[26:27], v132 offset:4096
    v_mfma_f32_16x16x32_bf16 v[68:71], v[52:55], v[40:43], v[68:71]
    ds_read_b64_tr_b16 v[28:29], v133 offset:0
    ds_read_b64_tr_b16 v[30:31], v133 offset:4096
    v_mfma_f32_16x16x32_bf16 v[84:87], v[52:55], v[44:47], v[84:87]
    ds_read_b64_tr_b16 v[32:33], v134 offset:0
    ds_read_b64_tr_b16 v[34:35], v134 offset:4096
    v_mfma_f32_16x16x32_bf16 v[72:75], v[56:59], v[40:43], v[72:75]
    ds_read_b64_tr_b16 v[36:37], v135 offset:0
    ds_read_b64_tr_b16 v[38:39], v135 offset:4096
    v_mfma_f32_16x16x32_bf16 v[88:91], v[56:59], v[44:47], v[88:91]
    v_mfma_f32_16x16x32_bf16 v[76:79], v[60:63], v[40:43], v[76:79]
    v_mfma_f32_16x16x32_bf16 v[92:95], v[60:63], v[44:47], v[92:95]
    s_waitcnt lgkmcnt(0)
    v_mfma_f32_16x16x32_bf16 v[64:67], v[24:27], v[16:19], v[64:67]
    ds_read_b128 v[40:43], v142 offset:1024
    ds_read_b128 v[44:47], v142 offset:3072
    v_mfma_f32_16x16x32_bf16 v[80:83], v[24:27], v[20:23], v[80:83]
    ds_read_b64_tr_b16 v[48:49], v132 offset:8192
    ds_read_b64_tr_b16 v[50:51], v132 offset:12288
    v_mfma_f32_16x16x32_bf16 v[68:71], v[28:31], v[16:19], v[68:71]
    ds_read_b64_tr_b16 v[52:53], v133 offset:8192
    ds_read_b64_tr_b16 v[54:55], v133 offset:12288
    v_mfma_f32_16x16x32_bf16 v[84:87], v[28:31], v[20:23], v[84:87]
    ds_read_b64_tr_b16 v[56:57], v134 offset:8192
    ds_read_b64_tr_b16 v[58:59], v134 offset:12288
    v_mfma_f32_16x16x32_bf16 v[72:75], v[32:35], v[16:19], v[72:75]
    ds_read_b64_tr_b16 v[60:61], v135 offset:8192
    ds_read_b64_tr_b16 v[62:63], v135 offset:12288
    v_mfma_f32_16x16x32_bf16 v[88:91], v[32:35], v[20:23], v[88:91]
    v_mfma_f32_16x16x32_bf16 v[76:79], v[36:39], v[16:19], v[76:79]
    v_mfma_f32_16x16x32_bf16 v[92:95], v[36:39], v[20:23], v[92:95]
    s_waitcnt lgkmcnt(0)
    s_barrier
    v_mfma_f32_16x16x32_bf16 v[64:67], v[48:51], v[40:43], v[64:67]
    ds_read_b128 v[16:19], v143 offset:0
    ds_read_b128 v[20:23], v143 offset:2048
    v_mfma_f32_16x16x32_bf16 v[80:83], v[48:51], v[44:47], v[80:83]
    ds_read_b64_tr_b16 v[24:25], v132 offset:24576
    ds_read_b64_tr_b16 v[26:27], v132 offset:28672
    v_mfma_f32_16x16x32_bf16 v[68:71], v[52:55], v[40:43], v[68:71]
    ds_read_b64_tr_b16 v[28:29], v133 offset:24576
    ds_read_b64_tr_b16 v[30:31], v133 offset:28672
    v_mfma_f32_16x16x32_bf16 v[84:87], v[52:55], v[44:47], v[84:87]
    ds_read_b64_tr_b16 v[32:33], v134 offset:24576
    ds_read_b64_tr_b16 v[34:35], v134 offset:28672
    v_mfma_f32_16x16x32_bf16 v[72:75], v[56:59], v[40:43], v[72:75]
    ds_read_b64_tr_b16 v[36:37], v135 offset:24576
    ds_read_b64_tr_b16 v[38:39], v135 offset:28672
    v_mfma_f32_16x16x32_bf16 v[88:91], v[56:59], v[44:47], v[88:91]
    v_mfma_f32_16x16x32_bf16 v[76:79], v[60:63], v[40:43], v[76:79]
    v_mfma_f32_16x16x32_bf16 v[92:95], v[60:63], v[44:47], v[92:95]
    s_waitcnt lgkmcnt(0)
    v_mfma_f32_16x16x32_bf16 v[64:67], v[24:27], v[16:19], v[64:67]
    ds_read_b128 v[40:43], v143 offset:1024
    ds_read_b128 v[44:47], v143 offset:3072
    v_mfma_f32_16x16x32_bf16 v[80:83], v[24:27], v[20:23], v[80:83]
    ds_read_b64_tr_b16 v[48:49], v132 offset:32768
    ds_read_b64_tr_b16 v[50:51], v132 offset:36864
    v_mfma_f32_16x16x32_bf16 v[68:71], v[28:31], v[16:19], v[68:71]
    ds_read_b64_tr_b16 v[52:53], v133 offset:32768
    ds_read_b64_tr_b16 v[54:55], v133 offset:36864
    v_mfma_f32_16x16x32_bf16 v[84:87], v[28:31], v[20:23], v[84:87]
    ds_read_b64_tr_b16 v[56:57], v134 offset:32768
    ds_read_b64_tr_b16 v[58:59], v134 offset:36864
    v_mfma_f32_16x16x32_bf16 v[72:75], v[32:35], v[16:19], v[72:75]
    ds_read_b64_tr_b16 v[60:61], v135 offset:32768
    ds_read_b64_tr_b16 v[62:63], v135 offset:36864
    v_mfma_f32_16x16x32_bf16 v[88:91], v[32:35], v[20:23], v[88:91]
    v_mfma_f32_16x16x32_bf16 v[76:79], v[36:39], v[16:19], v[76:79]
    v_mfma_f32_16x16x32_bf16 v[92:95], v[36:39], v[20:23], v[92:95]
    s_waitcnt lgkmcnt(0)
    v_mfma_f32_16x16x32_bf16 v[64:67], v[48:51], v[40:43], v[64:67]
    v_mfma_f32_16x16x32_bf16 v[80:83], v[48:51], v[44:47], v[80:83]
    v_mfma_f32_16x16x32_bf16 v[68:71], v[52:55], v[40:43], v[68:71]
    v_mfma_f32_16x16x32_bf16 v[84:87], v[52:55], v[44:47], v[84:87]
    v_mfma_f32_16x16x32_bf16 v[72:75], v[56:59], v[40:43], v[72:75]
    v_mfma_f32_16x16x32_bf16 v[88:91], v[56:59], v[44:47], v[88:91]
    v_mfma_f32_16x16x32_bf16 v[76:79], v[60:63], v[40:43], v[76:79]
    v_mfma_f32_16x16x32_bf16 v[92:95], v[60:63], v[44:47], v[92:95]
    s_nop 7
    s_waitcnt vmcnt(0)
    v_permlane16_swap_b32 v64, v68
    v_permlane16_swap_b32 v65, v69
    v_permlane16_swap_b32 v66, v70
    v_permlane16_swap_b32 v67, v71
    v_permlane16_swap_b32 v72, v76
    v_permlane16_swap_b32 v73, v77
    v_permlane16_swap_b32 v74, v78
    v_permlane16_swap_b32 v75, v79
    v_permlane16_swap_b32 v80, v84
    v_permlane16_swap_b32 v81, v85
    v_permlane16_swap_b32 v82, v86
    v_permlane16_swap_b32 v83, v87
    v_permlane16_swap_b32 v88, v92
    v_permlane16_swap_b32 v89, v93
    v_permlane16_swap_b32 v90, v94
    v_permlane16_swap_b32 v91, v95
    s_nop 1
    v_lshlrev_b32 v16, 16, v96
    v_and_b32 v17, 0xffff0000, v96
    v_lshlrev_b32 v18, 16, v97
    v_and_b32 v19, 0xffff0000, v97
    v_lshlrev_b32 v20, 16, v98
    v_and_b32 v21, 0xffff0000, v98
    v_lshlrev_b32 v22, 16, v99
    v_and_b32 v23, 0xffff0000, v99
    v_pk_add_f32 v[64:65], v[64:65], v[16:17]
    v_pk_add_f32 v[66:67], v[66:67], v[18:19]
    v_pk_add_f32 v[68:69], v[68:69], v[20:21]
    v_pk_add_f32 v[70:71], v[70:71], v[22:23]
    v_cvt_pk_bf16_f32 v96, v64, v65
    v_cvt_pk_bf16_f32 v97, v66, v67
    v_cvt_pk_bf16_f32 v98, v68, v69
    v_cvt_pk_bf16_f32 v99, v70, v71
    v_lshlrev_b32 v16, 16, v100
    v_and_b32 v17, 0xffff0000, v100
    v_lshlrev_b32 v18, 16, v101
    v_and_b32 v19, 0xffff0000, v101
    v_lshlrev_b32 v20, 16, v102
    v_and_b32 v21, 0xffff0000, v102
    v_lshlrev_b32 v22, 16, v103
    v_and_b32 v23, 0xffff0000, v103
    v_pk_add_f32 v[72:73], v[72:73], v[16:17]
    v_pk_add_f32 v[74:75], v[74:75], v[18:19]
    v_pk_add_f32 v[76:77], v[76:77], v[20:21]
    v_pk_add_f32 v[78:79], v[78:79], v[22:23]
    v_cvt_pk_bf16_f32 v100, v72, v73
    v_cvt_pk_bf16_f32 v101, v74, v75
    v_cvt_pk_bf16_f32 v102, v76, v77
    v_cvt_pk_bf16_f32 v103, v78, v79
    v_lshlrev_b32 v16, 16, v104
    v_and_b32 v17, 0xffff0000, v104
    v_lshlrev_b32 v18, 16, v105
    v_and_b32 v19, 0xffff0000, v105
    v_lshlrev_b32 v20, 16, v106
    v_and_b32 v21, 0xffff0000, v106
    v_lshlrev_b32 v22, 16, v107
    v_and_b32 v23, 0xffff0000, v107
    v_pk_add_f32 v[80:81], v[80:81], v[16:17]
    v_pk_add_f32 v[82:83], v[82:83], v[18:19]
    v_pk_add_f32 v[84:85], v[84:85], v[20:21]
    v_pk_add_f32 v[86:87], v[86:87], v[22:23]
    v_cvt_pk_bf16_f32 v104, v80, v81
    v_cvt_pk_bf16_f32 v105, v82, v83
    v_cvt_pk_bf16_f32 v106, v84, v85
    v_cvt_pk_bf16_f32 v107, v86, v87
    v_lshlrev_b32 v16, 16, v108
    v_and_b32 v17, 0xffff0000, v108
    v_lshlrev_b32 v18, 16, v109
    v_and_b32 v19, 0xffff0000, v109
    v_lshlrev_b32 v20, 16, v110
    v_and_b32 v21, 0xffff0000, v110
    v_lshlrev_b32 v22, 16, v111
    v_and_b32 v23, 0xffff0000, v111
    v_pk_add_f32 v[88:89], v[88:89], v[16:17]
    v_pk_add_f32 v[90:91], v[90:91], v[18:19]
    v_pk_add_f32 v[92:93], v[92:93], v[20:21]
    v_pk_add_f32 v[94:95], v[94:95], v[22:23]
    v_cvt_pk_bf16_f32 v108, v88, v89
    v_cvt_pk_bf16_f32 v109, v90, v91
    v_cvt_pk_bf16_f32 v110, v92, v93
    v_cvt_pk_bf16_f32 v111, v94, v95
    s_mov_b32 s24, s82
    s_mov_b32 s25, s83
    s_mov_b32 s26, 0x400000
    s_mov_b32 s27, 0x20000
    v_lshlrev_b32 v6, 11, v3
    v_and_b32 v7, 1, v4
    v_lshl_add_u32 v6, v7, 5, v6
    v_lshrrev_b32 v7, 1, v4
    v_lshl_add_u32 v6, v7, 4, v6
    s_lshl_b32 s45, s6, 17
    s_lshl_b32 s46, s37, 16
    s_add_u32 s45, s45, s46
    s_lshl_b32 s46, s7, 8
    s_add_u32 s45, s45, s46
    s_lshl_b32 s46, s38, 7
    s_add_u32 s45, s45, s46
    s_add_u32 s46, s45, 0
    buffer_store_dwordx4 v[96:99], v6, s[24:27], s46 offen offset:0
    buffer_store_dwordx4 v[100:103], v6, s[24:27], s46 offen offset:64
    s_add_u32 s46, s45, 32768
    buffer_store_dwordx4 v[104:107], v6, s[24:27], s46 offen offset:0
    buffer_store_dwordx4 v[108:111], v6, s[24:27], s46 offen offset:64
    s_branch p4end_68
p4end_68:
L_done:
    s_endpgm
.section .rodata,"a"
.p2align 6
.amdhsa_kernel interleave_layers__ssm_conv_h3__linear_attn_block__prompt_kernel
  .amdhsa_next_free_vgpr 256
  .amdhsa_next_free_sgpr 102
  .amdhsa_accum_offset 256
  .amdhsa_group_segment_fixed_size 0
  .amdhsa_kernarg_size 96
  .amdhsa_user_sgpr_count 2
  .amdhsa_user_sgpr_kernarg_segment_ptr 1
  .amdhsa_system_sgpr_workgroup_id_x 1
.end_amdhsa_kernel
```
